```python
import torch

def _softmax(x, axis=-1):
    return torch.softmax(x, dim=axis)
def _gelu(x):
    return torch.nn.functional.gelu(x, approximate="tanh")
def _silu(x):
    return torch.nn.functional.silu(x)
def _sigmoid(x):
    return torch.sigmoid(x)
def _layernorm(x, axis=-1, eps=1e-5):
    m = x.mean(dim=axis, keepdim=True)
    v = x.var(dim=axis, keepdim=True, unbiased=False)
    return (x - m) / torch.sqrt(v + eps)
def _scatter_add(tgt, idx, src, axis=0):
    return tgt.clone().index_add_(axis, idx, src)
def _segment_sum(src, seg, n):
    out = torch.zeros((n,) + src.shape[1:], dtype=src.dtype)
    return out.index_add_(0, seg, src)
def _pad(x, pw):
    flat = tuple(v for pair in reversed(pw) for v in pair)
    return torch.nn.functional.pad(x, flat)

kernel_name = 'standalone__mha_softmax__near_ridge'

def setup_inputs():

    _w = (lambda a: (lambda t: t.to(torch.bfloat16) if t.is_floating_point() else t)(torch.as_tensor(a)))
    B, H, Sq, Sk, D = 16, 32, 512, 512, 192
    return {
        "q": _w((lambda *s: torch.randn(*s, dtype=torch.bfloat16) * 0.8)(B, H, Sq, D)),
        "k": _w((lambda *s: torch.randn(*s, dtype=torch.bfloat16) * 0.8)(B, H, Sk, D)),
        "v": _w((lambda *s: torch.randn(*s, dtype=torch.bfloat16) * 0.05)(B, H, Sk, D)),
    }

def reference(q, k, v):
    scale = q.shape[-1] ** -0.5
    scores = torch.einsum("bhqd,bhkd->bhqk", q, k) * scale
    p = _softmax(scores, axis=-1)
    return torch.einsum("bhqk,bhkd->bhqd", p, v)
```

```asm
; @launch grid=(256,1,1) block=(256,1,1) lds=163840
.amdgcn_target "amdgcn-amd-amdhsa--gfx950"
.text
.globl standalone__mha_softmax__near_ridge_kernel
.p2align 8
.type standalone__mha_softmax__near_ridge_kernel,@function
standalone__mha_softmax__near_ridge_kernel:
 s_cmp_ge_u32 s2, 256
 s_cbranch_scc1 L_end
 s_load_dwordx8 s[36:43], s[0:1], 0
 s_getpc_b64 s[32:33]
L_pf:
 v_lshlrev_b32 v30, 7, v0
 global_load_dword v22, v30, s[32:33]
 v_add_u32 v30, 32768, v30
 v_min_u32 v30, L_codeend-L_pf-4, v30
 global_load_dword v23, v30, s[32:33]
 s_lshr_b32 s44, s2, 4
 s_lshl_b32 s44, s44, 3
 s_and_b32 s45, s2, 7
 s_add_u32 s44, s44, s45
 s_lshr_b32 s45, s2, 3
 s_and_b32 s45, s45, 1
 v_lshrrev_b32 v26, 6, v0
 v_and_b32 v0, 63, v0
 v_readfirstlane_b32 s46, v26
 s_mul_i32 s47, s44, 196608
 s_mul_i32 s48, s45, 98304
 s_mul_i32 s49, s46, 24576
 s_add_u32 s48, s48, s49
 s_add_u32 s48, s48, s47
 s_add_u32 s45, s49, 61440
 s_mul_i32 s21, s46, 3072
 v_and_b32 v26, 1, v0
 v_lshlrev_b32 v26, 4, v26
 v_lshrrev_b32 v27, 4, v0
 v_lshl_add_u32 v26, v27, 5, v26
 v_bfe_u32 v27, v0, 1, 3
 v_mul_u32_u24 v27, 384, v27
 v_add_u32 v26, v26, v27
 s_add_u32 s49, s21, 2048
 v_add_u32 v4, s49, v26
 v_add_u32 v5, -896, v4
 v_add_u32 v6, -1792, v4
 s_mov_b32 s50, 0
 s_mov_b32 s51, 3072
 s_mov_b32 s52, 6144
 s_mov_b32 s53, 9216
 s_mov_b32 s54, 12288
 s_mov_b32 s55, 15360
 s_mov_b32 s56, 18432
 s_mov_b32 s57, 21504
 s_add_u32 s35, s49, 24576
 s_mov_b32 s6, 75696128
 s_mov_b32 s7, 0x00020000
 s_mov_b32 s14, s35
 s_mov_b32 s15, 0x00020000
 s_mov_b32 s10, 75696128
 s_mov_b32 s11, 0x00020000
 s_mov_b32 s18, 0
 s_mov_b32 s19, 0x00020000
 s_waitcnt lgkmcnt(0)
 s_add_u32 s4, s38, s47
 s_addc_u32 s5, s39, 0
 s_sub_u32 s4, s4, 2048
 s_subb_u32 s5, s5, 0
 s_mov_b32 s20, 0
 s_add_u32 m0, s21, 0
 s_nop 0
 buffer_load_dwordx4 v4, s[4:7], s20 offen lds
 buffer_load_dwordx4 v5, s[4:7], s20 offen offset:1024 lds
 buffer_load_dwordx4 v6, s[4:7], s20 offen offset:2048 lds
 s_add_u32 s12, s36, s48
 s_addc_u32 s13, s37, 0
 s_sub_u32 s12, s12, s49
 s_subb_u32 s13, s13, 0
 s_add_u32 m0, s45, 0
 s_nop 0
 buffer_load_dwordx4 v4, s[12:15], s50 offen nt lds
 s_add_u32 m0, s45, 3072
 s_nop 0
 buffer_load_dwordx4 v4, s[12:15], s51 offen nt lds
 s_add_u32 m0, s45, 6144
 s_nop 0
 buffer_load_dwordx4 v4, s[12:15], s52 offen nt lds
 s_add_u32 m0, s45, 9216
 s_nop 0
 buffer_load_dwordx4 v4, s[12:15], s53 offen nt lds
 s_add_u32 m0, s45, 12288
 s_nop 0
 buffer_load_dwordx4 v4, s[12:15], s54 offen nt lds
 s_add_u32 m0, s45, 15360
 s_nop 0
 buffer_load_dwordx4 v4, s[12:15], s55 offen nt lds
 s_add_u32 m0, s45, 18432
 s_nop 0
 buffer_load_dwordx4 v4, s[12:15], s56 offen nt lds
 s_add_u32 m0, s45, 21504
 s_nop 0
 buffer_load_dwordx4 v4, s[12:15], s57 offen nt lds
 v_and_b32 v26, 1, v0
 v_lshlrev_b32 v26, 6, v26
 v_lshrrev_b32 v27, 4, v0
 v_lshl_add_u32 v26, v27, 4, v26
 v_bfe_u32 v27, v0, 1, 3
 v_mul_u32_u24 v27, 384, v27
 v_add_u32 v26, v26, v27
 v_add_u32 v26, s49, v26
 v_add_u32 v8, -1792, v26
 s_add_u32 s8, s40, s47
 s_addc_u32 s9, s41, 0
 s_sub_u32 s8, s8, 2048
 s_subb_u32 s9, s9, 0
 s_add_u32 s16, s42, s48
 s_addc_u32 s17, s43, 0
 s_sub_u32 s16, s16, 25165824
 s_subb_u32 s17, s17, 0
 s_mov_b32 s22, 0x3dd53b95
 s_mov_b32 s23, 0xbdd53b95
 s_mov_b32 s24, 0x4e800000
 s_mov_b32 s26, 0
 s_mov_b32 s27, 1
 s_mov_b32 s3, 0
 s_lshl_b32 s34, s46, 11
 s_add_u32 s34, s34, 122880
 v_lshrrev_b32 v28, 3, v0
 v_and_b32 v29, 7, v0
 v_mul_u32_u24 v10, 384, v28
 v_lshl_add_u32 v10, v29, 4, v10
 v_bfe_u32 v26, v0, 1, 1
 v_mul_u32_u24 v26, 1088, v26
 v_lshrrev_b32 v27, 5, v0
 v_lshl_add_u32 v26, v27, 8, v26
 v_and_b32 v27, 1, v0
 v_lshl_add_u32 v26, v27, 7, v26
 v_bfe_u32 v27, v0, 2, 2
 v_lshl_add_u32 v26, v27, 4, v26
 v_bfe_u32 v27, v0, 4, 1
 v_lshl_add_u32 v26, v27, 3, v26
 v_add_u32 v12, s34, v26
 v_xor_b32 v7, 64, v12
 v_lshlrev_b32 v26, 5, v29
 v_lshrrev_b32 v27, 5, v0
 v_lshl_add_u32 v26, v27, 8, v26
 v_bfe_u32 v27, v0, 4, 1
 v_lshl_add_u32 v26, v27, 4, v26
 v_bfe_u32 v27, v0, 3, 1
 v_lshl_add_u32 v11, v27, 10, v26
 v_add_u32 v11, s34, v11
 v_mul_u32_u24 v27, 3072, v27
 v_add_u32 v1, v26, v27
 v_add_u32 v2, 73728, v1
 v_add_u32 v30, s45, v1
 v_lshrrev_b32 v27, 5, v0
 v_mul_u32_u24 v26, 3072, v27
 v_and_b32 v27, 31, v0
 v_lshl_add_u32 v26, v27, 3, v26
 v_add_u32 v3, 36864, v26
 v_add_u32 v13, 86016, v26
 v_lshl_add_u32 v14, v0, 4, s34
 v_xor_b32 v15, 64, v14
 v_add_u32 v15, 1024, v15
 v_mov_b32 v26, 0x3f803f80
 v_accvgpr_write_b32 a240, v26
 v_accvgpr_write_b32 a241, v26
 v_accvgpr_write_b32 a242, v26
 v_accvgpr_write_b32 a243, v26
 s_add_u32 m0, s45, 0
 s_nop 0
 buffer_load_dwordx4 v5, s[12:15], s50 offen offset:1024 nt lds
 s_add_u32 m0, s45, 3072
 s_nop 0
 buffer_load_dwordx4 v5, s[12:15], s51 offen offset:1024 nt lds
 s_add_u32 m0, s45, 6144
 s_nop 0
 buffer_load_dwordx4 v5, s[12:15], s52 offen offset:1024 nt lds
 s_add_u32 m0, s45, 9216
 s_nop 0
 buffer_load_dwordx4 v5, s[12:15], s53 offen offset:1024 nt lds
 s_add_u32 m0, s45, 12288
 s_nop 0
 buffer_load_dwordx4 v5, s[12:15], s54 offen offset:1024 nt lds
 s_add_u32 m0, s45, 15360
 s_nop 0
 buffer_load_dwordx4 v5, s[12:15], s55 offen offset:1024 nt lds
 s_add_u32 m0, s45, 18432
 s_nop 0
 buffer_load_dwordx4 v5, s[12:15], s56 offen offset:1024 nt lds
 s_add_u32 m0, s45, 21504
 s_nop 0
 buffer_load_dwordx4 v5, s[12:15], s57 offen offset:1024 nt lds
 s_waitcnt vmcnt(16)
 s_barrier
 ds_read_b128 a[96:99], v1 offset:0
 ds_read_b128 a[104:107], v1 offset:512
 ds_read_b128 a[112:115], v1 offset:1024
 ds_read_b128 a[120:123], v1 offset:1536
 ds_read_b128 a[128:131], v1 offset:2048
 ds_read_b128 a[136:139], v1 offset:2560
 ds_read_b128 a[132:135], v1 offset:8192
 ds_read_b128 a[140:143], v1 offset:8704
 ds_read_b128 a[116:119], v1 offset:7168
 ds_read_b128 a[124:127], v1 offset:7680
 ds_read_b128 a[100:103], v1 offset:6144
 ds_read_b128 a[108:111], v1 offset:6656
 s_waitcnt vmcnt(8)
 ds_read_b128 a[0:3], v30 offset:0
 ds_read_b128 a[16:19], v30 offset:512
 ds_read_b128 a[4:7], v30 offset:6144
 ds_read_b128 a[20:23], v30 offset:6656
 ds_read_b128 a[8:11], v30 offset:12288
 ds_read_b128 a[24:27], v30 offset:12800
 ds_read_b128 a[12:15], v30 offset:18432
 ds_read_b128 a[28:31], v30 offset:18944
 s_waitcnt lgkmcnt(7)
 v_mfma_f32_16x16x32_bf16 v[32:35], a[96:99], a[0:3], 0
 s_waitcnt lgkmcnt(4)
 v_mfma_f32_16x16x32_bf16 v[32:35], a[104:107], a[16:19], v[32:35]
 v_mfma_f32_16x16x32_bf16 v[36:39], a[100:103], a[0:3], 0
 v_mfma_f32_16x16x32_bf16 v[36:39], a[108:111], a[16:19], v[36:39]
 v_mfma_f32_16x16x32_bf16 v[44:47], a[100:103], a[4:7], 0
 v_mfma_f32_16x16x32_bf16 v[44:47], a[108:111], a[20:23], v[44:47]
 v_mfma_f32_16x16x32_bf16 v[40:43], a[96:99], a[4:7], 0
 v_mfma_f32_16x16x32_bf16 v[40:43], a[104:107], a[20:23], v[40:43]
 s_waitcnt lgkmcnt(0)
 v_mfma_f32_16x16x32_bf16 v[48:51], a[96:99], a[8:11], 0
 v_mfma_f32_16x16x32_bf16 v[48:51], a[104:107], a[24:27], v[48:51]
 v_mfma_f32_16x16x32_bf16 v[52:55], a[100:103], a[8:11], 0
 v_mfma_f32_16x16x32_bf16 v[52:55], a[108:111], a[24:27], v[52:55]
 v_mfma_f32_16x16x32_bf16 v[60:63], a[100:103], a[12:15], 0
 v_mfma_f32_16x16x32_bf16 v[60:63], a[108:111], a[28:31], v[60:63]
 v_mfma_f32_16x16x32_bf16 v[56:59], a[96:99], a[12:15], 0
 v_mfma_f32_16x16x32_bf16 v[56:59], a[104:107], a[28:31], v[56:59]
 s_add_u32 m0, s45, 0
 s_nop 0
 buffer_load_dwordx4 v6, s[12:15], s50 offen offset:2048 nt lds
 s_add_u32 m0, s45, 3072
 s_nop 0
 buffer_load_dwordx4 v6, s[12:15], s51 offen offset:2048 nt lds
 s_add_u32 m0, s45, 6144
 s_nop 0
 buffer_load_dwordx4 v6, s[12:15], s52 offen offset:2048 nt lds
 s_add_u32 m0, s45, 9216
 s_nop 0
 buffer_load_dwordx4 v6, s[12:15], s53 offen offset:2048 nt lds
 s_add_u32 m0, s45, 12288
 s_nop 0
 buffer_load_dwordx4 v6, s[12:15], s54 offen offset:2048 nt lds
 s_add_u32 m0, s45, 15360
 s_nop 0
 buffer_load_dwordx4 v6, s[12:15], s55 offen offset:2048 nt lds
 s_add_u32 m0, s45, 18432
 s_nop 0
 buffer_load_dwordx4 v6, s[12:15], s56 offen offset:2048 nt lds
 s_add_u32 m0, s45, 21504
 s_nop 0
 buffer_load_dwordx4 v6, s[12:15], s57 offen offset:2048 nt lds
 s_add_u32 s12, s12, 25165824
 s_addc_u32 s13, s13, 0
 s_add_u32 s20, s20, 12288
 s_add_u32 m0, s21, 12288
 s_nop 0
 buffer_load_dwordx4 v4, s[4:7], s20 offen nt lds
 buffer_load_dwordx4 v5, s[4:7], s20 offen offset:1024 nt lds
 buffer_load_dwordx4 v6, s[4:7], s20 offen offset:2048 nt lds
 s_waitcnt vmcnt(11)
 ds_read_b128 a[32:35], v30 offset:1024
 ds_read_b128 a[48:51], v30 offset:1536
 ds_read_b128 a[36:39], v30 offset:7168
 ds_read_b128 a[52:55], v30 offset:7680
 ds_read_b128 a[40:43], v30 offset:13312
 ds_read_b128 a[56:59], v30 offset:13824
 ds_read_b128 a[44:47], v30 offset:19456
 ds_read_b128 a[60:63], v30 offset:19968
 s_waitcnt lgkmcnt(7)
 v_mfma_f32_16x16x32_bf16 v[32:35], a[112:115], a[32:35], v[32:35]
 s_waitcnt lgkmcnt(4)
 v_mfma_f32_16x16x32_bf16 v[32:35], a[120:123], a[48:51], v[32:35]
 v_mfma_f32_16x16x32_bf16 v[36:39], a[116:119], a[32:35], v[36:39]
 v_mfma_f32_16x16x32_bf16 v[36:39], a[124:127], a[48:51], v[36:39]
 v_mfma_f32_16x16x32_bf16 v[44:47], a[116:119], a[36:39], v[44:47]
 v_mfma_f32_16x16x32_bf16 v[44:47], a[124:127], a[52:55], v[44:47]
 v_mfma_f32_16x16x32_bf16 v[40:43], a[112:115], a[36:39], v[40:43]
 v_mfma_f32_16x16x32_bf16 v[40:43], a[120:123], a[52:55], v[40:43]
 s_waitcnt lgkmcnt(0)
 v_mfma_f32_16x16x32_bf16 v[48:51], a[112:115], a[40:43], v[48:51]
 v_mfma_f32_16x16x32_bf16 v[48:51], a[120:123], a[56:59], v[48:51]
 v_mfma_f32_16x16x32_bf16 v[52:55], a[116:119], a[40:43], v[52:55]
 v_mfma_f32_16x16x32_bf16 v[52:55], a[124:127], a[56:59], v[52:55]
 v_mfma_f32_16x16x32_bf16 v[60:63], a[116:119], a[44:47], v[60:63]
 v_mfma_f32_16x16x32_bf16 v[60:63], a[124:127], a[60:63], v[60:63]
 v_mfma_f32_16x16x32_bf16 v[56:59], a[112:115], a[44:47], v[56:59]
 v_mfma_f32_16x16x32_bf16 v[56:59], a[120:123], a[60:63], v[56:59]
 s_mov_b32 s25, 1792
 s_add_u32 m0, s21, 36864
 s_nop 0
 buffer_load_dwordx4 v8, s[8:11], s25 offen nt lds
 s_sub_u32 s25, s25, 896
 buffer_load_dwordx4 v8, s[8:11], s25 offen offset:1024 nt lds
 s_sub_u32 s25, s25, 896
 buffer_load_dwordx4 v8, s[8:11], s25 offen offset:2048 nt lds
 s_add_u32 s20, s20, 12288
 s_add_u32 m0, s21, 24576
 s_add_u32 s25, s25, 14080
 buffer_load_dwordx4 v4, s[4:7], s20 offen lds
 buffer_load_dwordx4 v5, s[4:7], s20 offen offset:1024 lds
 buffer_load_dwordx4 v6, s[4:7], s20 offen offset:2048 lds
 s_waitcnt vmcnt(9)
 ds_read_b128 a[64:67], v30 offset:2048
 ds_read_b128 a[80:83], v30 offset:2560
 ds_read_b128 a[68:71], v30 offset:8192
 ds_read_b128 a[84:87], v30 offset:8704
 ds_read_b128 a[72:75], v30 offset:14336
 ds_read_b128 a[88:91], v30 offset:14848
 ds_read_b128 a[76:79], v30 offset:20480
 ds_read_b128 a[92:95], v30 offset:20992
 s_waitcnt lgkmcnt(7)
 v_mfma_f32_16x16x32_bf16 v[32:35], a[128:131], a[64:67], v[32:35]
 s_waitcnt lgkmcnt(4)
 s_add_u32 m0, s21, 49152
 v_mfma_f32_16x16x32_bf16 v[32:35], a[136:139], a[80:83], v[32:35]
 buffer_load_dwordx4 v8, s[8:11], s25 offen lds
 v_mfma_f32_16x16x32_bf16 v[36:39], a[132:135], a[64:67], v[36:39]
 s_sub_u32 s25, s25, 896
 v_mfma_f32_16x16x32_bf16 v[36:39], a[140:143], a[80:83], v[36:39]
 v_mfma_f32_16x16x32_bf16 v[44:47], a[132:135], a[68:71], v[44:47]
 s_waitcnt lgkmcnt(0)
 s_waitcnt vmcnt(7)
 s_barrier
 v_mfma_f32_16x16x32_bf16 v[44:47], a[140:143], a[84:87], v[44:47]
 ds_read_b128 a[224:227], v1 offset:12288
 ds_read_b128 a[228:231], v1 offset:12800
 v_mfma_f32_16x16x32_bf16 v[40:43], a[128:131], a[68:71], v[40:43]
 ds_read_b128 a[232:235], v1 offset:13312
 ds_read_b128 a[236:239], v1 offset:13824
 v_mfma_f32_16x16x32_bf16 v[40:43], a[136:139], a[84:87], v[40:43]
 buffer_load_dwordx4 v8, s[8:11], s25 offen offset:1024 lds
 v_mfma_f32_16x16x32_bf16 v[48:51], a[128:131], a[72:75], v[48:51]
 s_sub_u32 s25, s25, 896
 s_add_u32 s20, s20, 12288
 v_max3_f32 v20, v32, v33, v34
 v_mfma_f32_16x16x32_bf16 v[48:51], a[136:139], a[88:91], v[48:51]
 v_max3_f32 v20, v20, v35, v36
 v_max3_f32 v20, v20, v37, v38
 v_mfma_f32_16x16x32_bf16 v[52:55], a[132:135], a[72:75], v[52:55]
 v_max_f32 v20, v20, v39
 v_mov_b32 v26, v20
 v_mfma_f32_16x16x32_bf16 v[52:55], a[140:143], a[88:91], v[52:55]
 v_max3_f32 v21, v40, v41, v42
 v_max3_f32 v21, v21, v43, v44
 v_mfma_f32_16x16x32_bf16 v[60:63], a[132:135], a[76:79], v[60:63]
 v_max3_f32 v21, v21, v45, v46
 v_permlane16_swap_b32 v20, v26
 v_mfma_f32_16x16x32_bf16 v[60:63], a[140:143], a[92:95], v[60:63]
 buffer_load_dwordx4 v8, s[8:11], s25 offen offset:2048 lds
 s_add_u32 m0, s21, 122880
 v_mfma_f32_16x16x32_bf16 v[56:59], a[128:131], a[76:79], v[56:59]
 s_add_u32 s25, s25, 14080
 buffer_load_dwordx4 v4, s[4:7], s20 offen nt lds
 v_mfma_f32_16x16x32_bf16 v[56:59], a[136:139], a[92:95], v[56:59]
 s_waitcnt lgkmcnt(0)
 v_max_f32 v21, v21, v47
 v_max_f32 v20, v20, v26
 v_mfma_f32_16x16x32_bf16 v[88:91], a[224:227], a[12:15], 0
 v_mov_b32 v27, v21
 v_mov_b32 v26, v20
 v_mfma_f32_16x16x32_bf16 v[88:91], a[228:231], a[28:31], v[88:91]
 v_permlane16_swap_b32 v21, v27
 v_permlane32_swap_b32 v20, v26
 v_mfma_f32_16x16x32_bf16 v[80:83], a[224:227], a[8:11], 0
 buffer_load_dwordx4 v5, s[4:7], s20 offen offset:1024 nt lds
 v_mfma_f32_16x16x32_bf16 v[80:83], a[228:231], a[24:27], v[80:83]
 v_max_f32 v21, v21, v27
 v_max_f32 v20, v20, v26
 v_mfma_f32_16x16x32_bf16 v[72:75], a[224:227], a[4:7], 0
 v_mov_b32 v27, v21
 v_mul_f32 v16, s23, v20
 v_mfma_f32_16x16x32_bf16 v[72:75], a[228:231], a[20:23], v[72:75]
 v_fma_f32 v32, v32, s22, v16
 v_fma_f32 v33, v33, s22, v16
 v_mfma_f32_16x16x32_bf16 v[64:67], a[224:227], a[0:3], 0
 ds_read_b128 a[224:227], v1 offset:14336
 v_permlane32_swap_b32 v21, v27
 v_mfma_f32_16x16x32_bf16 v[64:67], a[228:231], a[16:19], v[64:67]
 ds_read_b128 a[228:231], v1 offset:14848
 v_fma_f32 v34, v34, s22, v16
 v_mfma_f32_16x16x32_bf16 v[64:67], a[232:235], a[32:35], v[64:67]
 buffer_load_dwordx4 v6, s[4:7], s20 offen offset:2048 nt lds
 v_mfma_f32_16x16x32_bf16 v[64:67], a[236:239], a[48:51], v[64:67]
 v_exp_f32 v32, v32
 v_mfma_f32_16x16x32_bf16 v[72:75], a[232:235], a[36:39], v[72:75]
 v_exp_f32 v33, v33
 v_mfma_f32_16x16x32_bf16 v[72:75], a[236:239], a[52:55], v[72:75]
 v_exp_f32 v34, v34
 v_mfma_f32_16x16x32_bf16 v[80:83], a[232:235], a[40:43], v[80:83]
 v_fma_f32 v35, v35, s22, v16
 v_max_f32 v21, v21, v27
 v_mfma_f32_16x16x32_bf16 v[80:83], a[236:239], a[56:59], v[80:83]
 v_exp_f32 v35, v35
 v_mfma_f32_16x16x32_bf16 v[88:91], a[232:235], a[44:47], v[88:91]
 ds_read_b128 a[232:235], v1 offset:20480
 v_fma_f32 v36, v36, s22, v16
 v_mfma_f32_16x16x32_bf16 v[88:91], a[236:239], a[60:63], v[88:91]
 s_waitcnt lgkmcnt(2)
 ds_read_b128 a[236:239], v1 offset:20992
 v_fma_f32 v37, v37, s22, v16
 v_mfma_f32_16x16x32_bf16 v[88:91], a[224:227], a[76:79], v[88:91]
 s_waitcnt lgkmcnt(2)
 v_exp_f32 v36, v36
 v_mfma_f32_16x16x32_bf16 v[88:91], a[228:231], a[92:95], v[88:91]
 v_exp_f32 v37, v37
 v_mfma_f32_16x16x32_bf16 v[80:83], a[224:227], a[72:75], v[80:83]
 v_fma_f32 v38, v38, s22, v16
 v_fma_f32 v39, v39, s22, v16
 v_mfma_f32_16x16x32_bf16 v[80:83], a[228:231], a[88:91], v[80:83]
 s_add_u32 m0, s21, 135168
 v_exp_f32 v38, v38
 v_mfma_f32_16x16x32_bf16 v[72:75], a[224:227], a[68:71], v[72:75]
 buffer_load_dwordx4 v8, s[8:11], s25 offen nt lds
 v_mfma_f32_16x16x32_bf16 v[72:75], a[228:231], a[84:87], v[72:75]
 s_sub_u32 s25, s25, 896
 v_exp_f32 v39, v39
 v_mfma_f32_16x16x32_bf16 v[64:67], a[224:227], a[64:67], v[64:67]
 ds_read_b128 a[224:227], v1 offset:19456
 v_mul_f32 v17, s23, v21
 v_mfma_f32_16x16x32_bf16 v[64:67], a[228:231], a[80:83], v[64:67]
 s_waitcnt lgkmcnt(2)
 ds_read_b128 a[228:231], v1 offset:19968
 v_fma_f32 v40, v40, s22, v17
 v_mfma_f32_16x16x32_bf16 v[68:71], a[232:235], a[64:67], 0
 s_waitcnt lgkmcnt(2)
 v_exp_f32 v40, v40
 v_mfma_f32_16x16x32_bf16 v[68:71], a[236:239], a[80:83], v[68:71]
 v_fma_f32 v41, v41, s22, v17
 v_cvt_pk_bf16_f32 v32, v32, v33
 v_mfma_f32_16x16x32_bf16 v[76:79], a[232:235], a[68:71], 0
 buffer_load_dwordx4 v8, s[8:11], s25 offen offset:1024 nt lds
 v_mfma_f32_16x16x32_bf16 v[76:79], a[236:239], a[84:87], v[76:79]
 s_sub_u32 s25, s25, 896
 v_exp_f32 v41, v41
 v_mfma_f32_16x16x32_bf16 v[84:87], a[232:235], a[72:75], 0
 s_add_u32 s20, s20, 12288
 v_fma_f32 v42, v42, s22, v17
 v_fma_f32 v43, v43, s22, v17
 v_mfma_f32_16x16x32_bf16 v[84:87], a[236:239], a[88:91], v[84:87]
 v_exp_f32 v42, v42
 v_mfma_f32_16x16x32_bf16 v[92:95], a[232:235], a[76:79], 0
 ds_read_b128 a[232:235], v1 offset:18432
 v_cvt_pk_bf16_f32 v33, v34, v35
 v_mfma_f32_16x16x32_bf16 v[92:95], a[236:239], a[92:95], v[92:95]
 s_waitcnt lgkmcnt(2)
 ds_read_b128 a[236:239], v1 offset:18944
 v_fma_f32 v44, v44, s22, v17
 v_mfma_f32_16x16x32_bf16 v[92:95], a[224:227], a[44:47], v[92:95]
 s_waitcnt lgkmcnt(2)
 buffer_load_dwordx4 v8, s[8:11], s25 offen offset:2048 nt lds
 v_mfma_f32_16x16x32_bf16 v[92:95], a[228:231], a[60:63], v[92:95]
 v_exp_f32 v43, v43
 v_mfma_f32_16x16x32_bf16 v[84:87], a[224:227], a[40:43], v[84:87]
 v_exp_f32 v44, v44
 v_mfma_f32_16x16x32_bf16 v[84:87], a[228:231], a[56:59], v[84:87]
 v_fma_f32 v45, v45, s22, v17
 v_fma_f32 v46, v46, s22, v17
 v_mfma_f32_16x16x32_bf16 v[76:79], a[224:227], a[36:39], v[76:79]
 s_waitcnt vmcnt(12)
 s_barrier
 v_fma_f32 v47, v47, s22, v17
 v_mfma_f32_16x16x32_bf16 v[76:79], a[228:231], a[52:55], v[76:79]
 v_exp_f32 v45, v45
 v_mfma_f32_16x16x32_bf16 v[68:71], a[224:227], a[32:35], v[68:71]
 ds_read_b64_tr_b16 a[224:225], v3 offset:0
 v_cvt_pk_bf16_f32 v34, v36, v37
 v_mfma_f32_16x16x32_bf16 v[68:71], a[228:231], a[48:51], v[68:71]
 s_waitcnt lgkmcnt(2)
 ds_read_b64_tr_b16 a[226:227], v3 offset:6144
 v_cvt_pk_bf16_f32 v35, v38, v39
 v_mfma_f32_16x16x32_bf16 v[68:71], a[232:235], a[0:3], v[68:71]
 s_waitcnt lgkmcnt(2)
 ds_read_b64_tr_b16 a[228:229], v3 offset:256
 v_cvt_pk_bf16_f32 v40, v40, v41
 v_mfma_f32_16x16x32_bf16 v[68:71], a[236:239], a[16:19], v[68:71]
 ds_read_b64_tr_b16 a[230:231], v3 offset:6400
 v_max3_f32 v20, v48, v49, v50
 v_mfma_f32_16x16x32_bf16 v[76:79], a[232:235], a[4:7], v[76:79]
 v_exp_f32 v46, v46
 v_mfma_f32_16x16x32_bf16 v[76:79], a[236:239], a[20:23], v[76:79]
 s_add_u32 m0, s21, 73728
 v_exp_f32 v47, v47
 v_mfma_f32_16x16x32_bf16 v[84:87], a[232:235], a[8:11], v[84:87]
 s_add_u32 s25, s25, 14080
 buffer_load_dwordx4 v4, s[4:7], s20 offen lds
 v_mfma_f32_16x16x32_bf16 v[84:87], a[236:239], a[24:27], v[84:87]
 v_cvt_pk_bf16_f32 v41, v42, v43
 v_max3_f32 v20, v20, v51, v52
 v_mfma_f32_16x16x32_bf16 v[92:95], a[232:235], a[12:15], v[92:95]
 ds_read_b64_tr_b16 a[232:233], v3 offset:512
 v_cvt_pk_bf16_f32 v42, v44, v45
 v_mfma_f32_16x16x32_bf16 v[92:95], a[236:239], a[28:31], v[92:95]
 ds_read_b64_tr_b16 a[234:235], v3 offset:6656
 v_cvt_pk_bf16_f32 v43, v46, v47
 v_mfma_f32_16x16x32_bf16 v[28:31], a[240:243], v[32:35], 0
 v_max3_f32 v20, v20, v53, v54
 v_max_f32 v20, v20, v55
 v_mov_b32 v26, v20
 v_max3_f32 v21, v56, v57, v58
 v_max3_f32 v21, v21, v59, v60
 v_mfma_f32_16x16x32_bf16 a[244:247], a[240:243], v[40:43], 0
 s_waitcnt lgkmcnt(2)
 v_max3_f32 v21, v21, v61, v62
 v_permlane16_swap_b32 v20, v26
 v_max_f32 v21, v21, v63
 v_max_f32 v20, v20, v26
 v_mov_b32 v27, v21
 v_mov_b32 v26, v20
 v_mfma_f32_16x16x32_bf16 v[96:99], v[32:35], a[224:227], 0
 buffer_load_dwordx4 v5, s[4:7], s20 offen offset:1024 lds
 v_permlane16_swap_b32 v21, v27
 v_permlane32_swap_b32 v20, v26
 v_max_f32 v21, v21, v27
 v_max_f32 v20, v20, v26
 v_mov_b32 v27, v21
 v_mfma_f32_16x16x32_bf16 v[104:107], v[40:43], a[224:227], 0
 v_mul_f32 v18, s23, v20
 v_fma_f32 v48, v48, s22, v18
 v_fma_f32 v49, v49, s22, v18
 v_permlane32_swap_b32 v21, v27
 v_fma_f32 v50, v50, s22, v18
 v_fma_f32 v51, v51, s22, v18
 v_exp_f32 v48, v48
 v_exp_f32 v49, v49
 v_max_f32 v21, v21, v27
 v_fma_f32 v52, v52, s22, v18
 v_fma_f32 v53, v53, s22, v18
 v_fma_f32 v54, v54, s22, v18
 v_fma_f32 v55, v55, s22, v18
 v_exp_f32 v50, v50
 v_exp_f32 v51, v51
 v_mfma_f32_16x16x32_bf16 v[100:103], v[32:35], a[228:231], 0
 ds_read_b64_tr_b16 a[236:237], v3 offset:768
 ds_read_b64_tr_b16 a[238:239], v3 offset:6912
 v_mul_f32 v19, s23, v21
 v_exp_f32 v52, v52
 v_exp_f32 v53, v53
 v_exp_f32 v54, v54
 v_exp_f32 v55, v55
 v_fma_f32 v56, v56, s22, v19
 v_fma_f32 v57, v57, s22, v19
 v_cvt_pk_bf16_f32 v48, v48, v49
 v_fma_f32 v58, v58, s22, v19
 v_fma_f32 v59, v59, s22, v19
 v_cvt_pk_bf16_f32 v49, v50, v51
 v_exp_f32 v56, v56
 v_exp_f32 v57, v57
 v_fma_f32 v60, v60, s22, v19
 v_fma_f32 v61, v61, s22, v19
 v_fma_f32 v62, v62, s22, v19
 v_fma_f32 v63, v63, s22, v19
 v_cvt_pk_bf16_f32 v50, v52, v53
 v_cvt_pk_bf16_f32 v51, v54, v55
 v_exp_f32 v58, v58
 v_exp_f32 v59, v59
 v_mfma_f32_16x16x32_bf16 v[108:111], v[40:43], a[228:231], 0
 v_exp_f32 v60, v60
 v_exp_f32 v61, v61
 v_exp_f32 v62, v62
 v_exp_f32 v63, v63
 v_cvt_pk_bf16_f32 v56, v56, v57
 v_cvt_pk_bf16_f32 v57, v58, v59
 v_cvt_pk_bf16_f32 v58, v60, v61
 v_cvt_pk_bf16_f32 v59, v62, v63
 v_mfma_f32_16x16x32_bf16 a[192:195], v[48:51], a[224:227], 0
 v_fma_f32 v64, v64, s22, v16
 v_fma_f32 v65, v65, s22, v16
 v_mfma_f32_16x16x32_bf16 a[200:203], v[56:59], a[224:227], 0
 ds_read_b64_tr_b16 a[224:225], v3 offset:1024
 v_fma_f32 v66, v66, s22, v16
 v_mfma_f32_16x16x32_bf16 a[196:199], v[48:51], a[228:231], 0
 buffer_load_dwordx4 v6, s[4:7], s20 offen offset:2048 lds
 v_mfma_f32_16x16x32_bf16 a[204:207], v[56:59], a[228:231], 0
 ds_read_b64_tr_b16 a[226:227], v3 offset:7168
 v_fma_f32 v67, v67, s22, v16
 v_mfma_f32_16x16x32_bf16 a[248:251], a[240:243], v[48:51], 0
 ds_read_b64_tr_b16 a[228:229], v3 offset:1280
 v_fma_f32 v68, v68, s22, v16
 v_mfma_f32_16x16x32_bf16 a[252:255], a[240:243], v[56:59], 0
 s_waitcnt lgkmcnt(3)
 ds_read_b64_tr_b16 a[230:231], v3 offset:7424
 v_fma_f32 v69, v69, s22, v16
 v_mfma_f32_16x16x32_bf16 a[208:211], v[48:51], a[232:235], 0
 v_exp_f32 v64, v64
 v_mfma_f32_16x16x32_bf16 a[216:219], v[56:59], a[232:235], 0
 v_exp_f32 v65, v65
 v_mfma_f32_16x16x32_bf16 a[212:215], v[48:51], a[236:239], 0
 v_exp_f32 v66, v66
 v_mfma_f32_16x16x32_bf16 a[220:223], v[56:59], a[236:239], 0
 v_exp_f32 v67, v67
 v_mfma_f32_16x16x32_bf16 v[112:115], v[32:35], a[232:235], 0
 s_waitcnt vmcnt(9)
 s_barrier
 v_fma_f32 v70, v70, s22, v16
 v_mfma_f32_16x16x32_bf16 v[120:123], v[40:43], a[232:235], 0
 ds_read_b64_tr_b16 a[232:233], v3 offset:1536
 v_fma_f32 v71, v71, s22, v16
 v_mfma_f32_16x16x32_bf16 v[116:119], v[32:35], a[236:239], 0
 ds_read_b64_tr_b16 a[234:235], v3 offset:7680
 v_fma_f32 v72, v72, s22, v17
 v_mfma_f32_16x16x32_bf16 v[124:127], v[40:43], a[236:239], 0
 s_waitcnt lgkmcnt(3)
 ds_read_b64_tr_b16 a[236:237], v3 offset:1792
 s_add_u32 m0, s21, 86016
 v_mfma_f32_16x16x32_bf16 v[128:131], v[32:35], a[224:227], 0
 buffer_load_dwordx4 v8, s[8:11], s25 offen lds
 ds_read_b64_tr_b16 a[238:239], v3 offset:7936
 v_mfma_f32_16x16x32_bf16 v[136:139], v[40:43], a[224:227], 0
 s_waitcnt lgkmcnt(4)
 s_sub_u32 s25, s25, 896
 v_fma_f32 v73, v73, s22, v17
 v_mfma_f32_16x16x32_bf16 v[132:135], v[32:35], a[228:231], 0
 v_exp_f32 v68, v68
 v_mfma_f32_16x16x32_bf16 v[140:143], v[40:43], a[228:231], 0
 v_exp_f32 v69, v69
 v_mfma_f32_16x16x32_bf16 v[144:147], v[48:51], a[224:227], 0
 v_exp_f32 v70, v70
 v_mfma_f32_16x16x32_bf16 v[152:155], v[56:59], a[224:227], 0
 ds_read_b64_tr_b16 a[224:225], v3 offset:2048
 v_cvt_pk_bf16_f32 v64, v64, v65
 v_mfma_f32_16x16x32_bf16 v[148:151], v[48:51], a[228:231], 0
 buffer_load_dwordx4 v8, s[8:11], s25 offen offset:1024 lds
 ds_read_b64_tr_b16 a[226:227], v3 offset:8192
 v_mfma_f32_16x16x32_bf16 v[156:159], v[56:59], a[228:231], 0
 s_waitcnt lgkmcnt(3)
 ds_read_b64_tr_b16 a[228:229], v3 offset:2304
 s_sub_u32 s25, s25, 896
 v_mfma_f32_16x16x32_bf16 v[176:179], v[48:51], a[232:235], 0
 s_add_u32 s20, s20, 12288
 ds_read_b64_tr_b16 a[230:231], v3 offset:8448
 v_fma_f32 v74, v74, s22, v17
 v_mfma_f32_16x16x32_bf16 v[184:187], v[56:59], a[232:235], 0
 s_waitcnt lgkmcnt(4)
 v_exp_f32 v71, v71
 v_mfma_f32_16x16x32_bf16 v[180:183], v[48:51], a[236:239], 0
 v_exp_f32 v72, v72
 v_mfma_f32_16x16x32_bf16 v[188:191], v[56:59], a[236:239], 0
 v_exp_f32 v73, v73
 v_mfma_f32_16x16x32_bf16 v[160:163], v[32:35], a[232:235], 0
 buffer_load_dwordx4 v8, s[8:11], s25 offen offset:2048 lds
 v_mfma_f32_16x16x32_bf16 v[168:171], v[40:43], a[232:235], 0
 ds_read_b64_tr_b16 a[232:233], v3 offset:2560
 v_fma_f32 v75, v75, s22, v17
 v_mfma_f32_16x16x32_bf16 v[164:167], v[32:35], a[236:239], 0
 ds_read_b64_tr_b16 a[234:235], v3 offset:8704
 v_cvt_pk_bf16_f32 v65, v66, v67
 v_mfma_f32_16x16x32_bf16 v[172:175], v[40:43], a[236:239], 0
 s_waitcnt lgkmcnt(4)
 ds_read_b64_tr_b16 a[236:237], v3 offset:2816
 v_fma_f32 v76, v76, s22, v17
 v_mfma_f32_16x16x32_bf16 v[192:195], v[32:35], a[224:227], 0
 ds_read_b64_tr_b16 a[238:239], v3 offset:8960
 v_fma_f32 v77, v77, s22, v17
 v_mfma_f32_16x16x32_bf16 v[200:203], v[40:43], a[224:227], 0
 s_waitcnt lgkmcnt(4)
 v_exp_f32 v74, v74
 v_mfma_f32_16x16x32_bf16 v[196:199], v[32:35], a[228:231], 0
 v_exp_f32 v75, v75
 v_mfma_f32_16x16x32_bf16 v[204:207], v[40:43], a[228:231], 0
 v_exp_f32 v76, v76
 v_mfma_f32_16x16x32_bf16 v[208:211], v[48:51], a[224:227], 0
 v_exp_f32 v77, v77
 v_mfma_f32_16x16x32_bf16 v[216:219], v[56:59], a[224:227], 0
 ds_read_b128 a[224:227], v1 offset:24576
 v_fma_f32 v78, v78, s22, v17
 v_mfma_f32_16x16x32_bf16 v[212:215], v[48:51], a[228:231], 0
 v_exp_f32 v78, v78
 v_mfma_f32_16x16x32_bf16 v[220:223], v[56:59], a[228:231], 0
 s_waitcnt lgkmcnt(3)
 ds_read_b128 a[228:231], v1 offset:25088
 s_add_u32 m0, s21, 98304
 v_mfma_f32_16x16x32_bf16 v[240:243], v[48:51], a[232:235], 0
 s_add_u32 s25, s25, 14080
 buffer_load_dwordx4 v4, s[4:7], s20 offen nt lds
 v_mfma_f32_16x16x32_bf16 v[248:251], v[56:59], a[232:235], 0
 s_waitcnt lgkmcnt(2)
 v_fma_f32 v79, v79, s22, v17
 v_cvt_pk_bf16_f32 v66, v68, v69
 v_mfma_f32_16x16x32_bf16 v[244:247], v[48:51], a[236:239], 0
 v_exp_f32 v79, v79
 v_mfma_f32_16x16x32_bf16 v[252:255], v[56:59], a[236:239], 0
 v_cvt_pk_bf16_f32 v67, v70, v71
 v_cvt_pk_bf16_f32 v72, v72, v73
 v_mfma_f32_16x16x32_bf16 v[224:227], v[32:35], a[232:235], 0
 v_cvt_pk_bf16_f32 v73, v74, v75
 v_cvt_pk_bf16_f32 v74, v76, v77
 v_mfma_f32_16x16x32_bf16 v[232:235], v[40:43], a[232:235], 0
 ds_read_b128 a[232:235], v1 offset:25600
 v_cvt_pk_bf16_f32 v75, v78, v79
 v_mfma_f32_16x16x32_bf16 v[228:231], v[32:35], a[236:239], 0
 buffer_load_dwordx4 v5, s[4:7], s20 offen offset:1024 nt lds
 v_mfma_f32_16x16x32_bf16 v[236:239], v[40:43], a[236:239], 0
 s_waitcnt lgkmcnt(2)
 ds_read_b128 a[236:239], v1 offset:26112
 v_fma_f32 v80, v80, s22, v18
 v_mfma_f32_16x16x32_bf16 v[56:59], a[224:227], a[12:15], 0
 s_waitcnt lgkmcnt(2)
 v_exp_f32 v80, v80
 v_mfma_f32_16x16x32_bf16 v[56:59], a[228:231], a[28:31], v[56:59]
 v_fma_f32 v81, v81, s22, v18
 v_fma_f32 v82, v82, s22, v18
 v_mfma_f32_16x16x32_bf16 v[48:51], a[224:227], a[8:11], 0
 v_exp_f32 v81, v81
 v_mfma_f32_16x16x32_bf16 v[48:51], a[228:231], a[24:27], v[48:51]
 v_exp_f32 v82, v82
 v_mfma_f32_16x16x32_bf16 v[40:43], a[224:227], a[4:7], 0
 buffer_load_dwordx4 v6, s[4:7], s20 offen offset:2048 nt lds
 v_mfma_f32_16x16x32_bf16 v[40:43], a[228:231], a[20:23], v[40:43]
 v_fma_f32 v83, v83, s22, v18
 v_fma_f32 v84, v84, s22, v18
 v_mfma_f32_16x16x32_bf16 v[32:35], a[224:227], a[0:3], 0
 ds_read_b128 a[224:227], v1 offset:26624
 v_fma_f32 v85, v85, s22, v18
 v_mfma_f32_16x16x32_bf16 v[32:35], a[228:231], a[16:19], v[32:35]
 s_waitcnt lgkmcnt(2)
 ds_read_b128 a[228:231], v1 offset:27136
 v_fma_f32 v86, v86, s22, v18
 v_mfma_f32_16x16x32_bf16 v[32:35], a[232:235], a[32:35], v[32:35]
 s_waitcnt lgkmcnt(2)
 v_exp_f32 v83, v83
 v_mfma_f32_16x16x32_bf16 v[32:35], a[236:239], a[48:51], v[32:35]
 v_exp_f32 v84, v84
 v_mfma_f32_16x16x32_bf16 v[40:43], a[232:235], a[36:39], v[40:43]
 v_exp_f32 v85, v85
 v_mfma_f32_16x16x32_bf16 v[40:43], a[236:239], a[52:55], v[40:43]
 v_exp_f32 v86, v86
 v_mfma_f32_16x16x32_bf16 v[48:51], a[232:235], a[40:43], v[48:51]
 v_fma_f32 v87, v87, s22, v18
 v_fma_f32 v88, v88, s22, v19
 v_mfma_f32_16x16x32_bf16 v[48:51], a[236:239], a[56:59], v[48:51]
 v_exp_f32 v87, v87
 v_mfma_f32_16x16x32_bf16 v[56:59], a[232:235], a[44:47], v[56:59]
 ds_read_b128 a[232:235], v1 offset:32768
 v_fma_f32 v89, v89, s22, v19
 v_mfma_f32_16x16x32_bf16 v[56:59], a[236:239], a[60:63], v[56:59]
 s_waitcnt lgkmcnt(2)
 ds_read_b128 a[236:239], v1 offset:33280
 s_add_u32 m0, s21, 110592
 v_mfma_f32_16x16x32_bf16 v[56:59], a[224:227], a[76:79], v[56:59]
 s_waitcnt lgkmcnt(2)
 buffer_load_dwordx4 v8, s[8:11], s25 offen nt lds
 v_mfma_f32_16x16x32_bf16 v[56:59], a[228:231], a[92:95], v[56:59]
 s_sub_u32 s25, s25, 896
 v_exp_f32 v88, v88
 v_mfma_f32_16x16x32_bf16 v[48:51], a[224:227], a[72:75], v[48:51]
 v_exp_f32 v89, v89
 v_mfma_f32_16x16x32_bf16 v[48:51], a[228:231], a[88:91], v[48:51]
 v_cvt_pk_bf16_f32 v80, v80, v81
 v_fma_f32 v90, v90, s22, v19
 v_mfma_f32_16x16x32_bf16 v[40:43], a[224:227], a[68:71], v[40:43]
 v_exp_f32 v90, v90
 v_mfma_f32_16x16x32_bf16 v[40:43], a[228:231], a[84:87], v[40:43]
 v_fma_f32 v91, v91, s22, v19
 v_cvt_pk_bf16_f32 v81, v82, v83
 v_mfma_f32_16x16x32_bf16 v[32:35], a[224:227], a[64:67], v[32:35]
 buffer_load_dwordx4 v8, s[8:11], s25 offen offset:1024 nt lds
 ds_read_b128 a[224:227], v1 offset:31744
 v_mfma_f32_16x16x32_bf16 v[32:35], a[228:231], a[80:83], v[32:35]
 s_waitcnt lgkmcnt(2)
 ds_read_b128 a[228:231], v1 offset:32256
 v_fma_f32 v92, v92, s22, v19
 v_mfma_f32_16x16x32_bf16 v[36:39], a[232:235], a[64:67], 0
 s_waitcnt lgkmcnt(2)
 v_exp_f32 v91, v91
 v_mfma_f32_16x16x32_bf16 v[36:39], a[236:239], a[80:83], v[36:39]
 s_sub_u32 s25, s25, 896
 v_exp_f32 v92, v92
 v_mfma_f32_16x16x32_bf16 v[44:47], a[232:235], a[68:71], 0
 s_add_u32 s20, s20, 12288
 v_fma_f32 v93, v93, s22, v19
 v_fma_f32 v94, v94, s22, v19
 v_mfma_f32_16x16x32_bf16 v[44:47], a[236:239], a[84:87], v[44:47]
 v_exp_f32 v93, v93
 v_mfma_f32_16x16x32_bf16 v[52:55], a[232:235], a[72:75], 0
 buffer_load_dwordx4 v8, s[8:11], s25 offen offset:2048 nt lds
 v_mfma_f32_16x16x32_bf16 v[52:55], a[236:239], a[88:91], v[52:55]
 v_exp_f32 v94, v94
 v_mfma_f32_16x16x32_bf16 v[60:63], a[232:235], a[76:79], 0
 ds_read_b128 a[232:235], v1 offset:30720
 v_fma_f32 v95, v95, s22, v19
 v_mfma_f32_16x16x32_bf16 v[60:63], a[236:239], a[92:95], v[60:63]
 s_waitcnt lgkmcnt(2)
 ds_read_b128 a[236:239], v1 offset:31232
 v_cvt_pk_bf16_f32 v82, v84, v85
 v_mfma_f32_16x16x32_bf16 v[60:63], a[224:227], a[44:47], v[60:63]
 s_waitcnt lgkmcnt(2)
 v_exp_f32 v95, v95
 v_mfma_f32_16x16x32_bf16 v[60:63], a[228:231], a[60:63], v[60:63]
 v_cvt_pk_bf16_f32 v83, v86, v87
 v_cvt_pk_bf16_f32 v88, v88, v89
 v_mfma_f32_16x16x32_bf16 v[52:55], a[224:227], a[40:43], v[52:55]
 v_cvt_pk_bf16_f32 v89, v90, v91
 v_cvt_pk_bf16_f32 v90, v92, v93
 v_mfma_f32_16x16x32_bf16 v[52:55], a[228:231], a[56:59], v[52:55]
 v_cvt_pk_bf16_f32 v91, v94, v95
 v_fma_f32 v32, v32, s22, v16
 v_mfma_f32_16x16x32_bf16 v[44:47], a[224:227], a[36:39], v[44:47]
 v_exp_f32 v32, v32
 v_mfma_f32_16x16x32_bf16 v[44:47], a[228:231], a[52:55], v[44:47]
 v_fma_f32 v33, v33, s22, v16
 v_fma_f32 v34, v34, s22, v16
 v_mfma_f32_16x16x32_bf16 v[36:39], a[224:227], a[32:35], v[36:39]
 ds_read_b64_tr_b16 a[224:225], v3 offset:12288
 v_fma_f32 v35, v35, s22, v16
 v_mfma_f32_16x16x32_bf16 v[36:39], a[228:231], a[48:51], v[36:39]
 s_waitcnt lgkmcnt(2)
 ds_read_b64_tr_b16 a[226:227], v3 offset:18432
 s_add_u32 m0, s21, 0
 v_mfma_f32_16x16x32_bf16 v[36:39], a[232:235], a[0:3], v[36:39]
 s_waitcnt lgkmcnt(2)
 buffer_load_dwordx4 v4, s[4:7], s20 offen lds
 v_mfma_f32_16x16x32_bf16 v[36:39], a[236:239], a[16:19], v[36:39]
 ds_read_b64_tr_b16 a[228:229], v3 offset:12544
 v_fma_f32 v40, v40, s22, v17
 v_mfma_f32_16x16x32_bf16 v[44:47], a[232:235], a[4:7], v[44:47]
 ds_read_b64_tr_b16 a[230:231], v3 offset:18688
 v_fma_f32 v41, v41, s22, v17
 v_mfma_f32_16x16x32_bf16 v[44:47], a[236:239], a[20:23], v[44:47]
 v_exp_f32 v33, v33
 v_mfma_f32_16x16x32_bf16 v[52:55], a[232:235], a[8:11], v[52:55]
 v_exp_f32 v34, v34
 v_mfma_f32_16x16x32_bf16 v[52:55], a[236:239], a[24:27], v[52:55]
 v_exp_f32 v35, v35
 v_mfma_f32_16x16x32_bf16 v[60:63], a[232:235], a[12:15], v[60:63]
 buffer_load_dwordx4 v5, s[4:7], s20 offen offset:1024 lds
 v_mfma_f32_16x16x32_bf16 v[60:63], a[236:239], a[28:31], v[60:63]
 ds_read_b64_tr_b16 a[232:233], v3 offset:12800
 v_fma_f32 v36, v36, s22, v16
 v_mfma_f32_16x16x32_bf16 v[28:31], a[240:243], v[64:67], v[28:31]
 ds_read_b64_tr_b16 a[234:235], v3 offset:18944
 v_fma_f32 v37, v37, s22, v16
 v_mfma_f32_16x16x32_bf16 a[244:247], a[240:243], v[72:75], a[244:247]
 s_waitcnt lgkmcnt(4)
 ds_read_b64_tr_b16 a[236:237], v3 offset:13056
 v_fma_f32 v38, v38, s22, v16
 v_mfma_f32_16x16x32_bf16 v[96:99], v[64:67], a[224:227], v[96:99]
 ds_read_b64_tr_b16 a[238:239], v3 offset:19200
 v_fma_f32 v39, v39, s22, v16
 v_mfma_f32_16x16x32_bf16 v[104:107], v[72:75], a[224:227], v[104:107]
 s_waitcnt lgkmcnt(4)
 v_exp_f32 v36, v36
 v_mfma_f32_16x16x32_bf16 v[100:103], v[64:67], a[228:231], v[100:103]
 buffer_load_dwordx4 v6, s[4:7], s20 offen offset:2048 lds
 v_mfma_f32_16x16x32_bf16 v[108:111], v[72:75], a[228:231], v[108:111]
 s_add_u32 m0, s34, 24576
 v_exp_f32 v37, v37
 v_mfma_f32_16x16x32_bf16 a[192:195], v[80:83], a[224:227], a[192:195]
 buffer_load_dwordx4 v4, s[12:15], s54 offen nt lds
 v_mfma_f32_16x16x32_bf16 a[200:203], v[88:91], a[224:227], a[200:203]
 s_add_u32 m0, s34, 25600
 ds_read_b64_tr_b16 a[224:225], v3 offset:13312
 s_add_u32 s25, s25, 14080
 v_mfma_f32_16x16x32_bf16 a[196:199], v[80:83], a[228:231], a[196:199]
 buffer_load_dwordx4 v4, s[12:15], s55 offen nt lds
 v_mfma_f32_16x16x32_bf16 a[204:207], v[88:91], a[228:231], a[204:207]
 ds_read_b64_tr_b16 a[226:227], v3 offset:19456
 v_cvt_pk_bf16_f32 v32, v32, v33
 v_mfma_f32_16x16x32_bf16 a[248:251], a[240:243], v[80:83], a[248:251]
 ds_read_b64_tr_b16 a[228:229], v3 offset:13568
 v_fma_f32 v42, v42, s22, v17
 v_mfma_f32_16x16x32_bf16 a[252:255], a[240:243], v[88:91], a[252:255]
 s_waitcnt lgkmcnt(3)
 ds_read_b64_tr_b16 a[230:231], v3 offset:19712
 v_fma_f32 v43, v43, s22, v17
 v_mfma_f32_16x16x32_bf16 a[208:211], v[80:83], a[232:235], a[208:211]
 s_waitcnt vmcnt(17)
 s_barrier
 v_cvt_pk_bf16_f32 v33, v34, v35
 v_mfma_f32_16x16x32_bf16 a[216:219], v[88:91], a[232:235], a[216:219]
 v_exp_f32 v38, v38
 v_mfma_f32_16x16x32_bf16 a[212:215], v[80:83], a[236:239], a[212:215]
 v_exp_f32 v39, v39
 v_mfma_f32_16x16x32_bf16 a[220:223], v[88:91], a[236:239], a[220:223]
 s_add_u32 m0, s21, 61440
 v_exp_f32 v40, v40
 v_mfma_f32_16x16x32_bf16 v[112:115], v[64:67], a[232:235], v[112:115]
 buffer_load_dwordx4 v8, s[8:11], s25 offen lds
 v_mfma_f32_16x16x32_bf16 v[120:123], v[72:75], a[232:235], v[120:123]
 s_sub_u32 s25, s25, 896
 ds_read_b64_tr_b16 a[232:233], v3 offset:13824
 v_fma_f32 v44, v44, s22, v17
 v_mfma_f32_16x16x32_bf16 v[116:119], v[64:67], a[236:239], v[116:119]
 ds_read_b64_tr_b16 a[234:235], v3 offset:19968
 v_fma_f32 v45, v45, s22, v17
 v_mfma_f32_16x16x32_bf16 v[124:127], v[72:75], a[236:239], v[124:127]
 s_waitcnt lgkmcnt(3)
 ds_read_b64_tr_b16 a[236:237], v3 offset:14080
 v_fma_f32 v46, v46, s22, v17
 v_mfma_f32_16x16x32_bf16 v[128:131], v[64:67], a[224:227], v[128:131]
 ds_read_b64_tr_b16 a[238:239], v3 offset:20224
 v_fma_f32 v47, v47, s22, v17
 v_mfma_f32_16x16x32_bf16 v[136:139], v[72:75], a[224:227], v[136:139]
 s_waitcnt lgkmcnt(4)
 v_exp_f32 v41, v41
 v_mfma_f32_16x16x32_bf16 v[132:135], v[64:67], a[228:231], v[132:135]
 buffer_load_dwordx4 v8, s[8:11], s25 offen offset:1024 lds
 v_mfma_f32_16x16x32_bf16 v[140:143], v[72:75], a[228:231], v[140:143]
 s_sub_u32 s25, s25, 896
 s_add_u32 s20, s20, 12288
 v_cvt_pk_bf16_f32 v34, v36, v37
 v_mfma_f32_16x16x32_bf16 v[144:147], v[80:83], a[224:227], v[144:147]
 v_exp_f32 v42, v42
 v_mfma_f32_16x16x32_bf16 v[152:155], v[88:91], a[224:227], v[152:155]
 ds_read_b64_tr_b16 a[224:225], v3 offset:14336
 v_cvt_pk_bf16_f32 v35, v38, v39
 v_mfma_f32_16x16x32_bf16 v[148:151], v[80:83], a[228:231], v[148:151]
 ds_read_b64_tr_b16 a[226:227], v3 offset:20480
 v_cvt_pk_bf16_f32 v40, v40, v41
 v_mfma_f32_16x16x32_bf16 v[156:159], v[88:91], a[228:231], v[156:159]
 s_waitcnt lgkmcnt(4)
 ds_read_b64_tr_b16 a[228:229], v3 offset:14592
 v_fma_f32 v48, v48, s22, v18
 v_mfma_f32_16x16x32_bf16 v[176:179], v[80:83], a[232:235], v[176:179]
 buffer_load_dwordx4 v8, s[8:11], s25 offen offset:2048 lds
 ds_read_b64_tr_b16 a[230:231], v3 offset:20736
 v_mfma_f32_16x16x32_bf16 v[184:187], v[88:91], a[232:235], v[184:187]
 s_waitcnt lgkmcnt(4)
 v_exp_f32 v43, v43
 v_mfma_f32_16x16x32_bf16 v[180:183], v[80:83], a[236:239], v[180:183]
 v_exp_f32 v44, v44
 v_mfma_f32_16x16x32_bf16 v[188:191], v[88:91], a[236:239], v[188:191]
 v_exp_f32 v45, v45
 v_mfma_f32_16x16x32_bf16 v[160:163], v[64:67], a[232:235], v[160:163]
 v_exp_f32 v46, v46
 v_mfma_f32_16x16x32_bf16 v[168:171], v[72:75], a[232:235], v[168:171]
 ds_read_b64_tr_b16 a[232:233], v3 offset:14848
 v_cvt_pk_bf16_f32 v41, v42, v43
 v_mfma_f32_16x16x32_bf16 v[164:167], v[64:67], a[236:239], v[164:167]
 ds_read_b64_tr_b16 a[234:235], v3 offset:20992
 v_cvt_pk_bf16_f32 v42, v44, v45
 v_mfma_f32_16x16x32_bf16 v[172:175], v[72:75], a[236:239], v[172:175]
 s_waitcnt lgkmcnt(4)
 ds_read_b64_tr_b16 a[236:237], v3 offset:15104
 v_fma_f32 v49, v49, s22, v18
 v_mfma_f32_16x16x32_bf16 v[192:195], v[64:67], a[224:227], v[192:195]
 ds_read_b64_tr_b16 a[238:239], v3 offset:21248
 v_fma_f32 v50, v50, s22, v18
 v_mfma_f32_16x16x32_bf16 v[200:203], v[72:75], a[224:227], v[200:203]
 s_waitcnt lgkmcnt(4)
 v_exp_f32 v47, v47
 v_mfma_f32_16x16x32_bf16 v[196:199], v[64:67], a[228:231], v[196:199]
 v_exp_f32 v48, v48
 v_mfma_f32_16x16x32_bf16 v[204:207], v[72:75], a[228:231], v[204:207]
 s_add_u32 m0, s21, 12288
 v_exp_f32 v49, v49
 v_mfma_f32_16x16x32_bf16 v[208:211], v[80:83], a[224:227], v[208:211]
 buffer_load_dwordx4 v4, s[4:7], s20 offen nt lds
 v_mfma_f32_16x16x32_bf16 v[216:219], v[88:91], a[224:227], v[216:219]
 ds_read_b128 a[224:227], v2 offset:49152
 v_cvt_pk_bf16_f32 v43, v46, v47
 v_mfma_f32_16x16x32_bf16 v[212:215], v[80:83], a[228:231], v[212:215]
 v_exp_f32 v50, v50
 v_mfma_f32_16x16x32_bf16 v[220:223], v[88:91], a[228:231], v[220:223]
 s_waitcnt lgkmcnt(3)
 ds_read_b128 a[228:231], v2 offset:49664
 v_fma_f32 v51, v51, s22, v18
 v_mfma_f32_16x16x32_bf16 v[240:243], v[80:83], a[232:235], v[240:243]
 v_exp_f32 v51, v51
 v_mfma_f32_16x16x32_bf16 v[248:251], v[88:91], a[232:235], v[248:251]
 s_waitcnt lgkmcnt(2)
 v_fma_f32 v52, v52, s22, v18
 v_fma_f32 v53, v53, s22, v18
 v_mfma_f32_16x16x32_bf16 v[244:247], v[80:83], a[236:239], v[244:247]
 buffer_load_dwordx4 v5, s[4:7], s20 offen offset:1024 nt lds
 v_mfma_f32_16x16x32_bf16 v[252:255], v[88:91], a[236:239], v[252:255]
 v_exp_f32 v52, v52
 v_mfma_f32_16x16x32_bf16 v[224:227], v[64:67], a[232:235], v[224:227]
 v_exp_f32 v53, v53
 v_mfma_f32_16x16x32_bf16 v[232:235], v[72:75], a[232:235], v[232:235]
 ds_read_b128 a[232:235], v2 offset:50176
 v_fma_f32 v54, v54, s22, v18
 v_mfma_f32_16x16x32_bf16 v[228:231], v[64:67], a[236:239], v[228:231]
 v_exp_f32 v54, v54
 v_mfma_f32_16x16x32_bf16 v[236:239], v[72:75], a[236:239], v[236:239]
 s_waitcnt lgkmcnt(2)
 ds_read_b128 a[236:239], v2 offset:50688
 v_fma_f32 v55, v55, s22, v18
 v_mfma_f32_16x16x32_bf16 v[88:91], a[224:227], a[12:15], 0
 s_waitcnt lgkmcnt(2)
 buffer_load_dwordx4 v6, s[4:7], s20 offen offset:2048 nt lds
 v_mfma_f32_16x16x32_bf16 v[88:91], a[228:231], a[28:31], v[88:91]
 v_exp_f32 v55, v55
 v_mfma_f32_16x16x32_bf16 v[80:83], a[224:227], a[8:11], 0
 v_fma_f32 v56, v56, s22, v19
 v_fma_f32 v57, v57, s22, v19
 v_mfma_f32_16x16x32_bf16 v[80:83], a[228:231], a[24:27], v[80:83]
 v_exp_f32 v56, v56
 v_mfma_f32_16x16x32_bf16 v[72:75], a[224:227], a[4:7], 0
 v_exp_f32 v57, v57
 v_mfma_f32_16x16x32_bf16 v[72:75], a[228:231], a[20:23], v[72:75]
 v_cvt_pk_bf16_f32 v48, v48, v49
 v_fma_f32 v58, v58, s22, v19
 v_mfma_f32_16x16x32_bf16 v[64:67], a[224:227], a[0:3], 0
 ds_read_b128 a[224:227], v2 offset:51200
 v_fma_f32 v59, v59, s22, v19
 v_mfma_f32_16x16x32_bf16 v[64:67], a[228:231], a[16:19], v[64:67]
 s_waitcnt lgkmcnt(2)
 ds_read_b128 a[228:231], v2 offset:51712
 v_cvt_pk_bf16_f32 v49, v50, v51
 v_mfma_f32_16x16x32_bf16 v[64:67], a[232:235], a[32:35], v[64:67]
 s_waitcnt lgkmcnt(2)
 v_exp_f32 v58, v58
 v_mfma_f32_16x16x32_bf16 v[64:67], a[236:239], a[48:51], v[64:67]
 v_exp_f32 v59, v59
 v_mfma_f32_16x16x32_bf16 v[72:75], a[232:235], a[36:39], v[72:75]
 v_fma_f32 v60, v60, s22, v19
 v_fma_f32 v61, v61, s22, v19
 v_mfma_f32_16x16x32_bf16 v[72:75], a[236:239], a[52:55], v[72:75]
 v_exp_f32 v60, v60
 v_mfma_f32_16x16x32_bf16 v[80:83], a[232:235], a[40:43], v[80:83]
 v_exp_f32 v61, v61
 v_mfma_f32_16x16x32_bf16 v[80:83], a[236:239], a[56:59], v[80:83]
 v_fma_f32 v62, v62, s22, v19
 v_fma_f32 v63, v63, s22, v19
 v_mfma_f32_16x16x32_bf16 v[88:91], a[232:235], a[44:47], v[88:91]
 ds_read_b128 a[232:235], v2 offset:57344
 v_cvt_pk_bf16_f32 v50, v52, v53
 v_mfma_f32_16x16x32_bf16 v[88:91], a[236:239], a[60:63], v[88:91]
 s_waitcnt lgkmcnt(2)
 ds_read_b128 a[236:239], v2 offset:57856
 v_cvt_pk_bf16_f32 v51, v54, v55
 v_mfma_f32_16x16x32_bf16 v[88:91], a[224:227], a[76:79], v[88:91]
 s_waitcnt lgkmcnt(2)
 v_exp_f32 v62, v62
 v_mfma_f32_16x16x32_bf16 v[88:91], a[228:231], a[92:95], v[88:91]
 v_exp_f32 v63, v63
 v_mfma_f32_16x16x32_bf16 v[80:83], a[224:227], a[72:75], v[80:83]
 v_cvt_pk_bf16_f32 v56, v56, v57
 v_cvt_pk_bf16_f32 v57, v58, v59
 v_mfma_f32_16x16x32_bf16 v[80:83], a[228:231], a[88:91], v[80:83]
 v_cvt_pk_bf16_f32 v58, v60, v61
 v_cvt_pk_bf16_f32 v59, v62, v63
 v_mfma_f32_16x16x32_bf16 v[72:75], a[224:227], a[68:71], v[72:75]
 v_mfma_f32_16x16x32_bf16 v[72:75], a[228:231], a[84:87], v[72:75]
 v_mfma_f32_16x16x32_bf16 v[64:67], a[224:227], a[64:67], v[64:67]
 ds_read_b128 a[224:227], v2 offset:56320
 v_mfma_f32_16x16x32_bf16 v[64:67], a[228:231], a[80:83], v[64:67]
 s_waitcnt lgkmcnt(2)
 ds_read_b128 a[228:231], v2 offset:56832
 v_mfma_f32_16x16x32_bf16 v[68:71], a[232:235], a[64:67], 0
 s_waitcnt lgkmcnt(2)
 v_mfma_f32_16x16x32_bf16 v[68:71], a[236:239], a[80:83], v[68:71]
 v_mfma_f32_16x16x32_bf16 v[76:79], a[232:235], a[68:71], 0
 v_mfma_f32_16x16x32_bf16 v[76:79], a[236:239], a[84:87], v[76:79]
 v_mfma_f32_16x16x32_bf16 v[84:87], a[232:235], a[72:75], 0
 v_mfma_f32_16x16x32_bf16 v[84:87], a[236:239], a[88:91], v[84:87]
 v_mfma_f32_16x16x32_bf16 v[92:95], a[232:235], a[76:79], 0
 ds_read_b128 a[232:235], v2 offset:55296
 v_fma_f32 v64, v64, s22, v16
 v_mfma_f32_16x16x32_bf16 v[92:95], a[236:239], a[92:95], v[92:95]
 s_waitcnt lgkmcnt(2)
 ds_read_b128 a[236:239], v2 offset:55808
 v_fma_f32 v65, v65, s22, v16
 v_mfma_f32_16x16x32_bf16 v[92:95], a[224:227], a[44:47], v[92:95]
 s_waitcnt lgkmcnt(2)
 v_exp_f32 v64, v64
 v_mfma_f32_16x16x32_bf16 v[92:95], a[228:231], a[60:63], v[92:95]
 v_exp_f32 v65, v65
 v_mfma_f32_16x16x32_bf16 v[84:87], a[224:227], a[40:43], v[84:87]
 v_fma_f32 v72, v72, s22, v17
 v_fma_f32 v73, v73, s22, v17
 v_mfma_f32_16x16x32_bf16 v[84:87], a[228:231], a[56:59], v[84:87]
 v_exp_f32 v72, v72
 v_mfma_f32_16x16x32_bf16 v[76:79], a[224:227], a[36:39], v[76:79]
 v_exp_f32 v73, v73
 v_mfma_f32_16x16x32_bf16 v[76:79], a[228:231], a[52:55], v[76:79]
 v_fma_f32 v66, v66, s22, v16
 v_fma_f32 v67, v67, s22, v16
 v_mfma_f32_16x16x32_bf16 v[68:71], a[224:227], a[32:35], v[68:71]
 ds_read_b64_tr_b16 a[224:225], v13 offset:49152
 v_fma_f32 v74, v74, s22, v17
 v_mfma_f32_16x16x32_bf16 v[68:71], a[228:231], a[48:51], v[68:71]
 s_waitcnt lgkmcnt(2)
 ds_read_b64_tr_b16 a[226:227], v13 offset:55296
 v_fma_f32 v75, v75, s22, v17
 v_mfma_f32_16x16x32_bf16 v[68:71], a[232:235], a[0:3], v[68:71]
 s_waitcnt lgkmcnt(2)
 ds_read_b64_tr_b16 a[228:229], v13 offset:49408
 v_cvt_pk_bf16_f32 v64, v64, v65
 v_mfma_f32_16x16x32_bf16 v[68:71], a[236:239], a[16:19], v[68:71]
 ds_read_b64_tr_b16 a[230:231], v13 offset:55552
 v_cvt_pk_bf16_f32 v72, v72, v73
 v_mfma_f32_16x16x32_bf16 v[76:79], a[232:235], a[4:7], v[76:79]
 v_exp_f32 v66, v66
 v_mfma_f32_16x16x32_bf16 v[76:79], a[236:239], a[20:23], v[76:79]
 v_exp_f32 v67, v67
 v_mfma_f32_16x16x32_bf16 v[84:87], a[232:235], a[8:11], v[84:87]
 v_exp_f32 v74, v74
 v_mfma_f32_16x16x32_bf16 v[84:87], a[236:239], a[24:27], v[84:87]
 v_exp_f32 v75, v75
 v_mfma_f32_16x16x32_bf16 v[92:95], a[232:235], a[12:15], v[92:95]
 ds_read_b64_tr_b16 a[232:233], v13 offset:49664
 v_fma_f32 v68, v68, s22, v16
 v_mfma_f32_16x16x32_bf16 v[92:95], a[236:239], a[28:31], v[92:95]
 ds_read_b64_tr_b16 a[234:235], v13 offset:55808
 v_fma_f32 v69, v69, s22, v16
 v_mfma_f32_16x16x32_bf16 v[28:31], a[240:243], v[32:35], v[28:31]
 ds_read_b64_tr_b16 a[236:237], v13 offset:49920
 v_fma_f32 v70, v70, s22, v16
 v_mfma_f32_16x16x32_bf16 a[244:247], a[240:243], v[40:43], a[244:247]
 s_waitcnt lgkmcnt(4)
 ds_read_b64_tr_b16 a[238:239], v13 offset:56064
 v_fma_f32 v71, v71, s22, v16
 v_mfma_f32_16x16x32_bf16 v[96:99], v[32:35], a[224:227], v[96:99]
 v_exp_f32 v68, v68
 v_mfma_f32_16x16x32_bf16 v[104:107], v[40:43], a[224:227], v[104:107]
 s_waitcnt lgkmcnt(4)
 v_exp_f32 v69, v69
 v_mfma_f32_16x16x32_bf16 v[100:103], v[32:35], a[228:231], v[100:103]
 v_exp_f32 v70, v70
 v_mfma_f32_16x16x32_bf16 v[108:111], v[40:43], a[228:231], v[108:111]
 s_add_u32 m0, s34, 32768
 v_exp_f32 v71, v71
 v_mfma_f32_16x16x32_bf16 a[192:195], v[48:51], a[224:227], a[192:195]
 buffer_load_dwordx4 v4, s[12:15], s56 offen nt lds
 v_mfma_f32_16x16x32_bf16 a[200:203], v[56:59], a[224:227], a[200:203]
 s_add_u32 m0, s34, 33792
 ds_read_b64_tr_b16 a[224:225], v13 offset:50176
 s_add_u32 s25, s25, 14080
 v_mfma_f32_16x16x32_bf16 a[196:199], v[48:51], a[228:231], a[196:199]
 buffer_load_dwordx4 v4, s[12:15], s57 offen nt lds
 v_mfma_f32_16x16x32_bf16 a[204:207], v[56:59], a[228:231], a[204:207]
 ds_read_b64_tr_b16 a[226:227], v13 offset:56320
 v_fma_f32 v76, v76, s22, v17
 v_mfma_f32_16x16x32_bf16 a[248:251], a[240:243], v[48:51], a[248:251]
 ds_read_b64_tr_b16 a[228:229], v13 offset:50432
 v_fma_f32 v77, v77, s22, v17
 v_mfma_f32_16x16x32_bf16 a[252:255], a[240:243], v[56:59], a[252:255]
 s_waitcnt lgkmcnt(3)
 ds_read_b64_tr_b16 a[230:231], v13 offset:56576
 v_fma_f32 v78, v78, s22, v17
 v_mfma_f32_16x16x32_bf16 a[208:211], v[48:51], a[232:235], a[208:211]
 s_waitcnt vmcnt(19)
 s_barrier
 v_fma_f32 v79, v79, s22, v17
 v_mfma_f32_16x16x32_bf16 a[216:219], v[56:59], a[232:235], a[216:219]
 s_add_u32 m0, s21, 36864
 v_exp_f32 v76, v76
 v_mfma_f32_16x16x32_bf16 a[212:215], v[48:51], a[236:239], a[212:215]
 buffer_load_dwordx4 v8, s[8:11], s25 offen nt lds
 v_mfma_f32_16x16x32_bf16 a[220:223], v[56:59], a[236:239], a[220:223]
 s_sub_u32 s25, s25, 896
 v_exp_f32 v77, v77
 v_mfma_f32_16x16x32_bf16 v[112:115], v[32:35], a[232:235], v[112:115]
 v_exp_f32 v78, v78
 v_mfma_f32_16x16x32_bf16 v[120:123], v[40:43], a[232:235], v[120:123]
 ds_read_b64_tr_b16 a[232:233], v13 offset:50688
 v_cvt_pk_bf16_f32 v65, v66, v67
 v_mfma_f32_16x16x32_bf16 v[116:119], v[32:35], a[236:239], v[116:119]
 ds_read_b64_tr_b16 a[234:235], v13 offset:56832
 v_cvt_pk_bf16_f32 v73, v74, v75
 v_mfma_f32_16x16x32_bf16 v[124:127], v[40:43], a[236:239], v[124:127]
 s_waitcnt lgkmcnt(3)
 ds_read_b64_tr_b16 a[236:237], v13 offset:50944
 v_fma_f32 v80, v80, s22, v18
 v_mfma_f32_16x16x32_bf16 v[128:131], v[32:35], a[224:227], v[128:131]
 buffer_load_dwordx4 v8, s[8:11], s25 offen offset:1024 nt lds
 ds_read_b64_tr_b16 a[238:239], v13 offset:57088
 v_mfma_f32_16x16x32_bf16 v[136:139], v[40:43], a[224:227], v[136:139]
 s_waitcnt lgkmcnt(4)
 v_exp_f32 v79, v79
 v_mfma_f32_16x16x32_bf16 v[132:135], v[32:35], a[228:231], v[132:135]
 s_sub_u32 s25, s25, 896
 v_fma_f32 v81, v81, s22, v18
 v_fma_f32 v82, v82, s22, v18
 v_mfma_f32_16x16x32_bf16 v[140:143], v[40:43], a[228:231], v[140:143]
 s_add_u32 s20, s20, 12288
 v_fma_f32 v83, v83, s22, v18
 v_fma_f32 v84, v84, s22, v18
 v_mfma_f32_16x16x32_bf16 v[144:147], v[48:51], a[224:227], v[144:147]
 v_fma_f32 v85, v85, s22, v18
 v_fma_f32 v86, v86, s22, v18
 v_mfma_f32_16x16x32_bf16 v[152:155], v[56:59], a[224:227], v[152:155]
 ds_read_b64_tr_b16 a[224:225], v13 offset:51200
 v_fma_f32 v87, v87, s22, v18
 v_mfma_f32_16x16x32_bf16 v[148:151], v[48:51], a[228:231], v[148:151]
 buffer_load_dwordx4 v8, s[8:11], s25 offen offset:2048 nt lds
 ds_read_b64_tr_b16 a[226:227], v13 offset:57344
 v_mfma_f32_16x16x32_bf16 v[156:159], v[56:59], a[228:231], v[156:159]
 s_waitcnt lgkmcnt(3)
 ds_read_b64_tr_b16 a[228:229], v13 offset:51456
 v_fma_f32 v88, v88, s22, v19
 v_mfma_f32_16x16x32_bf16 v[176:179], v[48:51], a[232:235], v[176:179]
 ds_read_b64_tr_b16 a[230:231], v13 offset:57600
 v_fma_f32 v89, v89, s22, v19
 v_mfma_f32_16x16x32_bf16 v[184:187], v[56:59], a[232:235], v[184:187]
 s_waitcnt lgkmcnt(4)
 v_fma_f32 v90, v90, s22, v19
 v_fma_f32 v91, v91, s22, v19
 v_mfma_f32_16x16x32_bf16 v[180:183], v[48:51], a[236:239], v[180:183]
 v_fma_f32 v92, v92, s22, v19
 v_fma_f32 v93, v93, s22, v19
 v_mfma_f32_16x16x32_bf16 v[188:191], v[56:59], a[236:239], v[188:191]
 s_add_u32 m0, s21, 24576
 v_fma_f32 v94, v94, s22, v19
 v_fma_f32 v95, v95, s22, v19
 v_mfma_f32_16x16x32_bf16 v[160:163], v[32:35], a[232:235], v[160:163]
 buffer_load_dwordx4 v4, s[4:7], s20 offen lds
 v_mfma_f32_16x16x32_bf16 v[168:171], v[40:43], a[232:235], v[168:171]
 ds_read_b64_tr_b16 a[232:233], v13 offset:51712
 v_cvt_pk_bf16_f32 v66, v68, v69
 v_mfma_f32_16x16x32_bf16 v[164:167], v[32:35], a[236:239], v[164:167]
 ds_read_b64_tr_b16 a[234:235], v13 offset:57856
 v_cvt_pk_bf16_f32 v67, v70, v71
 v_mfma_f32_16x16x32_bf16 v[172:175], v[40:43], a[236:239], v[172:175]
 s_waitcnt lgkmcnt(4)
 ds_read_b64_tr_b16 a[236:237], v13 offset:51968
 v_cvt_pk_bf16_f32 v74, v76, v77
 v_mfma_f32_16x16x32_bf16 v[192:195], v[32:35], a[224:227], v[192:195]
 ds_read_b64_tr_b16 a[238:239], v13 offset:58112
 v_cvt_pk_bf16_f32 v75, v78, v79
 v_mfma_f32_16x16x32_bf16 v[200:203], v[40:43], a[224:227], v[200:203]
 s_waitcnt lgkmcnt(4)
 v_mfma_f32_16x16x32_bf16 v[196:199], v[32:35], a[228:231], v[196:199]
 buffer_load_dwordx4 v5, s[4:7], s20 offen offset:1024 lds
 v_mfma_f32_16x16x32_bf16 v[204:207], v[40:43], a[228:231], v[204:207]
 v_mfma_f32_16x16x32_bf16 v[208:211], v[48:51], a[224:227], v[208:211]
 v_mfma_f32_16x16x32_bf16 v[216:219], v[56:59], a[224:227], v[216:219]
 ds_read_b128 a[224:227], v2 offset:0
 v_mfma_f32_16x16x32_bf16 v[212:215], v[48:51], a[228:231], v[212:215]
 v_mfma_f32_16x16x32_bf16 v[220:223], v[56:59], a[228:231], v[220:223]
 s_waitcnt lgkmcnt(3)
 ds_read_b128 a[228:231], v2 offset:512
 v_mfma_f32_16x16x32_bf16 v[240:243], v[48:51], a[232:235], v[240:243]
 buffer_load_dwordx4 v6, s[4:7], s20 offen offset:2048 lds
 v_mfma_f32_16x16x32_bf16 v[248:251], v[56:59], a[232:235], v[248:251]
 s_waitcnt lgkmcnt(2)
 v_mfma_f32_16x16x32_bf16 v[244:247], v[48:51], a[236:239], v[244:247]
 v_mfma_f32_16x16x32_bf16 v[252:255], v[56:59], a[236:239], v[252:255]
 v_mfma_f32_16x16x32_bf16 v[224:227], v[32:35], a[232:235], v[224:227]
 v_mfma_f32_16x16x32_bf16 v[232:235], v[40:43], a[232:235], v[232:235]
 ds_read_b128 a[232:235], v2 offset:1024
 v_mfma_f32_16x16x32_bf16 v[228:231], v[32:35], a[236:239], v[228:231]
 v_mfma_f32_16x16x32_bf16 v[236:239], v[40:43], a[236:239], v[236:239]
L_loop:
 s_waitcnt lgkmcnt(2)
 v_mfma_f32_16x16x32_bf16 v[56:59], a[224:227], a[12:15], 0
 s_waitcnt lgkmcnt(1)
 ds_read_b128 a[236:239], v2 offset:1536
 v_mfma_f32_16x16x32_bf16 v[56:59], a[228:231], a[28:31], v[56:59]
 v_exp_f32 v80, v80
 v_mfma_f32_16x16x32_bf16 v[48:51], a[224:227], a[8:11], 0
 v_exp_f32 v81, v81
 v_mfma_f32_16x16x32_bf16 v[48:51], a[228:231], a[24:27], v[48:51]
 v_exp_f32 v82, v82
 v_mfma_f32_16x16x32_bf16 v[40:43], a[224:227], a[4:7], 0
 buffer_store_dwordx4 a[128:131], v10, s[16:19], s50 offen offset:128 nt
 v_mfma_f32_16x16x32_bf16 v[40:43], a[228:231], a[20:23], v[40:43]
 v_exp_f32 v83, v83
 v_mfma_f32_16x16x32_bf16 v[32:35], a[224:227], a[0:3], 0
 ds_read_b128 a[224:227], v2 offset:2048
 v_cvt_pk_bf16_f32 v80, v80, v81
 v_mfma_f32_16x16x32_bf16 v[32:35], a[228:231], a[16:19], v[32:35]
 s_waitcnt lgkmcnt(2)
 ds_read_b128 a[228:231], v2 offset:2560
 v_cvt_pk_bf16_f32 v81, v82, v83
 v_mfma_f32_16x16x32_bf16 v[32:35], a[232:235], a[32:35], v[32:35]
 s_waitcnt lgkmcnt(2)
 v_exp_f32 v84, v84
 v_mfma_f32_16x16x32_bf16 v[32:35], a[236:239], a[48:51], v[32:35]
 v_exp_f32 v85, v85
 v_mfma_f32_16x16x32_bf16 v[40:43], a[232:235], a[36:39], v[40:43]
 v_exp_f32 v86, v86
 v_mfma_f32_16x16x32_bf16 v[40:43], a[236:239], a[52:55], v[40:43]
 v_exp_f32 v87, v87
 v_mfma_f32_16x16x32_bf16 v[48:51], a[232:235], a[40:43], v[48:51]
 v_exp_f32 v88, v88
 v_mfma_f32_16x16x32_bf16 v[48:51], a[236:239], a[56:59], v[48:51]
 v_exp_f32 v89, v89
 v_mfma_f32_16x16x32_bf16 v[56:59], a[232:235], a[44:47], v[56:59]
 ds_read_b128 a[232:235], v2 offset:8192
 v_cvt_pk_bf16_f32 v82, v84, v85
 v_mfma_f32_16x16x32_bf16 v[56:59], a[236:239], a[60:63], v[56:59]
 s_waitcnt lgkmcnt(2)
 ds_read_b128 a[236:239], v2 offset:8704
 v_cvt_pk_bf16_f32 v83, v86, v87
 v_mfma_f32_16x16x32_bf16 v[56:59], a[224:227], a[76:79], v[56:59]
 s_waitcnt lgkmcnt(2)
 v_exp_f32 v90, v90
 v_mfma_f32_16x16x32_bf16 v[56:59], a[228:231], a[92:95], v[56:59]
 v_exp_f32 v91, v91
 v_mfma_f32_16x16x32_bf16 v[48:51], a[224:227], a[72:75], v[48:51]
 v_exp_f32 v92, v92
 v_mfma_f32_16x16x32_bf16 v[48:51], a[228:231], a[88:91], v[48:51]
 v_exp_f32 v93, v93
 v_mfma_f32_16x16x32_bf16 v[40:43], a[224:227], a[68:71], v[40:43]
 v_exp_f32 v94, v94
 v_mfma_f32_16x16x32_bf16 v[40:43], a[228:231], a[84:87], v[40:43]
 v_exp_f32 v95, v95
 v_mfma_f32_16x16x32_bf16 v[32:35], a[224:227], a[64:67], v[32:35]
 ds_read_b128 a[224:227], v2 offset:7168
 v_cvt_pk_bf16_f32 v88, v88, v89
 v_mfma_f32_16x16x32_bf16 v[32:35], a[228:231], a[80:83], v[32:35]
 s_waitcnt lgkmcnt(2)
 ds_read_b128 a[228:231], v2 offset:7680
 v_cvt_pk_bf16_f32 v89, v90, v91
 v_mfma_f32_16x16x32_bf16 v[36:39], a[232:235], a[64:67], 0
 s_waitcnt lgkmcnt(2)
 v_cvt_pk_bf16_f32 v90, v92, v93
 v_cvt_pk_bf16_f32 v91, v94, v95
 v_mfma_f32_16x16x32_bf16 v[36:39], a[236:239], a[80:83], v[36:39]
 v_mfma_f32_16x16x32_bf16 v[44:47], a[232:235], a[68:71], 0
 v_mfma_f32_16x16x32_bf16 v[44:47], a[236:239], a[84:87], v[44:47]
 v_mfma_f32_16x16x32_bf16 v[52:55], a[232:235], a[72:75], 0
 v_mfma_f32_16x16x32_bf16 v[52:55], a[236:239], a[88:91], v[52:55]
 v_mfma_f32_16x16x32_bf16 v[60:63], a[232:235], a[76:79], 0
 ds_read_b128 a[232:235], v2 offset:6144
 v_fma_f32 v32, v32, s22, v16
 v_mfma_f32_16x16x32_bf16 v[60:63], a[236:239], a[92:95], v[60:63]
 s_waitcnt lgkmcnt(2)
 ds_read_b128 a[236:239], v2 offset:6656
 v_fma_f32 v33, v33, s22, v16
 v_mfma_f32_16x16x32_bf16 v[60:63], a[224:227], a[44:47], v[60:63]
 s_waitcnt lgkmcnt(2)
 v_exp_f32 v32, v32
 v_mfma_f32_16x16x32_bf16 v[60:63], a[228:231], a[60:63], v[60:63]
 v_exp_f32 v33, v33
 v_mfma_f32_16x16x32_bf16 v[52:55], a[224:227], a[40:43], v[52:55]
 v_fma_f32 v34, v34, s22, v16
 v_fma_f32 v35, v35, s22, v16
 v_mfma_f32_16x16x32_bf16 v[52:55], a[228:231], a[56:59], v[52:55]
 v_exp_f32 v34, v34
 v_mfma_f32_16x16x32_bf16 v[44:47], a[224:227], a[36:39], v[44:47]
 v_exp_f32 v35, v35
 v_mfma_f32_16x16x32_bf16 v[44:47], a[228:231], a[52:55], v[44:47]
 v_fma_f32 v40, v40, s22, v17
 v_fma_f32 v41, v41, s22, v17
 v_mfma_f32_16x16x32_bf16 v[36:39], a[224:227], a[32:35], v[36:39]
 ds_read_b64_tr_b16 a[224:225], v13 offset:0
 v_cvt_pk_bf16_f32 v32, v32, v33
 v_mfma_f32_16x16x32_bf16 v[36:39], a[228:231], a[48:51], v[36:39]
 s_waitcnt lgkmcnt(2)
 ds_read_b64_tr_b16 a[226:227], v13 offset:6144
 v_fma_f32 v42, v42, s22, v17
 v_mfma_f32_16x16x32_bf16 v[36:39], a[232:235], a[0:3], v[36:39]
 s_waitcnt lgkmcnt(2)
 ds_read_b64_tr_b16 a[228:229], v13 offset:256
 v_fma_f32 v43, v43, s22, v17
 v_mfma_f32_16x16x32_bf16 v[36:39], a[236:239], a[16:19], v[36:39]
 ds_read_b64_tr_b16 a[230:231], v13 offset:6400
 v_cvt_pk_bf16_f32 v33, v34, v35
 v_mfma_f32_16x16x32_bf16 v[44:47], a[232:235], a[4:7], v[44:47]
 v_exp_f32 v40, v40
 v_mfma_f32_16x16x32_bf16 v[44:47], a[236:239], a[20:23], v[44:47]
 v_exp_f32 v41, v41
 v_mfma_f32_16x16x32_bf16 v[52:55], a[232:235], a[8:11], v[52:55]
 v_exp_f32 v42, v42
 v_mfma_f32_16x16x32_bf16 v[52:55], a[236:239], a[24:27], v[52:55]
 v_exp_f32 v43, v43
 v_mfma_f32_16x16x32_bf16 v[60:63], a[232:235], a[12:15], v[60:63]
 ds_read_b64_tr_b16 a[232:233], v13 offset:512
 v_fma_f32 v36, v36, s22, v16
 v_mfma_f32_16x16x32_bf16 v[60:63], a[236:239], a[28:31], v[60:63]
 ds_read_b64_tr_b16 a[234:235], v13 offset:6656
 v_fma_f32 v37, v37, s22, v16
 v_mfma_f32_16x16x32_bf16 v[28:31], a[240:243], v[64:67], v[28:31]
 ds_read_b64_tr_b16 a[236:237], v13 offset:768
 v_fma_f32 v38, v38, s22, v16
 v_mfma_f32_16x16x32_bf16 a[244:247], a[240:243], v[72:75], a[244:247]
 s_waitcnt lgkmcnt(4)
 ds_read_b64_tr_b16 a[238:239], v13 offset:6912
 v_fma_f32 v39, v39, s22, v16
 v_mfma_f32_16x16x32_bf16 v[96:99], v[64:67], a[224:227], v[96:99]
 v_exp_f32 v36, v36
 v_mfma_f32_16x16x32_bf16 v[104:107], v[72:75], a[224:227], v[104:107]
 s_waitcnt lgkmcnt(4)
 v_exp_f32 v37, v37
 v_mfma_f32_16x16x32_bf16 v[100:103], v[64:67], a[228:231], v[100:103]
 v_exp_f32 v38, v38
 v_mfma_f32_16x16x32_bf16 v[108:111], v[72:75], a[228:231], v[108:111]
 s_add_u32 m0, s34, -1024
 v_exp_f32 v39, v39
 v_mfma_f32_16x16x32_bf16 a[192:195], v[80:83], a[224:227], a[192:195]
 buffer_load_dwordx4 v5, s[12:15], s50 offen offset:1024 nt lds
 v_mfma_f32_16x16x32_bf16 a[200:203], v[88:91], a[224:227], a[200:203]
 s_add_u32 m0, s34, 0
 ds_read_b64_tr_b16 a[224:225], v13 offset:1024
 s_add_u32 s20, s20, 12288
 v_mfma_f32_16x16x32_bf16 a[196:199], v[80:83], a[228:231], a[196:199]
 buffer_load_dwordx4 v5, s[12:15], s51 offen offset:1024 nt lds
 v_mfma_f32_16x16x32_bf16 a[204:207], v[88:91], a[228:231], a[204:207]
 ds_read_b64_tr_b16 a[226:227], v13 offset:7168
 v_fma_f32 v44, v44, s22, v17
 v_mfma_f32_16x16x32_bf16 a[248:251], a[240:243], v[80:83], a[248:251]
 ds_read_b64_tr_b16 a[228:229], v13 offset:1280
 v_fma_f32 v45, v45, s22, v17
 v_mfma_f32_16x16x32_bf16 a[252:255], a[240:243], v[88:91], a[252:255]
 s_waitcnt lgkmcnt(3)
 ds_read_b64_tr_b16 a[230:231], v13 offset:7424
 v_fma_f32 v46, v46, s22, v17
 v_mfma_f32_16x16x32_bf16 a[208:211], v[80:83], a[232:235], a[208:211]
 s_waitcnt vmcnt(21)
 s_barrier
 v_fma_f32 v47, v47, s22, v17
 v_mfma_f32_16x16x32_bf16 a[216:219], v[88:91], a[232:235], a[216:219]
 v_exp_f32 v44, v44
 v_mfma_f32_16x16x32_bf16 a[212:215], v[80:83], a[236:239], a[212:215]
 v_exp_f32 v45, v45
 v_mfma_f32_16x16x32_bf16 a[220:223], v[88:91], a[236:239], a[220:223]
 s_add_u32 m0, s21, 73728
 s_add_u32 s25, s25, 14080
 v_cvt_pk_bf16_f32 v34, v36, v37
 v_mfma_f32_16x16x32_bf16 v[112:115], v[64:67], a[232:235], v[112:115]
 buffer_load_dwordx4 v4, s[4:7], s20 offen nt lds
 v_mfma_f32_16x16x32_bf16 v[120:123], v[72:75], a[232:235], v[120:123]
 ds_read_b64_tr_b16 a[232:233], v13 offset:1536
 v_cvt_pk_bf16_f32 v35, v38, v39
 v_mfma_f32_16x16x32_bf16 v[116:119], v[64:67], a[236:239], v[116:119]
 ds_read_b64_tr_b16 a[234:235], v13 offset:7680
 v_cvt_pk_bf16_f32 v40, v40, v41
 v_mfma_f32_16x16x32_bf16 v[124:127], v[72:75], a[236:239], v[124:127]
 s_waitcnt lgkmcnt(3)
 ds_read_b64_tr_b16 a[236:237], v13 offset:1792
 v_cvt_pk_bf16_f32 v41, v42, v43
 v_mfma_f32_16x16x32_bf16 v[128:131], v[64:67], a[224:227], v[128:131]
 ds_read_b64_tr_b16 a[238:239], v13 offset:7936
 v_cvt_pk_bf16_f32 v42, v44, v45
 v_mfma_f32_16x16x32_bf16 v[136:139], v[72:75], a[224:227], v[136:139]
 s_waitcnt lgkmcnt(4)
 v_exp_f32 v46, v46
 v_mfma_f32_16x16x32_bf16 v[132:135], v[64:67], a[228:231], v[132:135]
 buffer_load_dwordx4 v5, s[4:7], s20 offen offset:1024 nt lds
 v_mfma_f32_16x16x32_bf16 v[140:143], v[72:75], a[228:231], v[140:143]
 v_exp_f32 v47, v47
 v_mfma_f32_16x16x32_bf16 v[144:147], v[80:83], a[224:227], v[144:147]
 v_cvt_pk_bf16_f32 v43, v46, v47
 v_fma_f32 v48, v48, s22, v18
 v_mfma_f32_16x16x32_bf16 v[152:155], v[88:91], a[224:227], v[152:155]
 ds_read_b64_tr_b16 a[224:225], v13 offset:2048
 v_fma_f32 v49, v49, s22, v18
 v_mfma_f32_16x16x32_bf16 v[148:151], v[80:83], a[228:231], v[148:151]
 ds_read_b64_tr_b16 a[226:227], v13 offset:8192
 v_fma_f32 v50, v50, s22, v18
 v_mfma_f32_16x16x32_bf16 v[156:159], v[88:91], a[228:231], v[156:159]
 s_waitcnt lgkmcnt(4)
 ds_read_b64_tr_b16 a[228:229], v13 offset:2304
 v_fma_f32 v51, v51, s22, v18
 v_mfma_f32_16x16x32_bf16 v[176:179], v[80:83], a[232:235], v[176:179]
 buffer_load_dwordx4 v6, s[4:7], s20 offen offset:2048 nt lds
 ds_read_b64_tr_b16 a[230:231], v13 offset:8448
 v_mfma_f32_16x16x32_bf16 v[184:187], v[88:91], a[232:235], v[184:187]
 s_waitcnt lgkmcnt(4)
 v_exp_f32 v48, v48
 v_mfma_f32_16x16x32_bf16 v[180:183], v[80:83], a[236:239], v[180:183]
 v_exp_f32 v49, v49
 v_mfma_f32_16x16x32_bf16 v[188:191], v[88:91], a[236:239], v[188:191]
 v_exp_f32 v50, v50
 v_mfma_f32_16x16x32_bf16 v[160:163], v[64:67], a[232:235], v[160:163]
 v_exp_f32 v51, v51
 v_mfma_f32_16x16x32_bf16 v[168:171], v[72:75], a[232:235], v[168:171]
 s_add_u32 m0, s21, 49152
 ds_read_b64_tr_b16 a[232:233], v13 offset:2560
 v_fma_f32 v52, v52, s22, v18
 v_mfma_f32_16x16x32_bf16 v[164:167], v[64:67], a[236:239], v[164:167]
 buffer_load_dwordx4 v8, s[8:11], s25 offen lds
 ds_read_b64_tr_b16 a[234:235], v13 offset:8704
 v_mfma_f32_16x16x32_bf16 v[172:175], v[72:75], a[236:239], v[172:175]
 s_waitcnt lgkmcnt(3)
 ds_read_b64_tr_b16 a[236:237], v13 offset:2816
 s_sub_u32 s25, s25, 896
 v_mfma_f32_16x16x32_bf16 v[192:195], v[64:67], a[224:227], v[192:195]
 ds_read_b64_tr_b16 a[238:239], v13 offset:8960
 v_fma_f32 v53, v53, s22, v18
 v_mfma_f32_16x16x32_bf16 v[200:203], v[72:75], a[224:227], v[200:203]
 s_waitcnt lgkmcnt(4)
 v_exp_f32 v52, v52
 v_mfma_f32_16x16x32_bf16 v[196:199], v[64:67], a[228:231], v[196:199]
 v_exp_f32 v53, v53
 v_mfma_f32_16x16x32_bf16 v[204:207], v[72:75], a[228:231], v[204:207]
 v_fma_f32 v54, v54, s22, v18
 v_fma_f32 v55, v55, s22, v18
 v_mfma_f32_16x16x32_bf16 v[208:211], v[80:83], a[224:227], v[208:211]
 buffer_load_dwordx4 v8, s[8:11], s25 offen offset:1024 lds
 v_mfma_f32_16x16x32_bf16 v[216:219], v[88:91], a[224:227], v[216:219]
 s_sub_u32 s25, s25, 896
 ds_read_b128 a[224:227], v2 offset:24576
 v_fma_f32 v56, v56, s22, v19
 v_mfma_f32_16x16x32_bf16 v[212:215], v[80:83], a[228:231], v[212:215]
 v_exp_f32 v54, v54
 v_mfma_f32_16x16x32_bf16 v[220:223], v[88:91], a[228:231], v[220:223]
 s_waitcnt lgkmcnt(3)
 ds_read_b128 a[228:231], v2 offset:25088
 v_fma_f32 v57, v57, s22, v19
 v_mfma_f32_16x16x32_bf16 v[240:243], v[80:83], a[232:235], v[240:243]
 v_exp_f32 v55, v55
 v_mfma_f32_16x16x32_bf16 v[248:251], v[88:91], a[232:235], v[248:251]
 s_waitcnt lgkmcnt(2)
 v_exp_f32 v56, v56
 v_mfma_f32_16x16x32_bf16 v[244:247], v[80:83], a[236:239], v[244:247]
 buffer_load_dwordx4 v8, s[8:11], s25 offen offset:2048 lds
 v_mfma_f32_16x16x32_bf16 v[252:255], v[88:91], a[236:239], v[252:255]
 v_exp_f32 v57, v57
 v_mfma_f32_16x16x32_bf16 v[224:227], v[64:67], a[232:235], v[224:227]
 v_cvt_pk_bf16_f32 v48, v48, v49
 v_fma_f32 v58, v58, s22, v19
 v_mfma_f32_16x16x32_bf16 v[232:235], v[72:75], a[232:235], v[232:235]
 ds_read_b128 a[232:235], v2 offset:25600
 v_fma_f32 v59, v59, s22, v19
 v_mfma_f32_16x16x32_bf16 v[228:231], v[64:67], a[236:239], v[228:231]
 v_exp_f32 v58, v58
 v_mfma_f32_16x16x32_bf16 v[236:239], v[72:75], a[236:239], v[236:239]
 s_waitcnt lgkmcnt(2)
 ds_read_b128 a[236:239], v2 offset:26112
 v_cvt_pk_bf16_f32 v49, v50, v51
 v_mfma_f32_16x16x32_bf16 v[88:91], a[224:227], a[12:15], 0
 s_waitcnt lgkmcnt(2)
 v_exp_f32 v59, v59
 v_mfma_f32_16x16x32_bf16 v[88:91], a[228:231], a[28:31], v[88:91]
 v_fma_f32 v60, v60, s22, v19
 v_fma_f32 v61, v61, s22, v19
 v_mfma_f32_16x16x32_bf16 v[80:83], a[224:227], a[8:11], 0
 v_exp_f32 v60, v60
 v_mfma_f32_16x16x32_bf16 v[80:83], a[228:231], a[24:27], v[80:83]
 v_exp_f32 v61, v61
 v_mfma_f32_16x16x32_bf16 v[72:75], a[224:227], a[4:7], 0
 buffer_store_dwordx4 a[132:135], v10, s[16:19], s51 offen offset:128 nt
 v_mfma_f32_16x16x32_bf16 v[72:75], a[228:231], a[20:23], v[72:75]
 v_fma_f32 v62, v62, s22, v19
 v_fma_f32 v63, v63, s22, v19
 v_mfma_f32_16x16x32_bf16 v[64:67], a[224:227], a[0:3], 0
 ds_read_b128 a[224:227], v2 offset:26624
 v_cvt_pk_bf16_f32 v50, v52, v53
 v_mfma_f32_16x16x32_bf16 v[64:67], a[228:231], a[16:19], v[64:67]
 s_waitcnt lgkmcnt(1)
 ds_read_b128 a[228:231], v2 offset:27136
 v_cvt_pk_bf16_f32 v51, v54, v55
 v_mfma_f32_16x16x32_bf16 v[64:67], a[232:235], a[32:35], v[64:67]
 v_exp_f32 v62, v62
 v_mfma_f32_16x16x32_bf16 v[64:67], a[236:239], a[48:51], v[64:67]
 v_exp_f32 v63, v63
 v_mfma_f32_16x16x32_bf16 v[72:75], a[232:235], a[36:39], v[72:75]
 v_cvt_pk_bf16_f32 v56, v56, v57
 v_cvt_pk_bf16_f32 v57, v58, v59
 v_mfma_f32_16x16x32_bf16 v[72:75], a[236:239], a[52:55], v[72:75]
 v_cvt_pk_bf16_f32 v58, v60, v61
 v_cvt_pk_bf16_f32 v59, v62, v63
 v_mfma_f32_16x16x32_bf16 v[80:83], a[232:235], a[40:43], v[80:83]
 v_mfma_f32_16x16x32_bf16 v[80:83], a[236:239], a[56:59], v[80:83]
 v_mfma_f32_16x16x32_bf16 v[88:91], a[232:235], a[44:47], v[88:91]
 ds_read_b128 a[232:235], v2 offset:32768
 v_mfma_f32_16x16x32_bf16 v[88:91], a[236:239], a[60:63], v[88:91]
 s_waitcnt lgkmcnt(2)
 ds_read_b128 a[236:239], v2 offset:33280
 v_mfma_f32_16x16x32_bf16 v[88:91], a[224:227], a[76:79], v[88:91]
 s_waitcnt lgkmcnt(2)
 v_mfma_f32_16x16x32_bf16 v[88:91], a[228:231], a[92:95], v[88:91]
 v_mfma_f32_16x16x32_bf16 v[80:83], a[224:227], a[72:75], v[80:83]
 v_mfma_f32_16x16x32_bf16 v[80:83], a[228:231], a[88:91], v[80:83]
 v_mfma_f32_16x16x32_bf16 v[72:75], a[224:227], a[68:71], v[72:75]
 v_mfma_f32_16x16x32_bf16 v[72:75], a[228:231], a[84:87], v[72:75]
 v_mfma_f32_16x16x32_bf16 v[64:67], a[224:227], a[64:67], v[64:67]
 ds_read_b128 a[224:227], v2 offset:31744
 v_mfma_f32_16x16x32_bf16 v[64:67], a[228:231], a[80:83], v[64:67]
 s_waitcnt lgkmcnt(2)
 ds_read_b128 a[228:231], v2 offset:32256
 v_mfma_f32_16x16x32_bf16 v[68:71], a[232:235], a[64:67], 0
 s_waitcnt lgkmcnt(2)
 v_mfma_f32_16x16x32_bf16 v[68:71], a[236:239], a[80:83], v[68:71]
 v_mfma_f32_16x16x32_bf16 v[76:79], a[232:235], a[68:71], 0
 v_mfma_f32_16x16x32_bf16 v[76:79], a[236:239], a[84:87], v[76:79]
 v_mfma_f32_16x16x32_bf16 v[84:87], a[232:235], a[72:75], 0
 v_mfma_f32_16x16x32_bf16 v[84:87], a[236:239], a[88:91], v[84:87]
 v_mfma_f32_16x16x32_bf16 v[92:95], a[232:235], a[76:79], 0
 ds_read_b128 a[232:235], v2 offset:30720
 v_fma_f32 v64, v64, s22, v16
 v_mfma_f32_16x16x32_bf16 v[92:95], a[236:239], a[92:95], v[92:95]
 s_waitcnt lgkmcnt(2)
 ds_read_b128 a[236:239], v2 offset:31232
 v_fma_f32 v65, v65, s22, v16
 v_mfma_f32_16x16x32_bf16 v[92:95], a[224:227], a[44:47], v[92:95]
 s_waitcnt lgkmcnt(2)
 v_exp_f32 v64, v64
 v_mfma_f32_16x16x32_bf16 v[92:95], a[228:231], a[60:63], v[92:95]
 v_exp_f32 v65, v65
 v_mfma_f32_16x16x32_bf16 v[84:87], a[224:227], a[40:43], v[84:87]
 v_fma_f32 v66, v66, s22, v16
 v_fma_f32 v67, v67, s22, v16
 v_mfma_f32_16x16x32_bf16 v[84:87], a[228:231], a[56:59], v[84:87]
 v_exp_f32 v66, v66
 v_mfma_f32_16x16x32_bf16 v[76:79], a[224:227], a[36:39], v[76:79]
 v_exp_f32 v67, v67
 v_mfma_f32_16x16x32_bf16 v[76:79], a[228:231], a[52:55], v[76:79]
 v_fma_f32 v72, v72, s22, v17
 v_fma_f32 v73, v73, s22, v17
 v_mfma_f32_16x16x32_bf16 v[68:71], a[224:227], a[32:35], v[68:71]
 ds_read_b64_tr_b16 a[224:225], v13 offset:24576
 v_cvt_pk_bf16_f32 v64, v64, v65
 v_mfma_f32_16x16x32_bf16 v[68:71], a[228:231], a[48:51], v[68:71]
 s_waitcnt lgkmcnt(2)
 ds_read_b64_tr_b16 a[226:227], v13 offset:30720
 v_fma_f32 v74, v74, s22, v17
 v_mfma_f32_16x16x32_bf16 v[68:71], a[232:235], a[0:3], v[68:71]
 s_waitcnt lgkmcnt(2)
 ds_read_b64_tr_b16 a[228:229], v13 offset:24832
 v_fma_f32 v75, v75, s22, v17
 v_mfma_f32_16x16x32_bf16 v[68:71], a[236:239], a[16:19], v[68:71]
 ds_read_b64_tr_b16 a[230:231], v13 offset:30976
 v_cvt_pk_bf16_f32 v65, v66, v67
 v_mfma_f32_16x16x32_bf16 v[76:79], a[232:235], a[4:7], v[76:79]
 v_exp_f32 v72, v72
 v_mfma_f32_16x16x32_bf16 v[76:79], a[236:239], a[20:23], v[76:79]
 v_exp_f32 v73, v73
 v_mfma_f32_16x16x32_bf16 v[84:87], a[232:235], a[8:11], v[84:87]
 v_exp_f32 v74, v74
 v_mfma_f32_16x16x32_bf16 v[84:87], a[236:239], a[24:27], v[84:87]
 v_exp_f32 v75, v75
 v_mfma_f32_16x16x32_bf16 v[92:95], a[232:235], a[12:15], v[92:95]
 ds_read_b64_tr_b16 a[232:233], v13 offset:25088
 v_fma_f32 v68, v68, s22, v16
 v_mfma_f32_16x16x32_bf16 v[92:95], a[236:239], a[28:31], v[92:95]
 ds_read_b64_tr_b16 a[234:235], v13 offset:31232
 v_fma_f32 v69, v69, s22, v16
 v_mfma_f32_16x16x32_bf16 v[28:31], a[240:243], v[32:35], v[28:31]
 ds_read_b64_tr_b16 a[236:237], v13 offset:25344
 v_fma_f32 v70, v70, s22, v16
 v_mfma_f32_16x16x32_bf16 a[244:247], a[240:243], v[40:43], a[244:247]
 s_waitcnt lgkmcnt(4)
 ds_read_b64_tr_b16 a[238:239], v13 offset:31488
 v_fma_f32 v71, v71, s22, v16
 v_mfma_f32_16x16x32_bf16 v[96:99], v[32:35], a[224:227], v[96:99]
 v_exp_f32 v68, v68
 v_mfma_f32_16x16x32_bf16 v[104:107], v[40:43], a[224:227], v[104:107]
 s_waitcnt lgkmcnt(4)
 v_exp_f32 v69, v69
 v_mfma_f32_16x16x32_bf16 v[100:103], v[32:35], a[228:231], v[100:103]
 v_exp_f32 v70, v70
 v_mfma_f32_16x16x32_bf16 v[108:111], v[40:43], a[228:231], v[108:111]
 s_add_u32 m0, s34, 7168
 v_exp_f32 v71, v71
 v_mfma_f32_16x16x32_bf16 a[192:195], v[48:51], a[224:227], a[192:195]
 buffer_load_dwordx4 v5, s[12:15], s52 offen offset:1024 nt lds
 v_mfma_f32_16x16x32_bf16 a[200:203], v[56:59], a[224:227], a[200:203]
 s_add_u32 m0, s34, 8192
 ds_read_b64_tr_b16 a[224:225], v13 offset:25600
 s_add_u32 s20, s20, 12288
 v_mfma_f32_16x16x32_bf16 a[196:199], v[48:51], a[228:231], a[196:199]
 buffer_load_dwordx4 v5, s[12:15], s53 offen offset:1024 nt lds
 v_mfma_f32_16x16x32_bf16 a[204:207], v[56:59], a[228:231], a[204:207]
 ds_read_b64_tr_b16 a[226:227], v13 offset:31744
 v_fma_f32 v76, v76, s22, v17
 v_mfma_f32_16x16x32_bf16 a[248:251], a[240:243], v[48:51], a[248:251]
 ds_read_b64_tr_b16 a[228:229], v13 offset:25856
 v_fma_f32 v77, v77, s22, v17
 v_mfma_f32_16x16x32_bf16 a[252:255], a[240:243], v[56:59], a[252:255]
 s_waitcnt lgkmcnt(3)
 ds_read_b64_tr_b16 a[230:231], v13 offset:32000
 v_fma_f32 v78, v78, s22, v17
 v_mfma_f32_16x16x32_bf16 a[208:211], v[48:51], a[232:235], a[208:211]
 s_waitcnt vmcnt(21)
 s_barrier
 v_fma_f32 v79, v79, s22, v17
 v_mfma_f32_16x16x32_bf16 a[216:219], v[56:59], a[232:235], a[216:219]
 v_exp_f32 v76, v76
 v_mfma_f32_16x16x32_bf16 a[212:215], v[48:51], a[236:239], a[212:215]
 v_exp_f32 v77, v77
 v_mfma_f32_16x16x32_bf16 a[220:223], v[56:59], a[236:239], a[220:223]
 s_add_u32 m0, s21, 98304
 s_add_u32 s25, s25, 14080
 v_cvt_pk_bf16_f32 v66, v68, v69
 v_mfma_f32_16x16x32_bf16 v[112:115], v[32:35], a[232:235], v[112:115]
 buffer_load_dwordx4 v4, s[4:7], s20 offen lds
 v_mfma_f32_16x16x32_bf16 v[120:123], v[40:43], a[232:235], v[120:123]
 ds_read_b64_tr_b16 a[232:233], v13 offset:26112
 v_cvt_pk_bf16_f32 v67, v70, v71
 v_mfma_f32_16x16x32_bf16 v[116:119], v[32:35], a[236:239], v[116:119]
 ds_read_b64_tr_b16 a[234:235], v13 offset:32256
 v_cvt_pk_bf16_f32 v72, v72, v73
 v_mfma_f32_16x16x32_bf16 v[124:127], v[40:43], a[236:239], v[124:127]
 s_waitcnt lgkmcnt(3)
 ds_read_b64_tr_b16 a[236:237], v13 offset:26368
 v_cvt_pk_bf16_f32 v73, v74, v75
 v_mfma_f32_16x16x32_bf16 v[128:131], v[32:35], a[224:227], v[128:131]
 ds_read_b64_tr_b16 a[238:239], v13 offset:32512
 v_cvt_pk_bf16_f32 v74, v76, v77
 v_mfma_f32_16x16x32_bf16 v[136:139], v[40:43], a[224:227], v[136:139]
 s_waitcnt lgkmcnt(4)
 v_exp_f32 v78, v78
 v_mfma_f32_16x16x32_bf16 v[132:135], v[32:35], a[228:231], v[132:135]
 buffer_load_dwordx4 v5, s[4:7], s20 offen offset:1024 lds
 v_mfma_f32_16x16x32_bf16 v[140:143], v[40:43], a[228:231], v[140:143]
 v_exp_f32 v79, v79
 v_mfma_f32_16x16x32_bf16 v[144:147], v[48:51], a[224:227], v[144:147]
 v_cvt_pk_bf16_f32 v75, v78, v79
 v_fma_f32 v80, v80, s22, v18
 v_mfma_f32_16x16x32_bf16 v[152:155], v[56:59], a[224:227], v[152:155]
 ds_read_b64_tr_b16 a[224:225], v13 offset:26624
 v_fma_f32 v81, v81, s22, v18
 v_mfma_f32_16x16x32_bf16 v[148:151], v[48:51], a[228:231], v[148:151]
 ds_read_b64_tr_b16 a[226:227], v13 offset:32768
 v_fma_f32 v82, v82, s22, v18
 v_mfma_f32_16x16x32_bf16 v[156:159], v[56:59], a[228:231], v[156:159]
 s_waitcnt lgkmcnt(4)
 ds_read_b64_tr_b16 a[228:229], v13 offset:26880
 v_fma_f32 v83, v83, s22, v18
 v_mfma_f32_16x16x32_bf16 v[176:179], v[48:51], a[232:235], v[176:179]
 buffer_load_dwordx4 v6, s[4:7], s20 offen offset:2048 lds
 ds_read_b64_tr_b16 a[230:231], v13 offset:33024
 v_mfma_f32_16x16x32_bf16 v[184:187], v[56:59], a[232:235], v[184:187]
 s_waitcnt lgkmcnt(4)
 v_exp_f32 v80, v80
 v_mfma_f32_16x16x32_bf16 v[180:183], v[48:51], a[236:239], v[180:183]
 v_exp_f32 v81, v81
 v_mfma_f32_16x16x32_bf16 v[188:191], v[56:59], a[236:239], v[188:191]
 v_exp_f32 v82, v82
 v_mfma_f32_16x16x32_bf16 v[160:163], v[32:35], a[232:235], v[160:163]
 v_exp_f32 v83, v83
 v_mfma_f32_16x16x32_bf16 v[168:171], v[40:43], a[232:235], v[168:171]
 s_add_u32 m0, s21, 86016
 ds_read_b64_tr_b16 a[232:233], v13 offset:27136
 v_fma_f32 v84, v84, s22, v18
 v_mfma_f32_16x16x32_bf16 v[164:167], v[32:35], a[236:239], v[164:167]
 buffer_load_dwordx4 v8, s[8:11], s25 offen nt lds
 ds_read_b64_tr_b16 a[234:235], v13 offset:33280
 v_mfma_f32_16x16x32_bf16 v[172:175], v[40:43], a[236:239], v[172:175]
 s_waitcnt lgkmcnt(3)
 ds_read_b64_tr_b16 a[236:237], v13 offset:27392
 s_sub_u32 s25, s25, 896
 v_mfma_f32_16x16x32_bf16 v[192:195], v[32:35], a[224:227], v[192:195]
 ds_read_b64_tr_b16 a[238:239], v13 offset:33536
 v_fma_f32 v85, v85, s22, v18
 v_mfma_f32_16x16x32_bf16 v[200:203], v[40:43], a[224:227], v[200:203]
 s_waitcnt lgkmcnt(4)
 v_exp_f32 v84, v84
 v_mfma_f32_16x16x32_bf16 v[196:199], v[32:35], a[228:231], v[196:199]
 v_exp_f32 v85, v85
 v_mfma_f32_16x16x32_bf16 v[204:207], v[40:43], a[228:231], v[204:207]
 v_fma_f32 v86, v86, s22, v18
 v_fma_f32 v87, v87, s22, v18
 v_mfma_f32_16x16x32_bf16 v[208:211], v[48:51], a[224:227], v[208:211]
 buffer_load_dwordx4 v8, s[8:11], s25 offen offset:1024 nt lds
 v_mfma_f32_16x16x32_bf16 v[216:219], v[56:59], a[224:227], v[216:219]
 s_sub_u32 s25, s25, 896
 ds_read_b128 a[224:227], v1 offset:0
 v_fma_f32 v88, v88, s22, v19
 v_mfma_f32_16x16x32_bf16 v[212:215], v[48:51], a[228:231], v[212:215]
 v_exp_f32 v86, v86
 v_mfma_f32_16x16x32_bf16 v[220:223], v[56:59], a[228:231], v[220:223]
 s_waitcnt lgkmcnt(3)
 ds_read_b128 a[228:231], v1 offset:512
 v_fma_f32 v89, v89, s22, v19
 v_mfma_f32_16x16x32_bf16 v[240:243], v[48:51], a[232:235], v[240:243]
 v_exp_f32 v87, v87
 v_mfma_f32_16x16x32_bf16 v[248:251], v[56:59], a[232:235], v[248:251]
 s_waitcnt lgkmcnt(2)
 v_exp_f32 v88, v88
 v_mfma_f32_16x16x32_bf16 v[244:247], v[48:51], a[236:239], v[244:247]
 buffer_load_dwordx4 v8, s[8:11], s25 offen offset:2048 nt lds
 v_mfma_f32_16x16x32_bf16 v[252:255], v[56:59], a[236:239], v[252:255]
 v_exp_f32 v89, v89
 v_mfma_f32_16x16x32_bf16 v[224:227], v[32:35], a[232:235], v[224:227]
 v_cvt_pk_bf16_f32 v80, v80, v81
 v_fma_f32 v90, v90, s22, v19
 v_mfma_f32_16x16x32_bf16 v[232:235], v[40:43], a[232:235], v[232:235]
 ds_read_b128 a[232:235], v1 offset:1024
 v_fma_f32 v91, v91, s22, v19
 v_mfma_f32_16x16x32_bf16 v[228:231], v[32:35], a[236:239], v[228:231]
 v_exp_f32 v90, v90
 v_mfma_f32_16x16x32_bf16 v[236:239], v[40:43], a[236:239], v[236:239]
 s_waitcnt lgkmcnt(2)
 ds_read_b128 a[236:239], v1 offset:1536
 v_cvt_pk_bf16_f32 v81, v82, v83
 v_mfma_f32_16x16x32_bf16 v[56:59], a[224:227], a[12:15], 0
 s_waitcnt lgkmcnt(2)
 v_exp_f32 v91, v91
 v_mfma_f32_16x16x32_bf16 v[56:59], a[228:231], a[28:31], v[56:59]
 v_fma_f32 v92, v92, s22, v19
 v_fma_f32 v93, v93, s22, v19
 v_mfma_f32_16x16x32_bf16 v[48:51], a[224:227], a[8:11], 0
 v_exp_f32 v92, v92
 v_mfma_f32_16x16x32_bf16 v[48:51], a[228:231], a[24:27], v[48:51]
 v_exp_f32 v93, v93
 v_mfma_f32_16x16x32_bf16 v[40:43], a[224:227], a[4:7], 0
 buffer_store_dwordx4 a[136:139], v10, s[16:19], s52 offen offset:128 nt
 v_mfma_f32_16x16x32_bf16 v[40:43], a[228:231], a[20:23], v[40:43]
 v_fma_f32 v94, v94, s22, v19
 v_fma_f32 v95, v95, s22, v19
 v_mfma_f32_16x16x32_bf16 v[32:35], a[224:227], a[0:3], 0
 ds_read_b128 a[224:227], v1 offset:2048
 v_cvt_pk_bf16_f32 v82, v84, v85
 v_mfma_f32_16x16x32_bf16 v[32:35], a[228:231], a[16:19], v[32:35]
 s_waitcnt lgkmcnt(1)
 ds_read_b128 a[228:231], v1 offset:2560
 v_cvt_pk_bf16_f32 v83, v86, v87
 v_mfma_f32_16x16x32_bf16 v[32:35], a[232:235], a[32:35], v[32:35]
 v_exp_f32 v94, v94
 v_mfma_f32_16x16x32_bf16 v[32:35], a[236:239], a[48:51], v[32:35]
 v_exp_f32 v95, v95
 v_mfma_f32_16x16x32_bf16 v[40:43], a[232:235], a[36:39], v[40:43]
 v_cvt_pk_bf16_f32 v88, v88, v89
 v_cvt_pk_bf16_f32 v89, v90, v91
 v_mfma_f32_16x16x32_bf16 v[40:43], a[236:239], a[52:55], v[40:43]
 v_cvt_pk_bf16_f32 v90, v92, v93
 v_cvt_pk_bf16_f32 v91, v94, v95
 v_mfma_f32_16x16x32_bf16 v[48:51], a[232:235], a[40:43], v[48:51]
 v_mfma_f32_16x16x32_bf16 v[48:51], a[236:239], a[56:59], v[48:51]
 v_mfma_f32_16x16x32_bf16 v[56:59], a[232:235], a[44:47], v[56:59]
 ds_read_b128 a[232:235], v1 offset:8192
 v_mfma_f32_16x16x32_bf16 v[56:59], a[236:239], a[60:63], v[56:59]
 s_waitcnt lgkmcnt(2)
 ds_read_b128 a[236:239], v1 offset:8704
 v_mfma_f32_16x16x32_bf16 v[56:59], a[224:227], a[76:79], v[56:59]
 s_waitcnt lgkmcnt(2)
 v_mfma_f32_16x16x32_bf16 v[56:59], a[228:231], a[92:95], v[56:59]
 v_mfma_f32_16x16x32_bf16 v[48:51], a[224:227], a[72:75], v[48:51]
 v_mfma_f32_16x16x32_bf16 v[48:51], a[228:231], a[88:91], v[48:51]
 v_mfma_f32_16x16x32_bf16 v[40:43], a[224:227], a[68:71], v[40:43]
 v_mfma_f32_16x16x32_bf16 v[40:43], a[228:231], a[84:87], v[40:43]
 v_mfma_f32_16x16x32_bf16 v[32:35], a[224:227], a[64:67], v[32:35]
 ds_read_b128 a[224:227], v1 offset:7168
 v_mfma_f32_16x16x32_bf16 v[32:35], a[228:231], a[80:83], v[32:35]
 s_waitcnt lgkmcnt(2)
 ds_read_b128 a[228:231], v1 offset:7680
 v_mfma_f32_16x16x32_bf16 v[36:39], a[232:235], a[64:67], 0
 s_waitcnt lgkmcnt(2)
 v_mfma_f32_16x16x32_bf16 v[36:39], a[236:239], a[80:83], v[36:39]
 v_mfma_f32_16x16x32_bf16 v[44:47], a[232:235], a[68:71], 0
 v_mfma_f32_16x16x32_bf16 v[44:47], a[236:239], a[84:87], v[44:47]
 v_mfma_f32_16x16x32_bf16 v[52:55], a[232:235], a[72:75], 0
 v_mfma_f32_16x16x32_bf16 v[52:55], a[236:239], a[88:91], v[52:55]
 v_mfma_f32_16x16x32_bf16 v[60:63], a[232:235], a[76:79], 0
 ds_read_b128 a[232:235], v1 offset:6144
 v_fma_f32 v32, v32, s22, v16
 v_mfma_f32_16x16x32_bf16 v[60:63], a[236:239], a[92:95], v[60:63]
 s_waitcnt lgkmcnt(2)
 ds_read_b128 a[236:239], v1 offset:6656
 v_fma_f32 v33, v33, s22, v16
 v_mfma_f32_16x16x32_bf16 v[60:63], a[224:227], a[44:47], v[60:63]
 s_waitcnt lgkmcnt(2)
 v_exp_f32 v32, v32
 v_mfma_f32_16x16x32_bf16 v[60:63], a[228:231], a[60:63], v[60:63]
 v_exp_f32 v33, v33
 v_mfma_f32_16x16x32_bf16 v[52:55], a[224:227], a[40:43], v[52:55]
 v_fma_f32 v34, v34, s22, v16
 v_fma_f32 v35, v35, s22, v16
 v_mfma_f32_16x16x32_bf16 v[52:55], a[228:231], a[56:59], v[52:55]
 v_exp_f32 v34, v34
 v_mfma_f32_16x16x32_bf16 v[44:47], a[224:227], a[36:39], v[44:47]
 v_exp_f32 v35, v35
 v_mfma_f32_16x16x32_bf16 v[44:47], a[228:231], a[52:55], v[44:47]
 v_fma_f32 v40, v40, s22, v17
 v_fma_f32 v41, v41, s22, v17
 v_mfma_f32_16x16x32_bf16 v[36:39], a[224:227], a[32:35], v[36:39]
 ds_read_b64_tr_b16 a[224:225], v3 offset:24576
 v_cvt_pk_bf16_f32 v32, v32, v33
 v_mfma_f32_16x16x32_bf16 v[36:39], a[228:231], a[48:51], v[36:39]
 s_waitcnt lgkmcnt(2)
 ds_read_b64_tr_b16 a[226:227], v3 offset:30720
 v_fma_f32 v42, v42, s22, v17
 v_mfma_f32_16x16x32_bf16 v[36:39], a[232:235], a[0:3], v[36:39]
 s_waitcnt lgkmcnt(2)
 ds_read_b64_tr_b16 a[228:229], v3 offset:24832
 v_fma_f32 v43, v43, s22, v17
 v_mfma_f32_16x16x32_bf16 v[36:39], a[236:239], a[16:19], v[36:39]
 ds_read_b64_tr_b16 a[230:231], v3 offset:30976
 v_cvt_pk_bf16_f32 v33, v34, v35
 v_mfma_f32_16x16x32_bf16 v[44:47], a[232:235], a[4:7], v[44:47]
 v_exp_f32 v40, v40
 v_mfma_f32_16x16x32_bf16 v[44:47], a[236:239], a[20:23], v[44:47]
 v_exp_f32 v41, v41
 v_mfma_f32_16x16x32_bf16 v[52:55], a[232:235], a[8:11], v[52:55]
 v_exp_f32 v42, v42
 v_mfma_f32_16x16x32_bf16 v[52:55], a[236:239], a[24:27], v[52:55]
 v_exp_f32 v43, v43
 v_mfma_f32_16x16x32_bf16 v[60:63], a[232:235], a[12:15], v[60:63]
 ds_read_b64_tr_b16 a[232:233], v3 offset:25088
 v_fma_f32 v36, v36, s22, v16
 v_mfma_f32_16x16x32_bf16 v[60:63], a[236:239], a[28:31], v[60:63]
 ds_read_b64_tr_b16 a[234:235], v3 offset:31232
 v_fma_f32 v37, v37, s22, v16
 v_mfma_f32_16x16x32_bf16 v[28:31], a[240:243], v[64:67], v[28:31]
 ds_read_b64_tr_b16 a[236:237], v3 offset:25344
 v_fma_f32 v38, v38, s22, v16
 v_mfma_f32_16x16x32_bf16 a[244:247], a[240:243], v[72:75], a[244:247]
 s_waitcnt lgkmcnt(4)
 ds_read_b64_tr_b16 a[238:239], v3 offset:31488
 v_fma_f32 v39, v39, s22, v16
 v_mfma_f32_16x16x32_bf16 v[96:99], v[64:67], a[224:227], v[96:99]
 v_exp_f32 v36, v36
 v_mfma_f32_16x16x32_bf16 v[104:107], v[72:75], a[224:227], v[104:107]
 s_waitcnt lgkmcnt(4)
 v_exp_f32 v37, v37
 v_mfma_f32_16x16x32_bf16 v[100:103], v[64:67], a[228:231], v[100:103]
 v_exp_f32 v38, v38
 v_mfma_f32_16x16x32_bf16 v[108:111], v[72:75], a[228:231], v[108:111]
 s_add_u32 m0, s34, 15360
 v_exp_f32 v39, v39
 v_mfma_f32_16x16x32_bf16 a[192:195], v[80:83], a[224:227], a[192:195]
 buffer_load_dwordx4 v5, s[12:15], s54 offen offset:1024 nt lds
 v_mfma_f32_16x16x32_bf16 a[200:203], v[88:91], a[224:227], a[200:203]
 s_add_u32 m0, s34, 16384
 ds_read_b64_tr_b16 a[224:225], v3 offset:25600
 s_add_u32 s20, s20, 12288
 v_mfma_f32_16x16x32_bf16 a[196:199], v[80:83], a[228:231], a[196:199]
 buffer_load_dwordx4 v5, s[12:15], s55 offen offset:1024 nt lds
 v_mfma_f32_16x16x32_bf16 a[204:207], v[88:91], a[228:231], a[204:207]
 ds_read_b64_tr_b16 a[226:227], v3 offset:31744
 v_fma_f32 v44, v44, s22, v17
 v_mfma_f32_16x16x32_bf16 a[248:251], a[240:243], v[80:83], a[248:251]
 ds_read_b64_tr_b16 a[228:229], v3 offset:25856
 v_fma_f32 v45, v45, s22, v17
 v_mfma_f32_16x16x32_bf16 a[252:255], a[240:243], v[88:91], a[252:255]
 s_waitcnt lgkmcnt(3)
 ds_read_b64_tr_b16 a[230:231], v3 offset:32000
 v_fma_f32 v46, v46, s22, v17
 v_mfma_f32_16x16x32_bf16 a[208:211], v[80:83], a[232:235], a[208:211]
 s_waitcnt vmcnt(21)
 s_barrier
 v_fma_f32 v47, v47, s22, v17
 v_mfma_f32_16x16x32_bf16 a[216:219], v[88:91], a[232:235], a[216:219]
 v_exp_f32 v44, v44
 v_mfma_f32_16x16x32_bf16 a[212:215], v[80:83], a[236:239], a[212:215]
 v_exp_f32 v45, v45
 v_mfma_f32_16x16x32_bf16 a[220:223], v[88:91], a[236:239], a[220:223]
 s_add_u32 m0, s21, 0
 s_add_u32 s25, s25, 14080
 v_cvt_pk_bf16_f32 v34, v36, v37
 v_mfma_f32_16x16x32_bf16 v[112:115], v[64:67], a[232:235], v[112:115]
 buffer_load_dwordx4 v4, s[4:7], s20 offen nt lds
 v_mfma_f32_16x16x32_bf16 v[120:123], v[72:75], a[232:235], v[120:123]
 ds_read_b64_tr_b16 a[232:233], v3 offset:26112
 v_cvt_pk_bf16_f32 v35, v38, v39
 v_mfma_f32_16x16x32_bf16 v[116:119], v[64:67], a[236:239], v[116:119]
 ds_read_b64_tr_b16 a[234:235], v3 offset:32256
 v_cvt_pk_bf16_f32 v40, v40, v41
 v_mfma_f32_16x16x32_bf16 v[124:127], v[72:75], a[236:239], v[124:127]
 s_waitcnt lgkmcnt(3)
 ds_read_b64_tr_b16 a[236:237], v3 offset:26368
 v_cvt_pk_bf16_f32 v41, v42, v43
 v_mfma_f32_16x16x32_bf16 v[128:131], v[64:67], a[224:227], v[128:131]
 ds_read_b64_tr_b16 a[238:239], v3 offset:32512
 v_cvt_pk_bf16_f32 v42, v44, v45
 v_mfma_f32_16x16x32_bf16 v[136:139], v[72:75], a[224:227], v[136:139]
 s_waitcnt lgkmcnt(4)
 v_exp_f32 v46, v46
 v_mfma_f32_16x16x32_bf16 v[132:135], v[64:67], a[228:231], v[132:135]
 buffer_load_dwordx4 v5, s[4:7], s20 offen offset:1024 nt lds
 v_mfma_f32_16x16x32_bf16 v[140:143], v[72:75], a[228:231], v[140:143]
 v_exp_f32 v47, v47
 v_mfma_f32_16x16x32_bf16 v[144:147], v[80:83], a[224:227], v[144:147]
 v_cvt_pk_bf16_f32 v43, v46, v47
 v_fma_f32 v48, v48, s22, v18
 v_mfma_f32_16x16x32_bf16 v[152:155], v[88:91], a[224:227], v[152:155]
 ds_read_b64_tr_b16 a[224:225], v3 offset:26624
 v_fma_f32 v49, v49, s22, v18
 v_mfma_f32_16x16x32_bf16 v[148:151], v[80:83], a[228:231], v[148:151]
 ds_read_b64_tr_b16 a[226:227], v3 offset:32768
 v_fma_f32 v50, v50, s22, v18
 v_mfma_f32_16x16x32_bf16 v[156:159], v[88:91], a[228:231], v[156:159]
 s_waitcnt lgkmcnt(4)
 ds_read_b64_tr_b16 a[228:229], v3 offset:26880
 v_fma_f32 v51, v51, s22, v18
 v_mfma_f32_16x16x32_bf16 v[176:179], v[80:83], a[232:235], v[176:179]
 buffer_load_dwordx4 v6, s[4:7], s20 offen offset:2048 nt lds
 ds_read_b64_tr_b16 a[230:231], v3 offset:33024
 v_mfma_f32_16x16x32_bf16 v[184:187], v[88:91], a[232:235], v[184:187]
 s_waitcnt lgkmcnt(4)
 v_exp_f32 v48, v48
 v_mfma_f32_16x16x32_bf16 v[180:183], v[80:83], a[236:239], v[180:183]
 v_exp_f32 v49, v49
 v_mfma_f32_16x16x32_bf16 v[188:191], v[88:91], a[236:239], v[188:191]
 v_exp_f32 v50, v50
 v_mfma_f32_16x16x32_bf16 v[160:163], v[64:67], a[232:235], v[160:163]
 v_exp_f32 v51, v51
 v_mfma_f32_16x16x32_bf16 v[168:171], v[72:75], a[232:235], v[168:171]
 s_add_u32 m0, s21, 110592
 ds_read_b64_tr_b16 a[232:233], v3 offset:27136
 v_fma_f32 v52, v52, s22, v18
 v_mfma_f32_16x16x32_bf16 v[164:167], v[64:67], a[236:239], v[164:167]
 buffer_load_dwordx4 v8, s[8:11], s25 offen lds
 ds_read_b64_tr_b16 a[234:235], v3 offset:33280
 v_mfma_f32_16x16x32_bf16 v[172:175], v[72:75], a[236:239], v[172:175]
 s_waitcnt lgkmcnt(3)
 ds_read_b64_tr_b16 a[236:237], v3 offset:27392
 s_sub_u32 s25, s25, 896
 v_mfma_f32_16x16x32_bf16 v[192:195], v[64:67], a[224:227], v[192:195]
 ds_read_b64_tr_b16 a[238:239], v3 offset:33536
 v_fma_f32 v53, v53, s22, v18
 v_mfma_f32_16x16x32_bf16 v[200:203], v[72:75], a[224:227], v[200:203]
 s_waitcnt lgkmcnt(4)
 v_exp_f32 v52, v52
 v_mfma_f32_16x16x32_bf16 v[196:199], v[64:67], a[228:231], v[196:199]
 v_exp_f32 v53, v53
 v_mfma_f32_16x16x32_bf16 v[204:207], v[72:75], a[228:231], v[204:207]
 v_fma_f32 v54, v54, s22, v18
 v_fma_f32 v55, v55, s22, v18
 v_mfma_f32_16x16x32_bf16 v[208:211], v[80:83], a[224:227], v[208:211]
 buffer_load_dwordx4 v8, s[8:11], s25 offen offset:1024 lds
 v_mfma_f32_16x16x32_bf16 v[216:219], v[88:91], a[224:227], v[216:219]
 s_sub_u32 s25, s25, 896
 ds_read_b128 a[224:227], v1 offset:12288
 v_fma_f32 v56, v56, s22, v19
 v_mfma_f32_16x16x32_bf16 v[212:215], v[80:83], a[228:231], v[212:215]
 v_exp_f32 v54, v54
 v_mfma_f32_16x16x32_bf16 v[220:223], v[88:91], a[228:231], v[220:223]
 s_waitcnt lgkmcnt(3)
 ds_read_b128 a[228:231], v1 offset:12800
 v_fma_f32 v57, v57, s22, v19
 v_mfma_f32_16x16x32_bf16 v[240:243], v[80:83], a[232:235], v[240:243]
 v_exp_f32 v55, v55
 v_mfma_f32_16x16x32_bf16 v[248:251], v[88:91], a[232:235], v[248:251]
 s_waitcnt lgkmcnt(2)
 v_exp_f32 v56, v56
 v_mfma_f32_16x16x32_bf16 v[244:247], v[80:83], a[236:239], v[244:247]
 buffer_load_dwordx4 v8, s[8:11], s25 offen offset:2048 lds
 v_mfma_f32_16x16x32_bf16 v[252:255], v[88:91], a[236:239], v[252:255]
 v_exp_f32 v57, v57
 v_mfma_f32_16x16x32_bf16 v[224:227], v[64:67], a[232:235], v[224:227]
 v_cvt_pk_bf16_f32 v48, v48, v49
 v_fma_f32 v58, v58, s22, v19
 v_mfma_f32_16x16x32_bf16 v[232:235], v[72:75], a[232:235], v[232:235]
 ds_read_b128 a[232:235], v1 offset:13312
 v_fma_f32 v59, v59, s22, v19
 v_mfma_f32_16x16x32_bf16 v[228:231], v[64:67], a[236:239], v[228:231]
 v_exp_f32 v58, v58
 v_mfma_f32_16x16x32_bf16 v[236:239], v[72:75], a[236:239], v[236:239]
 s_waitcnt lgkmcnt(2)
 ds_read_b128 a[236:239], v1 offset:13824
 v_cvt_pk_bf16_f32 v49, v50, v51
 v_mfma_f32_16x16x32_bf16 v[88:91], a[224:227], a[12:15], 0
 s_waitcnt lgkmcnt(2)
 v_exp_f32 v59, v59
 v_mfma_f32_16x16x32_bf16 v[88:91], a[228:231], a[28:31], v[88:91]
 v_fma_f32 v60, v60, s22, v19
 v_fma_f32 v61, v61, s22, v19
 v_mfma_f32_16x16x32_bf16 v[80:83], a[224:227], a[8:11], 0
 v_exp_f32 v60, v60
 v_mfma_f32_16x16x32_bf16 v[80:83], a[228:231], a[24:27], v[80:83]
 v_exp_f32 v61, v61
 v_mfma_f32_16x16x32_bf16 v[72:75], a[224:227], a[4:7], 0
 buffer_store_dwordx4 a[140:143], v10, s[16:19], s53 offen offset:128 nt
 v_mfma_f32_16x16x32_bf16 v[72:75], a[228:231], a[20:23], v[72:75]
 v_fma_f32 v62, v62, s22, v19
 v_fma_f32 v63, v63, s22, v19
 v_mfma_f32_16x16x32_bf16 v[64:67], a[224:227], a[0:3], 0
 ds_read_b128 a[224:227], v1 offset:14336
 v_cvt_pk_bf16_f32 v50, v52, v53
 v_mfma_f32_16x16x32_bf16 v[64:67], a[228:231], a[16:19], v[64:67]
 s_waitcnt lgkmcnt(1)
 ds_read_b128 a[228:231], v1 offset:14848
 v_cvt_pk_bf16_f32 v51, v54, v55
 v_mfma_f32_16x16x32_bf16 v[64:67], a[232:235], a[32:35], v[64:67]
 v_exp_f32 v62, v62
 v_mfma_f32_16x16x32_bf16 v[64:67], a[236:239], a[48:51], v[64:67]
 v_exp_f32 v63, v63
 v_mfma_f32_16x16x32_bf16 v[72:75], a[232:235], a[36:39], v[72:75]
 v_cvt_pk_bf16_f32 v56, v56, v57
 v_cvt_pk_bf16_f32 v57, v58, v59
 v_mfma_f32_16x16x32_bf16 v[72:75], a[236:239], a[52:55], v[72:75]
 v_cvt_pk_bf16_f32 v58, v60, v61
 v_cvt_pk_bf16_f32 v59, v62, v63
 v_mfma_f32_16x16x32_bf16 v[80:83], a[232:235], a[40:43], v[80:83]
 v_mfma_f32_16x16x32_bf16 v[80:83], a[236:239], a[56:59], v[80:83]
 v_mfma_f32_16x16x32_bf16 v[88:91], a[232:235], a[44:47], v[88:91]
 ds_read_b128 a[232:235], v1 offset:20480
 v_mfma_f32_16x16x32_bf16 v[88:91], a[236:239], a[60:63], v[88:91]
 s_waitcnt lgkmcnt(2)
 ds_read_b128 a[236:239], v1 offset:20992
 v_mfma_f32_16x16x32_bf16 v[88:91], a[224:227], a[76:79], v[88:91]
 s_waitcnt lgkmcnt(2)
 v_mfma_f32_16x16x32_bf16 v[88:91], a[228:231], a[92:95], v[88:91]
 v_mfma_f32_16x16x32_bf16 v[80:83], a[224:227], a[72:75], v[80:83]
 v_mfma_f32_16x16x32_bf16 v[80:83], a[228:231], a[88:91], v[80:83]
 v_mfma_f32_16x16x32_bf16 v[72:75], a[224:227], a[68:71], v[72:75]
 v_mfma_f32_16x16x32_bf16 v[72:75], a[228:231], a[84:87], v[72:75]
 v_mfma_f32_16x16x32_bf16 v[64:67], a[224:227], a[64:67], v[64:67]
 ds_read_b128 a[224:227], v1 offset:19456
 v_mfma_f32_16x16x32_bf16 v[64:67], a[228:231], a[80:83], v[64:67]
 s_waitcnt lgkmcnt(2)
 ds_read_b128 a[228:231], v1 offset:19968
 v_mfma_f32_16x16x32_bf16 v[68:71], a[232:235], a[64:67], 0
 s_waitcnt lgkmcnt(2)
 v_mfma_f32_16x16x32_bf16 v[68:71], a[236:239], a[80:83], v[68:71]
 v_mfma_f32_16x16x32_bf16 v[76:79], a[232:235], a[68:71], 0
 v_mfma_f32_16x16x32_bf16 v[76:79], a[236:239], a[84:87], v[76:79]
 v_mfma_f32_16x16x32_bf16 v[84:87], a[232:235], a[72:75], 0
 v_mfma_f32_16x16x32_bf16 v[84:87], a[236:239], a[88:91], v[84:87]
 v_mfma_f32_16x16x32_bf16 v[92:95], a[232:235], a[76:79], 0
 ds_read_b128 a[232:235], v1 offset:18432
 v_fma_f32 v64, v64, s22, v16
 v_mfma_f32_16x16x32_bf16 v[92:95], a[236:239], a[92:95], v[92:95]
 s_waitcnt lgkmcnt(2)
 ds_read_b128 a[236:239], v1 offset:18944
 v_fma_f32 v65, v65, s22, v16
 v_mfma_f32_16x16x32_bf16 v[92:95], a[224:227], a[44:47], v[92:95]
 s_waitcnt lgkmcnt(2)
 v_exp_f32 v64, v64
 v_mfma_f32_16x16x32_bf16 v[92:95], a[228:231], a[60:63], v[92:95]
 v_exp_f32 v65, v65
 v_mfma_f32_16x16x32_bf16 v[84:87], a[224:227], a[40:43], v[84:87]
 v_fma_f32 v66, v66, s22, v16
 v_fma_f32 v67, v67, s22, v16
 v_mfma_f32_16x16x32_bf16 v[84:87], a[228:231], a[56:59], v[84:87]
 v_exp_f32 v66, v66
 v_mfma_f32_16x16x32_bf16 v[76:79], a[224:227], a[36:39], v[76:79]
 v_exp_f32 v67, v67
 v_mfma_f32_16x16x32_bf16 v[76:79], a[228:231], a[52:55], v[76:79]
 v_fma_f32 v72, v72, s22, v17
 v_fma_f32 v73, v73, s22, v17
 v_mfma_f32_16x16x32_bf16 v[68:71], a[224:227], a[32:35], v[68:71]
 ds_read_b64_tr_b16 a[224:225], v3 offset:0
 v_cvt_pk_bf16_f32 v64, v64, v65
 v_mfma_f32_16x16x32_bf16 v[68:71], a[228:231], a[48:51], v[68:71]
 s_waitcnt lgkmcnt(2)
 ds_read_b64_tr_b16 a[226:227], v3 offset:6144
 v_fma_f32 v74, v74, s22, v17
 v_mfma_f32_16x16x32_bf16 v[68:71], a[232:235], a[0:3], v[68:71]
 s_waitcnt lgkmcnt(2)
 ds_read_b64_tr_b16 a[228:229], v3 offset:256
 v_fma_f32 v75, v75, s22, v17
 v_mfma_f32_16x16x32_bf16 v[68:71], a[236:239], a[16:19], v[68:71]
 ds_read_b64_tr_b16 a[230:231], v3 offset:6400
 v_cvt_pk_bf16_f32 v65, v66, v67
 v_mfma_f32_16x16x32_bf16 v[76:79], a[232:235], a[4:7], v[76:79]
 s_waitcnt vmcnt(42)
 ds_read_b128 a[96:99], v11 offset:24576
 ds_read_b128 a[100:103], v11 offset:25088
 v_mfma_f32_16x16x32_bf16 v[76:79], a[236:239], a[20:23], v[76:79]
 v_exp_f32 v72, v72
 v_mfma_f32_16x16x32_bf16 v[84:87], a[232:235], a[8:11], v[84:87]
 v_exp_f32 v73, v73
 v_mfma_f32_16x16x32_bf16 v[84:87], a[236:239], a[24:27], v[84:87]
 v_exp_f32 v74, v74
 v_mfma_f32_16x16x32_bf16 v[92:95], a[232:235], a[12:15], v[92:95]
 ds_read_b64_tr_b16 a[232:233], v3 offset:512
 v_fma_f32 v68, v68, s22, v16
 v_mfma_f32_16x16x32_bf16 v[92:95], a[236:239], a[28:31], v[92:95]
 ds_read_b64_tr_b16 a[234:235], v3 offset:6656
 v_fma_f32 v69, v69, s22, v16
 v_mfma_f32_16x16x32_bf16 v[28:31], a[240:243], v[32:35], v[28:31]
 ds_read_b64_tr_b16 a[236:237], v3 offset:768
 v_fma_f32 v70, v70, s22, v16
 v_mfma_f32_16x16x32_bf16 a[244:247], a[240:243], v[40:43], a[244:247]
 s_waitcnt lgkmcnt(6)
 ds_read_b64_tr_b16 a[238:239], v3 offset:6912
 v_fma_f32 v71, v71, s22, v16
 v_mfma_f32_16x16x32_bf16 v[96:99], v[32:35], a[224:227], v[96:99]
 v_exp_f32 v68, v68
 v_mfma_f32_16x16x32_bf16 v[104:107], v[40:43], a[224:227], v[104:107]
 s_waitcnt lgkmcnt(4)
 v_exp_f32 v69, v69
 v_mfma_f32_16x16x32_bf16 v[100:103], v[32:35], a[228:231], v[100:103]
 v_exp_f32 v70, v70
 v_mfma_f32_16x16x32_bf16 v[108:111], v[40:43], a[228:231], v[108:111]
 s_add_u32 m0, s34, 23552
 v_exp_f32 v71, v71
 v_mfma_f32_16x16x32_bf16 a[192:195], v[48:51], a[224:227], a[192:195]
 buffer_load_dwordx4 v5, s[12:15], s56 offen offset:1024 nt lds
 v_mfma_f32_16x16x32_bf16 a[200:203], v[56:59], a[224:227], a[200:203]
 s_add_u32 m0, s34, 24576
 ds_read_b64_tr_b16 a[224:225], v3 offset:1024
 s_add_u32 s25, s25, 14080
 v_mfma_f32_16x16x32_bf16 a[196:199], v[48:51], a[228:231], a[196:199]
 buffer_load_dwordx4 v5, s[12:15], s57 offen offset:1024 nt lds
 v_mfma_f32_16x16x32_bf16 a[204:207], v[56:59], a[228:231], a[204:207]
 ds_read_b64_tr_b16 a[226:227], v3 offset:7168
 v_fma_f32 v76, v76, s22, v17
 v_mfma_f32_16x16x32_bf16 a[248:251], a[240:243], v[48:51], a[248:251]
 ds_read_b64_tr_b16 a[228:229], v3 offset:1280
 v_fma_f32 v77, v77, s22, v17
 v_mfma_f32_16x16x32_bf16 a[252:255], a[240:243], v[56:59], a[252:255]
 s_waitcnt lgkmcnt(3)
 ds_read_b64_tr_b16 a[230:231], v3 offset:7424
 v_fma_f32 v78, v78, s22, v17
 v_mfma_f32_16x16x32_bf16 a[208:211], v[48:51], a[232:235], a[208:211]
 s_waitcnt vmcnt(21)
 s_barrier
 v_fma_f32 v79, v79, s22, v17
 v_mfma_f32_16x16x32_bf16 a[216:219], v[56:59], a[232:235], a[216:219]
 v_exp_f32 v75, v75
 v_mfma_f32_16x16x32_bf16 a[212:215], v[48:51], a[236:239], a[212:215]
 v_exp_f32 v76, v76
 v_mfma_f32_16x16x32_bf16 a[220:223], v[56:59], a[236:239], a[220:223]
 s_add_u32 m0, s21, 61440
 v_exp_f32 v77, v77
 v_mfma_f32_16x16x32_bf16 v[112:115], v[32:35], a[232:235], v[112:115]
 buffer_load_dwordx4 v8, s[8:11], s25 offen nt lds
 v_mfma_f32_16x16x32_bf16 v[120:123], v[40:43], a[232:235], v[120:123]
 s_sub_u32 s25, s25, 896
 ds_read_b64_tr_b16 a[232:233], v3 offset:1536
 v_cvt_pk_bf16_f32 v66, v68, v69
 v_mfma_f32_16x16x32_bf16 v[116:119], v[32:35], a[236:239], v[116:119]
 ds_read_b64_tr_b16 a[234:235], v3 offset:7680
 v_cvt_pk_bf16_f32 v67, v70, v71
 v_mfma_f32_16x16x32_bf16 v[124:127], v[40:43], a[236:239], v[124:127]
 s_waitcnt lgkmcnt(3)
 ds_read_b64_tr_b16 a[236:237], v3 offset:1792
 v_cvt_pk_bf16_f32 v72, v72, v73
 v_mfma_f32_16x16x32_bf16 v[128:131], v[32:35], a[224:227], v[128:131]
 ds_read_b64_tr_b16 a[238:239], v3 offset:7936
 v_cvt_pk_bf16_f32 v73, v74, v75
 v_mfma_f32_16x16x32_bf16 v[136:139], v[40:43], a[224:227], v[136:139]
 s_waitcnt lgkmcnt(4)
 v_exp_f32 v78, v78
 v_mfma_f32_16x16x32_bf16 v[132:135], v[32:35], a[228:231], v[132:135]
 buffer_load_dwordx4 v8, s[8:11], s25 offen offset:1024 nt lds
 v_mfma_f32_16x16x32_bf16 v[140:143], v[40:43], a[228:231], v[140:143]
 s_sub_u32 s25, s25, 896
 v_exp_f32 v79, v79
 v_mfma_f32_16x16x32_bf16 v[144:147], v[48:51], a[224:227], v[144:147]
 v_cvt_pk_bf16_f32 v74, v76, v77
 v_cvt_pk_bf16_f32 v75, v78, v79
 v_mfma_f32_16x16x32_bf16 v[152:155], v[56:59], a[224:227], v[152:155]
 ds_read_b64_tr_b16 a[224:225], v3 offset:2048
 v_fma_f32 v80, v80, s22, v18
 v_mfma_f32_16x16x32_bf16 v[148:151], v[48:51], a[228:231], v[148:151]
 ds_read_b64_tr_b16 a[226:227], v3 offset:8192
 v_fma_f32 v81, v81, s22, v18
 v_mfma_f32_16x16x32_bf16 v[156:159], v[56:59], a[228:231], v[156:159]
 s_waitcnt lgkmcnt(4)
 ds_read_b64_tr_b16 a[228:229], v3 offset:2304
 v_fma_f32 v82, v82, s22, v18
 v_mfma_f32_16x16x32_bf16 v[176:179], v[48:51], a[232:235], v[176:179]
 buffer_load_dwordx4 v8, s[8:11], s25 offen offset:2048 nt lds
 ds_read_b64_tr_b16 a[230:231], v3 offset:8448
 v_mfma_f32_16x16x32_bf16 v[184:187], v[56:59], a[232:235], v[184:187]
 s_waitcnt lgkmcnt(4)
 v_exp_f32 v80, v80
 v_mfma_f32_16x16x32_bf16 v[180:183], v[48:51], a[236:239], v[180:183]
 v_exp_f32 v81, v81
 v_mfma_f32_16x16x32_bf16 v[188:191], v[56:59], a[236:239], v[188:191]
 v_exp_f32 v82, v82
 v_mfma_f32_16x16x32_bf16 v[160:163], v[32:35], a[232:235], v[160:163]
 v_fma_f32 v83, v83, s22, v18
 v_fma_f32 v84, v84, s22, v18
 v_mfma_f32_16x16x32_bf16 v[168:171], v[40:43], a[232:235], v[168:171]
 ds_read_b64_tr_b16 a[232:233], v3 offset:2560
 v_fma_f32 v85, v85, s22, v18
 v_mfma_f32_16x16x32_bf16 v[164:167], v[32:35], a[236:239], v[164:167]
 ds_read_b64_tr_b16 a[234:235], v3 offset:8704
 v_fma_f32 v86, v86, s22, v18
 v_mfma_f32_16x16x32_bf16 v[172:175], v[40:43], a[236:239], v[172:175]
 s_waitcnt lgkmcnt(4)
 ds_read_b64_tr_b16 a[236:237], v3 offset:2816
 v_fma_f32 v87, v87, s22, v18
 v_mfma_f32_16x16x32_bf16 v[192:195], v[32:35], a[224:227], v[192:195]
 ds_read_b64_tr_b16 a[238:239], v3 offset:8960
 v_fma_f32 v88, v88, s22, v19
 v_mfma_f32_16x16x32_bf16 v[200:203], v[40:43], a[224:227], v[200:203]
 s_waitcnt lgkmcnt(4)
 v_exp_f32 v83, v83
 v_mfma_f32_16x16x32_bf16 v[196:199], v[32:35], a[228:231], v[196:199]
 v_exp_f32 v84, v84
 v_mfma_f32_16x16x32_bf16 v[204:207], v[40:43], a[228:231], v[204:207]
 v_exp_f32 v85, v85
 v_mfma_f32_16x16x32_bf16 v[208:211], v[48:51], a[224:227], v[208:211]
 v_exp_f32 v86, v86
 v_mfma_f32_16x16x32_bf16 v[216:219], v[56:59], a[224:227], v[216:219]
 ds_read_b128 a[224:227], v1 offset:24576
 v_fma_f32 v89, v89, s22, v19
 v_mfma_f32_16x16x32_bf16 v[212:215], v[48:51], a[228:231], v[212:215]
 v_exp_f32 v87, v87
 v_mfma_f32_16x16x32_bf16 v[220:223], v[56:59], a[228:231], v[220:223]
 s_waitcnt lgkmcnt(3)
 ds_read_b128 a[228:231], v1 offset:25088
 v_cvt_pk_bf16_f32 v80, v80, v81
 v_mfma_f32_16x16x32_bf16 v[240:243], v[48:51], a[232:235], v[240:243]
 v_exp_f32 v88, v88
 v_mfma_f32_16x16x32_bf16 v[248:251], v[56:59], a[232:235], v[248:251]
 s_waitcnt lgkmcnt(2)
 v_exp_f32 v89, v89
 v_mfma_f32_16x16x32_bf16 v[244:247], v[48:51], a[236:239], v[244:247]
 v_fma_f32 v90, v90, s22, v19
 v_fma_f32 v91, v91, s22, v19
 v_mfma_f32_16x16x32_bf16 v[252:255], v[56:59], a[236:239], v[252:255]
 v_exp_f32 v90, v90
 v_mfma_f32_16x16x32_bf16 v[224:227], v[32:35], a[232:235], v[224:227]
 v_exp_f32 v91, v91
 v_mfma_f32_16x16x32_bf16 v[232:235], v[40:43], a[232:235], v[232:235]
 ds_read_b128 a[232:235], v1 offset:25600
 v_cvt_pk_bf16_f32 v81, v82, v83
 v_mfma_f32_16x16x32_bf16 v[228:231], v[32:35], a[236:239], v[228:231]
 v_fma_f32 v92, v92, s22, v19
 v_fma_f32 v93, v93, s22, v19
 v_mfma_f32_16x16x32_bf16 v[236:239], v[40:43], a[236:239], v[236:239]
 s_waitcnt lgkmcnt(2)
 ds_read_b128 a[236:239], v1 offset:26112
 v_fma_f32 v94, v94, s22, v19
 v_mfma_f32_16x16x32_bf16 v[56:59], a[224:227], a[12:15], 0
 s_waitcnt lgkmcnt(2)
 v_exp_f32 v92, v92
 v_mfma_f32_16x16x32_bf16 v[56:59], a[228:231], a[28:31], v[56:59]
 v_exp_f32 v93, v93
 v_mfma_f32_16x16x32_bf16 v[48:51], a[224:227], a[8:11], 0
 v_exp_f32 v94, v94
 v_mfma_f32_16x16x32_bf16 v[48:51], a[228:231], a[24:27], v[48:51]
 v_fma_f32 v95, v95, s22, v19
 v_cvt_pk_bf16_f32 v82, v84, v85
 v_mfma_f32_16x16x32_bf16 v[40:43], a[224:227], a[4:7], 0
 buffer_store_dwordx4 a[144:147], v10, s[16:19], s54 offen offset:128 nt
 v_mfma_f32_16x16x32_bf16 v[40:43], a[228:231], a[20:23], v[40:43]
 v_exp_f32 v95, v95
 v_mfma_f32_16x16x32_bf16 v[32:35], a[224:227], a[0:3], 0
 ds_read_b128 a[224:227], v1 offset:26624
 v_cvt_pk_bf16_f32 v83, v86, v87
 v_mfma_f32_16x16x32_bf16 v[32:35], a[228:231], a[16:19], v[32:35]
 s_waitcnt lgkmcnt(1)
 ds_read_b128 a[228:231], v1 offset:27136
 v_cvt_pk_bf16_f32 v88, v88, v89
 v_mfma_f32_16x16x32_bf16 v[32:35], a[232:235], a[32:35], v[32:35]
 v_cvt_pk_bf16_f32 v89, v90, v91
 v_cvt_pk_bf16_f32 v90, v92, v93
 v_mfma_f32_16x16x32_bf16 v[32:35], a[236:239], a[48:51], v[32:35]
 v_cvt_pk_bf16_f32 v91, v94, v95
 v_mfma_f32_16x16x32_bf16 v[40:43], a[232:235], a[36:39], v[40:43]
 v_mfma_f32_16x16x32_bf16 v[40:43], a[236:239], a[52:55], v[40:43]
 v_mfma_f32_16x16x32_bf16 v[48:51], a[232:235], a[40:43], v[48:51]
 v_mfma_f32_16x16x32_bf16 v[48:51], a[236:239], a[56:59], v[48:51]
 v_mfma_f32_16x16x32_bf16 v[56:59], a[232:235], a[44:47], v[56:59]
 ds_read_b128 a[232:235], v1 offset:32768
 v_mfma_f32_16x16x32_bf16 v[56:59], a[236:239], a[60:63], v[56:59]
 s_waitcnt lgkmcnt(2)
 ds_read_b128 a[236:239], v1 offset:33280
 v_mfma_f32_16x16x32_bf16 v[56:59], a[224:227], a[76:79], v[56:59]
 s_waitcnt lgkmcnt(2)
 v_mfma_f32_16x16x32_bf16 v[56:59], a[228:231], a[92:95], v[56:59]
 v_mfma_f32_16x16x32_bf16 v[48:51], a[224:227], a[72:75], v[48:51]
 v_mfma_f32_16x16x32_bf16 v[48:51], a[228:231], a[88:91], v[48:51]
 v_mfma_f32_16x16x32_bf16 v[40:43], a[224:227], a[68:71], v[40:43]
 v_mfma_f32_16x16x32_bf16 v[40:43], a[228:231], a[84:87], v[40:43]
 v_mfma_f32_16x16x32_bf16 v[32:35], a[224:227], a[64:67], v[32:35]
 ds_read_b128 a[224:227], v1 offset:31744
 v_mfma_f32_16x16x32_bf16 v[32:35], a[228:231], a[80:83], v[32:35]
 s_waitcnt lgkmcnt(2)
 ds_read_b128 a[228:231], v1 offset:32256
 v_mfma_f32_16x16x32_bf16 v[36:39], a[232:235], a[64:67], 0
 s_waitcnt lgkmcnt(2)
 v_mfma_f32_16x16x32_bf16 v[36:39], a[236:239], a[80:83], v[36:39]
 v_mfma_f32_16x16x32_bf16 v[44:47], a[232:235], a[68:71], 0
 v_mfma_f32_16x16x32_bf16 v[44:47], a[236:239], a[84:87], v[44:47]
 v_mfma_f32_16x16x32_bf16 v[52:55], a[232:235], a[72:75], 0
 v_mfma_f32_16x16x32_bf16 v[52:55], a[236:239], a[88:91], v[52:55]
 v_mfma_f32_16x16x32_bf16 v[60:63], a[232:235], a[76:79], 0
 ds_read_b128 a[232:235], v1 offset:30720
 v_fma_f32 v32, v32, s22, v16
 v_mfma_f32_16x16x32_bf16 v[60:63], a[236:239], a[92:95], v[60:63]
 s_waitcnt lgkmcnt(2)
 ds_read_b128 a[236:239], v1 offset:31232
 v_fma_f32 v33, v33, s22, v16
 v_mfma_f32_16x16x32_bf16 v[60:63], a[224:227], a[44:47], v[60:63]
 s_waitcnt lgkmcnt(2)
 v_exp_f32 v32, v32
 v_mfma_f32_16x16x32_bf16 v[60:63], a[228:231], a[60:63], v[60:63]
 v_exp_f32 v33, v33
 v_mfma_f32_16x16x32_bf16 v[52:55], a[224:227], a[40:43], v[52:55]
 v_fma_f32 v34, v34, s22, v16
 v_fma_f32 v35, v35, s22, v16
 v_mfma_f32_16x16x32_bf16 v[52:55], a[228:231], a[56:59], v[52:55]
 v_exp_f32 v34, v34
 v_mfma_f32_16x16x32_bf16 v[44:47], a[224:227], a[36:39], v[44:47]
 v_exp_f32 v35, v35
 v_mfma_f32_16x16x32_bf16 v[44:47], a[228:231], a[52:55], v[44:47]
 v_fma_f32 v40, v40, s22, v17
 v_fma_f32 v41, v41, s22, v17
 v_mfma_f32_16x16x32_bf16 v[36:39], a[224:227], a[32:35], v[36:39]
 ds_read_b64_tr_b16 a[224:225], v3 offset:12288
 v_cvt_pk_bf16_f32 v32, v32, v33
 v_mfma_f32_16x16x32_bf16 v[36:39], a[228:231], a[48:51], v[36:39]
 s_waitcnt lgkmcnt(2)
 ds_read_b64_tr_b16 a[226:227], v3 offset:18432
 v_fma_f32 v42, v42, s22, v17
 v_mfma_f32_16x16x32_bf16 v[36:39], a[232:235], a[0:3], v[36:39]
 s_waitcnt lgkmcnt(2)
 ds_read_b64_tr_b16 a[228:229], v3 offset:12544
 v_fma_f32 v43, v43, s22, v17
 v_mfma_f32_16x16x32_bf16 v[36:39], a[236:239], a[16:19], v[36:39]
 ds_read_b64_tr_b16 a[230:231], v3 offset:18688
 v_cvt_pk_bf16_f32 v33, v34, v35
 v_mfma_f32_16x16x32_bf16 v[44:47], a[232:235], a[4:7], v[44:47]
 s_waitcnt vmcnt(40)
 ds_read_b128 a[104:107], v11 offset:32768
 ds_read_b128 a[108:111], v11 offset:33280
 v_mfma_f32_16x16x32_bf16 v[44:47], a[236:239], a[20:23], v[44:47]
 v_exp_f32 v40, v40
 v_mfma_f32_16x16x32_bf16 v[52:55], a[232:235], a[8:11], v[52:55]
 v_exp_f32 v41, v41
 v_mfma_f32_16x16x32_bf16 v[52:55], a[236:239], a[24:27], v[52:55]
 v_exp_f32 v42, v42
 v_mfma_f32_16x16x32_bf16 v[60:63], a[232:235], a[12:15], v[60:63]
 ds_read_b64_tr_b16 a[232:233], v3 offset:12800
 v_fma_f32 v36, v36, s22, v16
 v_mfma_f32_16x16x32_bf16 v[60:63], a[236:239], a[28:31], v[60:63]
 ds_read_b64_tr_b16 a[234:235], v3 offset:18944
 v_fma_f32 v37, v37, s22, v16
 v_mfma_f32_16x16x32_bf16 v[28:31], a[240:243], v[64:67], v[28:31]
 ds_read_b64_tr_b16 a[236:237], v3 offset:13056
 v_fma_f32 v38, v38, s22, v16
 v_mfma_f32_16x16x32_bf16 a[244:247], a[240:243], v[72:75], a[244:247]
 s_waitcnt lgkmcnt(6)
 ds_read_b64_tr_b16 a[238:239], v3 offset:19200
 v_fma_f32 v39, v39, s22, v16
 v_mfma_f32_16x16x32_bf16 v[96:99], v[64:67], a[224:227], v[96:99]
 v_exp_f32 v36, v36
 v_mfma_f32_16x16x32_bf16 v[104:107], v[72:75], a[224:227], v[104:107]
 s_waitcnt lgkmcnt(4)
 v_exp_f32 v37, v37
 v_mfma_f32_16x16x32_bf16 v[100:103], v[64:67], a[228:231], v[100:103]
 v_exp_f32 v38, v38
 v_mfma_f32_16x16x32_bf16 v[108:111], v[72:75], a[228:231], v[108:111]
 s_add_u32 m0, s34, 30720
 v_exp_f32 v39, v39
 v_mfma_f32_16x16x32_bf16 a[192:195], v[80:83], a[224:227], a[192:195]
 buffer_load_dwordx4 v6, s[12:15], s50 offen offset:2048 nt lds
 v_mfma_f32_16x16x32_bf16 a[200:203], v[88:91], a[224:227], a[200:203]
 s_add_u32 m0, s34, 31744
 ds_read_b64_tr_b16 a[224:225], v3 offset:13312
 s_add_u32 s20, s20, 12288
 v_mfma_f32_16x16x32_bf16 a[196:199], v[80:83], a[228:231], a[196:199]
 buffer_load_dwordx4 v6, s[12:15], s51 offen offset:2048 nt lds
 v_mfma_f32_16x16x32_bf16 a[204:207], v[88:91], a[228:231], a[204:207]
 ds_read_b64_tr_b16 a[226:227], v3 offset:19456
 v_fma_f32 v44, v44, s22, v17
 v_mfma_f32_16x16x32_bf16 a[248:251], a[240:243], v[80:83], a[248:251]
 ds_read_b64_tr_b16 a[228:229], v3 offset:13568
 v_fma_f32 v45, v45, s22, v17
 v_mfma_f32_16x16x32_bf16 a[252:255], a[240:243], v[88:91], a[252:255]
 s_waitcnt lgkmcnt(3)
 ds_read_b64_tr_b16 a[230:231], v3 offset:19712
 v_fma_f32 v46, v46, s22, v17
 v_mfma_f32_16x16x32_bf16 a[208:211], v[80:83], a[232:235], a[208:211]
 s_waitcnt vmcnt(18)
 s_barrier
 v_fma_f32 v47, v47, s22, v17
 v_mfma_f32_16x16x32_bf16 a[216:219], v[88:91], a[232:235], a[216:219]
 v_exp_f32 v43, v43
 v_mfma_f32_16x16x32_bf16 a[212:215], v[80:83], a[236:239], a[212:215]
 v_exp_f32 v44, v44
 v_mfma_f32_16x16x32_bf16 a[220:223], v[88:91], a[236:239], a[220:223]
 s_add_u32 m0, s21, 12288
 s_add_u32 s25, s25, 14080
 v_cvt_pk_bf16_f32 v34, v36, v37
 v_mfma_f32_16x16x32_bf16 v[112:115], v[64:67], a[232:235], v[112:115]
 buffer_load_dwordx4 v4, s[4:7], s20 offen lds
 v_mfma_f32_16x16x32_bf16 v[120:123], v[72:75], a[232:235], v[120:123]
 ds_read_b64_tr_b16 a[232:233], v3 offset:13824
 v_cvt_pk_bf16_f32 v35, v38, v39
 v_mfma_f32_16x16x32_bf16 v[116:119], v[64:67], a[236:239], v[116:119]
 ds_read_b64_tr_b16 a[234:235], v3 offset:19968
 v_cvt_pk_bf16_f32 v40, v40, v41
 v_mfma_f32_16x16x32_bf16 v[124:127], v[72:75], a[236:239], v[124:127]
 s_waitcnt lgkmcnt(3)
 ds_read_b64_tr_b16 a[236:237], v3 offset:14080
 v_cvt_pk_bf16_f32 v41, v42, v43
 v_mfma_f32_16x16x32_bf16 v[128:131], v[64:67], a[224:227], v[128:131]
 ds_read_b64_tr_b16 a[238:239], v3 offset:20224
 v_fma_f32 v48, v48, s22, v18
 v_mfma_f32_16x16x32_bf16 v[136:139], v[72:75], a[224:227], v[136:139]
 s_waitcnt lgkmcnt(4)
 v_exp_f32 v45, v45
 v_mfma_f32_16x16x32_bf16 v[132:135], v[64:67], a[228:231], v[132:135]
 buffer_load_dwordx4 v5, s[4:7], s20 offen offset:1024 lds
 v_mfma_f32_16x16x32_bf16 v[140:143], v[72:75], a[228:231], v[140:143]
 v_exp_f32 v46, v46
 v_mfma_f32_16x16x32_bf16 v[144:147], v[80:83], a[224:227], v[144:147]
 v_exp_f32 v47, v47
 v_mfma_f32_16x16x32_bf16 v[152:155], v[88:91], a[224:227], v[152:155]
 ds_read_b64_tr_b16 a[224:225], v3 offset:14336
 v_cvt_pk_bf16_f32 v42, v44, v45
 v_mfma_f32_16x16x32_bf16 v[148:151], v[80:83], a[228:231], v[148:151]
 ds_read_b64_tr_b16 a[226:227], v3 offset:20480
 v_cvt_pk_bf16_f32 v43, v46, v47
 v_mfma_f32_16x16x32_bf16 v[156:159], v[88:91], a[228:231], v[156:159]
 s_waitcnt lgkmcnt(4)
 ds_read_b64_tr_b16 a[228:229], v3 offset:14592
 v_fma_f32 v49, v49, s22, v18
 v_mfma_f32_16x16x32_bf16 v[176:179], v[80:83], a[232:235], v[176:179]
 buffer_load_dwordx4 v6, s[4:7], s20 offen offset:2048 lds
 ds_read_b64_tr_b16 a[230:231], v3 offset:20736
 v_mfma_f32_16x16x32_bf16 v[184:187], v[88:91], a[232:235], v[184:187]
 s_waitcnt lgkmcnt(4)
 v_exp_f32 v48, v48
 v_mfma_f32_16x16x32_bf16 v[180:183], v[80:83], a[236:239], v[180:183]
 v_exp_f32 v49, v49
 v_mfma_f32_16x16x32_bf16 v[188:191], v[88:91], a[236:239], v[188:191]
 v_fma_f32 v50, v50, s22, v18
 v_fma_f32 v51, v51, s22, v18
 v_mfma_f32_16x16x32_bf16 v[160:163], v[64:67], a[232:235], v[160:163]
 v_exp_f32 v50, v50
 v_mfma_f32_16x16x32_bf16 v[168:171], v[72:75], a[232:235], v[168:171]
 s_add_u32 m0, s21, 36864
 ds_read_b64_tr_b16 a[232:233], v3 offset:14848
 v_fma_f32 v52, v52, s22, v18
 v_mfma_f32_16x16x32_bf16 v[164:167], v[64:67], a[236:239], v[164:167]
 buffer_load_dwordx4 v8, s[8:11], s25 offen lds
 ds_read_b64_tr_b16 a[234:235], v3 offset:20992
 v_mfma_f32_16x16x32_bf16 v[172:175], v[72:75], a[236:239], v[172:175]
 s_waitcnt lgkmcnt(3)
 ds_read_b64_tr_b16 a[236:237], v3 offset:15104
 s_sub_u32 s25, s25, 896
 v_mfma_f32_16x16x32_bf16 v[192:195], v[64:67], a[224:227], v[192:195]
 ds_read_b64_tr_b16 a[238:239], v3 offset:21248
 v_fma_f32 v53, v53, s22, v18
 v_mfma_f32_16x16x32_bf16 v[200:203], v[72:75], a[224:227], v[200:203]
 s_waitcnt lgkmcnt(4)
 v_exp_f32 v51, v51
 v_mfma_f32_16x16x32_bf16 v[196:199], v[64:67], a[228:231], v[196:199]
 v_exp_f32 v52, v52
 v_mfma_f32_16x16x32_bf16 v[204:207], v[72:75], a[228:231], v[204:207]
 v_exp_f32 v53, v53
 v_mfma_f32_16x16x32_bf16 v[208:211], v[80:83], a[224:227], v[208:211]
 buffer_load_dwordx4 v8, s[8:11], s25 offen offset:1024 lds
 v_mfma_f32_16x16x32_bf16 v[216:219], v[88:91], a[224:227], v[216:219]
 s_sub_u32 s25, s25, 896
 ds_read_b128 a[224:227], v2 offset:0
 v_fma_f32 v54, v54, s22, v18
 v_mfma_f32_16x16x32_bf16 v[212:215], v[80:83], a[228:231], v[212:215]
 v_exp_f32 v54, v54
 v_mfma_f32_16x16x32_bf16 v[220:223], v[88:91], a[228:231], v[220:223]
 s_waitcnt lgkmcnt(3)
 ds_read_b128 a[228:231], v2 offset:512
 v_fma_f32 v55, v55, s22, v18
 v_mfma_f32_16x16x32_bf16 v[240:243], v[80:83], a[232:235], v[240:243]
 v_exp_f32 v55, v55
 v_mfma_f32_16x16x32_bf16 v[248:251], v[88:91], a[232:235], v[248:251]
 s_waitcnt lgkmcnt(2)
 v_fma_f32 v56, v56, s22, v19
 v_fma_f32 v57, v57, s22, v19
 v_mfma_f32_16x16x32_bf16 v[244:247], v[80:83], a[236:239], v[244:247]
 buffer_load_dwordx4 v8, s[8:11], s25 offen offset:2048 lds
 v_mfma_f32_16x16x32_bf16 v[252:255], v[88:91], a[236:239], v[252:255]
 v_exp_f32 v56, v56
 v_mfma_f32_16x16x32_bf16 v[224:227], v[64:67], a[232:235], v[224:227]
 v_exp_f32 v57, v57
 v_mfma_f32_16x16x32_bf16 v[232:235], v[72:75], a[232:235], v[232:235]
 ds_read_b128 a[232:235], v2 offset:1024
 v_cvt_pk_bf16_f32 v48, v48, v49
 v_mfma_f32_16x16x32_bf16 v[228:231], v[64:67], a[236:239], v[228:231]
 v_fma_f32 v58, v58, s22, v19
 v_fma_f32 v59, v59, s22, v19
 v_mfma_f32_16x16x32_bf16 v[236:239], v[72:75], a[236:239], v[236:239]
 s_waitcnt lgkmcnt(2)
 ds_read_b128 a[236:239], v2 offset:1536
 v_cvt_pk_bf16_f32 v49, v50, v51
 v_mfma_f32_16x16x32_bf16 v[88:91], a[224:227], a[12:15], 0
 s_waitcnt lgkmcnt(2)
 v_exp_f32 v58, v58
 v_mfma_f32_16x16x32_bf16 v[88:91], a[228:231], a[28:31], v[88:91]
 v_exp_f32 v59, v59
 v_mfma_f32_16x16x32_bf16 v[80:83], a[224:227], a[8:11], 0
 v_fma_f32 v60, v60, s22, v19
 v_fma_f32 v61, v61, s22, v19
 v_mfma_f32_16x16x32_bf16 v[80:83], a[228:231], a[24:27], v[80:83]
 v_exp_f32 v60, v60
 v_mfma_f32_16x16x32_bf16 v[72:75], a[224:227], a[4:7], 0
 buffer_store_dwordx4 a[148:151], v10, s[16:19], s55 offen offset:128 nt
 v_mfma_f32_16x16x32_bf16 v[72:75], a[228:231], a[20:23], v[72:75]
 v_exp_f32 v61, v61
 v_mfma_f32_16x16x32_bf16 v[64:67], a[224:227], a[0:3], 0
 ds_read_b128 a[224:227], v2 offset:2048
 v_fma_f32 v62, v62, s22, v19
 v_mfma_f32_16x16x32_bf16 v[64:67], a[228:231], a[16:19], v[64:67]
 s_waitcnt lgkmcnt(1)
 ds_read_b128 a[228:231], v2 offset:2560
 v_fma_f32 v63, v63, s22, v19
 v_mfma_f32_16x16x32_bf16 v[64:67], a[232:235], a[32:35], v[64:67]
 v_exp_f32 v62, v62
 v_mfma_f32_16x16x32_bf16 v[64:67], a[236:239], a[48:51], v[64:67]
 v_exp_f32 v63, v63
 v_mfma_f32_16x16x32_bf16 v[72:75], a[232:235], a[36:39], v[72:75]
 v_cvt_pk_bf16_f32 v50, v52, v53
 v_cvt_pk_bf16_f32 v51, v54, v55
 v_mfma_f32_16x16x32_bf16 v[72:75], a[236:239], a[52:55], v[72:75]
 v_cvt_pk_bf16_f32 v56, v56, v57
 v_cvt_pk_bf16_f32 v57, v58, v59
 v_mfma_f32_16x16x32_bf16 v[80:83], a[232:235], a[40:43], v[80:83]
 v_cvt_pk_bf16_f32 v58, v60, v61
 v_cvt_pk_bf16_f32 v59, v62, v63
 v_mfma_f32_16x16x32_bf16 v[80:83], a[236:239], a[56:59], v[80:83]
 v_mfma_f32_16x16x32_bf16 v[88:91], a[232:235], a[44:47], v[88:91]
 ds_read_b128 a[232:235], v2 offset:8192
 v_mfma_f32_16x16x32_bf16 v[88:91], a[236:239], a[60:63], v[88:91]
 s_waitcnt lgkmcnt(2)
 ds_read_b128 a[236:239], v2 offset:8704
 v_mfma_f32_16x16x32_bf16 v[88:91], a[224:227], a[76:79], v[88:91]
 s_waitcnt lgkmcnt(2)
 v_mfma_f32_16x16x32_bf16 v[88:91], a[228:231], a[92:95], v[88:91]
 v_mfma_f32_16x16x32_bf16 v[80:83], a[224:227], a[72:75], v[80:83]
 v_mfma_f32_16x16x32_bf16 v[80:83], a[228:231], a[88:91], v[80:83]
 v_mfma_f32_16x16x32_bf16 v[72:75], a[224:227], a[68:71], v[72:75]
 v_mfma_f32_16x16x32_bf16 v[72:75], a[228:231], a[84:87], v[72:75]
 v_mfma_f32_16x16x32_bf16 v[64:67], a[224:227], a[64:67], v[64:67]
 ds_read_b128 a[224:227], v2 offset:7168
 v_mfma_f32_16x16x32_bf16 v[64:67], a[228:231], a[80:83], v[64:67]
 s_waitcnt lgkmcnt(2)
 ds_read_b128 a[228:231], v2 offset:7680
 v_mfma_f32_16x16x32_bf16 v[68:71], a[232:235], a[64:67], 0
 s_waitcnt lgkmcnt(2)
 v_mfma_f32_16x16x32_bf16 v[68:71], a[236:239], a[80:83], v[68:71]
 v_mfma_f32_16x16x32_bf16 v[76:79], a[232:235], a[68:71], 0
 v_mfma_f32_16x16x32_bf16 v[76:79], a[236:239], a[84:87], v[76:79]
 v_mfma_f32_16x16x32_bf16 v[84:87], a[232:235], a[72:75], 0
 v_mfma_f32_16x16x32_bf16 v[84:87], a[236:239], a[88:91], v[84:87]
 v_mfma_f32_16x16x32_bf16 v[92:95], a[232:235], a[76:79], 0
 ds_read_b128 a[232:235], v2 offset:6144
 v_fma_f32 v64, v64, s22, v16
 v_mfma_f32_16x16x32_bf16 v[92:95], a[236:239], a[92:95], v[92:95]
 s_waitcnt lgkmcnt(2)
 ds_read_b128 a[236:239], v2 offset:6656
 v_fma_f32 v65, v65, s22, v16
 v_mfma_f32_16x16x32_bf16 v[92:95], a[224:227], a[44:47], v[92:95]
 s_waitcnt lgkmcnt(2)
 v_exp_f32 v64, v64
 v_mfma_f32_16x16x32_bf16 v[92:95], a[228:231], a[60:63], v[92:95]
 v_exp_f32 v65, v65
 v_mfma_f32_16x16x32_bf16 v[84:87], a[224:227], a[40:43], v[84:87]
 v_fma_f32 v66, v66, s22, v16
 v_fma_f32 v67, v67, s22, v16
 v_mfma_f32_16x16x32_bf16 v[84:87], a[228:231], a[56:59], v[84:87]
 v_exp_f32 v66, v66
 v_mfma_f32_16x16x32_bf16 v[76:79], a[224:227], a[36:39], v[76:79]
 v_exp_f32 v67, v67
 v_mfma_f32_16x16x32_bf16 v[76:79], a[228:231], a[52:55], v[76:79]
 v_fma_f32 v72, v72, s22, v17
 v_fma_f32 v73, v73, s22, v17
 v_mfma_f32_16x16x32_bf16 v[68:71], a[224:227], a[32:35], v[68:71]
 ds_read_b64_tr_b16 a[224:225], v13 offset:0
 v_cvt_pk_bf16_f32 v64, v64, v65
 v_mfma_f32_16x16x32_bf16 v[68:71], a[228:231], a[48:51], v[68:71]
 s_waitcnt lgkmcnt(2)
 ds_read_b64_tr_b16 a[226:227], v13 offset:6144
 v_fma_f32 v74, v74, s22, v17
 v_mfma_f32_16x16x32_bf16 v[68:71], a[232:235], a[0:3], v[68:71]
 s_waitcnt lgkmcnt(2)
 ds_read_b64_tr_b16 a[228:229], v13 offset:256
 v_fma_f32 v75, v75, s22, v17
 v_mfma_f32_16x16x32_bf16 v[68:71], a[236:239], a[16:19], v[68:71]
 ds_read_b64_tr_b16 a[230:231], v13 offset:6400
 v_cvt_pk_bf16_f32 v65, v66, v67
 v_mfma_f32_16x16x32_bf16 v[76:79], a[232:235], a[4:7], v[76:79]
 s_waitcnt vmcnt(40)
 ds_read_b128 a[112:115], v11 offset:0
 ds_read_b128 a[116:119], v11 offset:512
 v_mfma_f32_16x16x32_bf16 v[76:79], a[236:239], a[20:23], v[76:79]
 v_exp_f32 v72, v72
 v_mfma_f32_16x16x32_bf16 v[84:87], a[232:235], a[8:11], v[84:87]
 v_exp_f32 v73, v73
 v_mfma_f32_16x16x32_bf16 v[84:87], a[236:239], a[24:27], v[84:87]
 v_exp_f32 v74, v74
 v_mfma_f32_16x16x32_bf16 v[92:95], a[232:235], a[12:15], v[92:95]
 ds_read_b64_tr_b16 a[232:233], v13 offset:512
 v_fma_f32 v68, v68, s22, v16
 v_mfma_f32_16x16x32_bf16 v[92:95], a[236:239], a[28:31], v[92:95]
 ds_read_b64_tr_b16 a[234:235], v13 offset:6656
 v_fma_f32 v69, v69, s22, v16
 v_mfma_f32_16x16x32_bf16 v[28:31], a[240:243], v[32:35], v[28:31]
 ds_read_b64_tr_b16 a[236:237], v13 offset:768
 v_fma_f32 v70, v70, s22, v16
 v_mfma_f32_16x16x32_bf16 a[244:247], a[240:243], v[40:43], a[244:247]
 s_waitcnt lgkmcnt(6)
 ds_read_b64_tr_b16 a[238:239], v13 offset:6912
 v_fma_f32 v71, v71, s22, v16
 v_mfma_f32_16x16x32_bf16 v[96:99], v[32:35], a[224:227], v[96:99]
 v_exp_f32 v68, v68
 v_mfma_f32_16x16x32_bf16 v[104:107], v[40:43], a[224:227], v[104:107]
 s_waitcnt lgkmcnt(4)
 v_exp_f32 v69, v69
 v_mfma_f32_16x16x32_bf16 v[100:103], v[32:35], a[228:231], v[100:103]
 v_exp_f32 v70, v70
 v_mfma_f32_16x16x32_bf16 v[108:111], v[40:43], a[228:231], v[108:111]
 s_add_u32 m0, s34, -2048
 v_exp_f32 v71, v71
 v_mfma_f32_16x16x32_bf16 a[192:195], v[48:51], a[224:227], a[192:195]
 buffer_load_dwordx4 v6, s[12:15], s52 offen offset:2048 nt lds
 v_mfma_f32_16x16x32_bf16 a[200:203], v[56:59], a[224:227], a[200:203]
 s_add_u32 m0, s34, -1024
 ds_read_b64_tr_b16 a[224:225], v13 offset:1024
 s_add_u32 s20, s20, 12288
 v_mfma_f32_16x16x32_bf16 a[196:199], v[48:51], a[228:231], a[196:199]
 buffer_load_dwordx4 v6, s[12:15], s53 offen offset:2048 nt lds
 v_mfma_f32_16x16x32_bf16 a[204:207], v[56:59], a[228:231], a[204:207]
 ds_read_b64_tr_b16 a[226:227], v13 offset:7168
 v_fma_f32 v76, v76, s22, v17
 v_mfma_f32_16x16x32_bf16 a[248:251], a[240:243], v[48:51], a[248:251]
 ds_read_b64_tr_b16 a[228:229], v13 offset:1280
 v_fma_f32 v77, v77, s22, v17
 v_mfma_f32_16x16x32_bf16 a[252:255], a[240:243], v[56:59], a[252:255]
 s_waitcnt lgkmcnt(3)
 ds_read_b64_tr_b16 a[230:231], v13 offset:7424
 v_fma_f32 v78, v78, s22, v17
 v_mfma_f32_16x16x32_bf16 a[208:211], v[48:51], a[232:235], a[208:211]
 s_waitcnt vmcnt(18)
 s_barrier
 v_fma_f32 v79, v79, s22, v17
 v_mfma_f32_16x16x32_bf16 a[216:219], v[56:59], a[232:235], a[216:219]
 v_exp_f32 v75, v75
 v_mfma_f32_16x16x32_bf16 a[212:215], v[48:51], a[236:239], a[212:215]
 v_exp_f32 v76, v76
 v_mfma_f32_16x16x32_bf16 a[220:223], v[56:59], a[236:239], a[220:223]
 s_add_u32 m0, s21, 24576
 s_add_u32 s25, s25, 14080
 v_cvt_pk_bf16_f32 v66, v68, v69
 v_mfma_f32_16x16x32_bf16 v[112:115], v[32:35], a[232:235], v[112:115]
 buffer_load_dwordx4 v4, s[4:7], s20 offen nt lds
 v_mfma_f32_16x16x32_bf16 v[120:123], v[40:43], a[232:235], v[120:123]
 ds_read_b64_tr_b16 a[232:233], v13 offset:1536
 v_cvt_pk_bf16_f32 v67, v70, v71
 v_mfma_f32_16x16x32_bf16 v[116:119], v[32:35], a[236:239], v[116:119]
 ds_read_b64_tr_b16 a[234:235], v13 offset:7680
 v_cvt_pk_bf16_f32 v72, v72, v73
 v_mfma_f32_16x16x32_bf16 v[124:127], v[40:43], a[236:239], v[124:127]
 s_waitcnt lgkmcnt(3)
 ds_read_b64_tr_b16 a[236:237], v13 offset:1792
 v_cvt_pk_bf16_f32 v73, v74, v75
 v_mfma_f32_16x16x32_bf16 v[128:131], v[32:35], a[224:227], v[128:131]
 ds_read_b64_tr_b16 a[238:239], v13 offset:7936
 v_fma_f32 v80, v80, s22, v18
 v_mfma_f32_16x16x32_bf16 v[136:139], v[40:43], a[224:227], v[136:139]
 s_waitcnt lgkmcnt(4)
 v_exp_f32 v77, v77
 v_mfma_f32_16x16x32_bf16 v[132:135], v[32:35], a[228:231], v[132:135]
 buffer_load_dwordx4 v5, s[4:7], s20 offen offset:1024 nt lds
 v_mfma_f32_16x16x32_bf16 v[140:143], v[40:43], a[228:231], v[140:143]
 v_exp_f32 v78, v78
 v_mfma_f32_16x16x32_bf16 v[144:147], v[48:51], a[224:227], v[144:147]
 v_exp_f32 v79, v79
 v_mfma_f32_16x16x32_bf16 v[152:155], v[56:59], a[224:227], v[152:155]
 ds_read_b64_tr_b16 a[224:225], v13 offset:2048
 v_cvt_pk_bf16_f32 v74, v76, v77
 v_mfma_f32_16x16x32_bf16 v[148:151], v[48:51], a[228:231], v[148:151]
 ds_read_b64_tr_b16 a[226:227], v13 offset:8192
 v_cvt_pk_bf16_f32 v75, v78, v79
 v_mfma_f32_16x16x32_bf16 v[156:159], v[56:59], a[228:231], v[156:159]
 s_waitcnt lgkmcnt(4)
 ds_read_b64_tr_b16 a[228:229], v13 offset:2304
 v_fma_f32 v81, v81, s22, v18
 v_mfma_f32_16x16x32_bf16 v[176:179], v[48:51], a[232:235], v[176:179]
 buffer_load_dwordx4 v6, s[4:7], s20 offen offset:2048 nt lds
 ds_read_b64_tr_b16 a[230:231], v13 offset:8448
 v_mfma_f32_16x16x32_bf16 v[184:187], v[56:59], a[232:235], v[184:187]
 s_waitcnt lgkmcnt(4)
 v_exp_f32 v80, v80
 v_mfma_f32_16x16x32_bf16 v[180:183], v[48:51], a[236:239], v[180:183]
 v_exp_f32 v81, v81
 v_mfma_f32_16x16x32_bf16 v[188:191], v[56:59], a[236:239], v[188:191]
 v_fma_f32 v82, v82, s22, v18
 v_fma_f32 v83, v83, s22, v18
 v_mfma_f32_16x16x32_bf16 v[160:163], v[32:35], a[232:235], v[160:163]
 v_exp_f32 v82, v82
 v_mfma_f32_16x16x32_bf16 v[168:171], v[40:43], a[232:235], v[168:171]
 s_add_u32 m0, s21, 49152
 ds_read_b64_tr_b16 a[232:233], v13 offset:2560
 v_fma_f32 v84, v84, s22, v18
 v_mfma_f32_16x16x32_bf16 v[164:167], v[32:35], a[236:239], v[164:167]
 buffer_load_dwordx4 v8, s[8:11], s25 offen nt lds
 ds_read_b64_tr_b16 a[234:235], v13 offset:8704
 v_mfma_f32_16x16x32_bf16 v[172:175], v[40:43], a[236:239], v[172:175]
 s_waitcnt lgkmcnt(3)
 ds_read_b64_tr_b16 a[236:237], v13 offset:2816
 s_sub_u32 s25, s25, 896
 v_mfma_f32_16x16x32_bf16 v[192:195], v[32:35], a[224:227], v[192:195]
 ds_read_b64_tr_b16 a[238:239], v13 offset:8960
 v_fma_f32 v85, v85, s22, v18
 v_mfma_f32_16x16x32_bf16 v[200:203], v[40:43], a[224:227], v[200:203]
 s_waitcnt lgkmcnt(4)
 v_exp_f32 v83, v83
 v_mfma_f32_16x16x32_bf16 v[196:199], v[32:35], a[228:231], v[196:199]
 v_exp_f32 v84, v84
 v_mfma_f32_16x16x32_bf16 v[204:207], v[40:43], a[228:231], v[204:207]
 v_exp_f32 v85, v85
 v_mfma_f32_16x16x32_bf16 v[208:211], v[48:51], a[224:227], v[208:211]
 buffer_load_dwordx4 v8, s[8:11], s25 offen offset:1024 nt lds
 v_mfma_f32_16x16x32_bf16 v[216:219], v[56:59], a[224:227], v[216:219]
 s_sub_u32 s25, s25, 896
 ds_read_b128 a[224:227], v2 offset:24576
 v_fma_f32 v86, v86, s22, v18
 v_mfma_f32_16x16x32_bf16 v[212:215], v[48:51], a[228:231], v[212:215]
 v_exp_f32 v86, v86
 v_mfma_f32_16x16x32_bf16 v[220:223], v[56:59], a[228:231], v[220:223]
 s_waitcnt lgkmcnt(3)
 ds_read_b128 a[228:231], v2 offset:25088
 v_fma_f32 v87, v87, s22, v18
 v_mfma_f32_16x16x32_bf16 v[240:243], v[48:51], a[232:235], v[240:243]
 v_exp_f32 v87, v87
 v_mfma_f32_16x16x32_bf16 v[248:251], v[56:59], a[232:235], v[248:251]
 s_waitcnt lgkmcnt(2)
 v_fma_f32 v88, v88, s22, v19
 v_fma_f32 v89, v89, s22, v19
 v_mfma_f32_16x16x32_bf16 v[244:247], v[48:51], a[236:239], v[244:247]
 buffer_load_dwordx4 v8, s[8:11], s25 offen offset:2048 nt lds
 v_mfma_f32_16x16x32_bf16 v[252:255], v[56:59], a[236:239], v[252:255]
 v_exp_f32 v88, v88
 v_mfma_f32_16x16x32_bf16 v[224:227], v[32:35], a[232:235], v[224:227]
 v_exp_f32 v89, v89
 v_mfma_f32_16x16x32_bf16 v[232:235], v[40:43], a[232:235], v[232:235]
 ds_read_b128 a[232:235], v2 offset:25600
 v_cvt_pk_bf16_f32 v80, v80, v81
 v_mfma_f32_16x16x32_bf16 v[228:231], v[32:35], a[236:239], v[228:231]
 v_fma_f32 v90, v90, s22, v19
 v_fma_f32 v91, v91, s22, v19
 v_mfma_f32_16x16x32_bf16 v[236:239], v[40:43], a[236:239], v[236:239]
 s_waitcnt lgkmcnt(2)
 ds_read_b128 a[236:239], v2 offset:26112
 v_cvt_pk_bf16_f32 v81, v82, v83
 v_mfma_f32_16x16x32_bf16 v[56:59], a[224:227], a[12:15], 0
 s_waitcnt lgkmcnt(2)
 v_exp_f32 v90, v90
 v_mfma_f32_16x16x32_bf16 v[56:59], a[228:231], a[28:31], v[56:59]
 v_exp_f32 v91, v91
 v_mfma_f32_16x16x32_bf16 v[48:51], a[224:227], a[8:11], 0
 v_fma_f32 v92, v92, s22, v19
 v_fma_f32 v93, v93, s22, v19
 v_mfma_f32_16x16x32_bf16 v[48:51], a[228:231], a[24:27], v[48:51]
 v_exp_f32 v92, v92
 v_mfma_f32_16x16x32_bf16 v[40:43], a[224:227], a[4:7], 0
 buffer_store_dwordx4 a[152:155], v10, s[16:19], s56 offen offset:128 nt
 v_mfma_f32_16x16x32_bf16 v[40:43], a[228:231], a[20:23], v[40:43]
 v_exp_f32 v93, v93
 v_mfma_f32_16x16x32_bf16 v[32:35], a[224:227], a[0:3], 0
 ds_read_b128 a[224:227], v2 offset:26624
 v_fma_f32 v94, v94, s22, v19
 v_mfma_f32_16x16x32_bf16 v[32:35], a[228:231], a[16:19], v[32:35]
 s_waitcnt lgkmcnt(1)
 ds_read_b128 a[228:231], v2 offset:27136
 v_fma_f32 v95, v95, s22, v19
 v_mfma_f32_16x16x32_bf16 v[32:35], a[232:235], a[32:35], v[32:35]
 v_exp_f32 v94, v94
 v_mfma_f32_16x16x32_bf16 v[32:35], a[236:239], a[48:51], v[32:35]
 v_exp_f32 v95, v95
 v_mfma_f32_16x16x32_bf16 v[40:43], a[232:235], a[36:39], v[40:43]
 v_cvt_pk_bf16_f32 v82, v84, v85
 v_cvt_pk_bf16_f32 v83, v86, v87
 v_mfma_f32_16x16x32_bf16 v[40:43], a[236:239], a[52:55], v[40:43]
 v_cvt_pk_bf16_f32 v88, v88, v89
 v_cvt_pk_bf16_f32 v89, v90, v91
 v_mfma_f32_16x16x32_bf16 v[48:51], a[232:235], a[40:43], v[48:51]
 v_cvt_pk_bf16_f32 v90, v92, v93
 v_cvt_pk_bf16_f32 v91, v94, v95
 v_mfma_f32_16x16x32_bf16 v[48:51], a[236:239], a[56:59], v[48:51]
 v_mfma_f32_16x16x32_bf16 v[56:59], a[232:235], a[44:47], v[56:59]
 ds_read_b128 a[232:235], v2 offset:32768
 v_mfma_f32_16x16x32_bf16 v[56:59], a[236:239], a[60:63], v[56:59]
 s_waitcnt lgkmcnt(2)
 ds_read_b128 a[236:239], v2 offset:33280
 v_mfma_f32_16x16x32_bf16 v[56:59], a[224:227], a[76:79], v[56:59]
 s_waitcnt lgkmcnt(2)
 v_mfma_f32_16x16x32_bf16 v[56:59], a[228:231], a[92:95], v[56:59]
 v_mfma_f32_16x16x32_bf16 v[48:51], a[224:227], a[72:75], v[48:51]
 v_mfma_f32_16x16x32_bf16 v[48:51], a[228:231], a[88:91], v[48:51]
 v_mfma_f32_16x16x32_bf16 v[40:43], a[224:227], a[68:71], v[40:43]
 v_mfma_f32_16x16x32_bf16 v[40:43], a[228:231], a[84:87], v[40:43]
 v_mfma_f32_16x16x32_bf16 v[32:35], a[224:227], a[64:67], v[32:35]
 ds_read_b128 a[224:227], v2 offset:31744
 v_mfma_f32_16x16x32_bf16 v[32:35], a[228:231], a[80:83], v[32:35]
 s_waitcnt lgkmcnt(2)
 ds_read_b128 a[228:231], v2 offset:32256
 v_mfma_f32_16x16x32_bf16 v[36:39], a[232:235], a[64:67], 0
 s_waitcnt lgkmcnt(2)
 v_mfma_f32_16x16x32_bf16 v[36:39], a[236:239], a[80:83], v[36:39]
 v_mfma_f32_16x16x32_bf16 v[44:47], a[232:235], a[68:71], 0
 v_mfma_f32_16x16x32_bf16 v[44:47], a[236:239], a[84:87], v[44:47]
 v_mfma_f32_16x16x32_bf16 v[52:55], a[232:235], a[72:75], 0
 v_mfma_f32_16x16x32_bf16 v[52:55], a[236:239], a[88:91], v[52:55]
 v_mfma_f32_16x16x32_bf16 v[60:63], a[232:235], a[76:79], 0
 ds_read_b128 a[232:235], v2 offset:30720
 v_fma_f32 v32, v32, s22, v16
 v_mfma_f32_16x16x32_bf16 v[60:63], a[236:239], a[92:95], v[60:63]
 s_waitcnt lgkmcnt(2)
 ds_read_b128 a[236:239], v2 offset:31232
 v_fma_f32 v33, v33, s22, v16
 v_mfma_f32_16x16x32_bf16 v[60:63], a[224:227], a[44:47], v[60:63]
 s_waitcnt lgkmcnt(2)
 v_exp_f32 v32, v32
 v_mfma_f32_16x16x32_bf16 v[60:63], a[228:231], a[60:63], v[60:63]
 v_exp_f32 v33, v33
 v_mfma_f32_16x16x32_bf16 v[52:55], a[224:227], a[40:43], v[52:55]
 v_fma_f32 v34, v34, s22, v16
 v_fma_f32 v35, v35, s22, v16
 v_mfma_f32_16x16x32_bf16 v[52:55], a[228:231], a[56:59], v[52:55]
 v_exp_f32 v34, v34
 v_mfma_f32_16x16x32_bf16 v[44:47], a[224:227], a[36:39], v[44:47]
 v_exp_f32 v35, v35
 v_mfma_f32_16x16x32_bf16 v[44:47], a[228:231], a[52:55], v[44:47]
 v_fma_f32 v40, v40, s22, v17
 v_fma_f32 v41, v41, s22, v17
 v_mfma_f32_16x16x32_bf16 v[36:39], a[224:227], a[32:35], v[36:39]
 ds_read_b64_tr_b16 a[224:225], v13 offset:24576
 v_cvt_pk_bf16_f32 v32, v32, v33
 v_mfma_f32_16x16x32_bf16 v[36:39], a[228:231], a[48:51], v[36:39]
 s_waitcnt lgkmcnt(2)
 ds_read_b64_tr_b16 a[226:227], v13 offset:30720
 v_fma_f32 v42, v42, s22, v17
 v_mfma_f32_16x16x32_bf16 v[36:39], a[232:235], a[0:3], v[36:39]
 s_waitcnt lgkmcnt(2)
 ds_read_b64_tr_b16 a[228:229], v13 offset:24832
 v_fma_f32 v43, v43, s22, v17
 v_mfma_f32_16x16x32_bf16 v[36:39], a[236:239], a[16:19], v[36:39]
 ds_read_b64_tr_b16 a[230:231], v13 offset:30976
 v_cvt_pk_bf16_f32 v33, v34, v35
 v_mfma_f32_16x16x32_bf16 v[44:47], a[232:235], a[4:7], v[44:47]
 s_waitcnt vmcnt(40)
 ds_read_b128 a[120:123], v11 offset:8192
 ds_read_b128 a[124:127], v11 offset:8704
 v_mfma_f32_16x16x32_bf16 v[44:47], a[236:239], a[20:23], v[44:47]
 v_exp_f32 v40, v40
 v_mfma_f32_16x16x32_bf16 v[52:55], a[232:235], a[8:11], v[52:55]
 v_exp_f32 v41, v41
 v_mfma_f32_16x16x32_bf16 v[52:55], a[236:239], a[24:27], v[52:55]
 v_exp_f32 v42, v42
 v_mfma_f32_16x16x32_bf16 v[60:63], a[232:235], a[12:15], v[60:63]
 ds_read_b64_tr_b16 a[232:233], v13 offset:25088
 v_fma_f32 v36, v36, s22, v16
 v_mfma_f32_16x16x32_bf16 v[60:63], a[236:239], a[28:31], v[60:63]
 ds_read_b64_tr_b16 a[234:235], v13 offset:31232
 v_fma_f32 v37, v37, s22, v16
 v_mfma_f32_16x16x32_bf16 v[28:31], a[240:243], v[64:67], v[28:31]
 ds_read_b64_tr_b16 a[236:237], v13 offset:25344
 v_fma_f32 v38, v38, s22, v16
 v_mfma_f32_16x16x32_bf16 a[244:247], a[240:243], v[72:75], a[244:247]
 s_waitcnt lgkmcnt(6)
 ds_read_b64_tr_b16 a[238:239], v13 offset:31488
 v_fma_f32 v39, v39, s22, v16
 v_mfma_f32_16x16x32_bf16 v[96:99], v[64:67], a[224:227], v[96:99]
 v_exp_f32 v36, v36
 v_mfma_f32_16x16x32_bf16 v[104:107], v[72:75], a[224:227], v[104:107]
 s_waitcnt lgkmcnt(4)
 v_exp_f32 v37, v37
 v_mfma_f32_16x16x32_bf16 v[100:103], v[64:67], a[228:231], v[100:103]
 v_exp_f32 v38, v38
 v_mfma_f32_16x16x32_bf16 v[108:111], v[72:75], a[228:231], v[108:111]
 s_add_u32 m0, s34, 6144
 v_exp_f32 v39, v39
 v_mfma_f32_16x16x32_bf16 a[192:195], v[80:83], a[224:227], a[192:195]
 buffer_load_dwordx4 v6, s[12:15], s54 offen offset:2048 nt lds
 v_mfma_f32_16x16x32_bf16 a[200:203], v[88:91], a[224:227], a[200:203]
 s_add_u32 m0, s34, 7168
 ds_read_b64_tr_b16 a[224:225], v13 offset:25600
 s_add_u32 s20, s20, 12288
 v_mfma_f32_16x16x32_bf16 a[196:199], v[80:83], a[228:231], a[196:199]
 buffer_load_dwordx4 v6, s[12:15], s55 offen offset:2048 nt lds
 v_mfma_f32_16x16x32_bf16 a[204:207], v[88:91], a[228:231], a[204:207]
 ds_read_b64_tr_b16 a[226:227], v13 offset:31744
 v_fma_f32 v44, v44, s22, v17
 v_mfma_f32_16x16x32_bf16 a[248:251], a[240:243], v[80:83], a[248:251]
 ds_read_b64_tr_b16 a[228:229], v13 offset:25856
 v_fma_f32 v45, v45, s22, v17
 v_mfma_f32_16x16x32_bf16 a[252:255], a[240:243], v[88:91], a[252:255]
 s_waitcnt lgkmcnt(3)
 ds_read_b64_tr_b16 a[230:231], v13 offset:32000
 v_fma_f32 v46, v46, s22, v17
 v_mfma_f32_16x16x32_bf16 a[208:211], v[80:83], a[232:235], a[208:211]
 s_waitcnt vmcnt(21)
 s_barrier
 v_fma_f32 v47, v47, s22, v17
 v_mfma_f32_16x16x32_bf16 a[216:219], v[88:91], a[232:235], a[216:219]
 v_exp_f32 v43, v43
 v_mfma_f32_16x16x32_bf16 a[212:215], v[80:83], a[236:239], a[212:215]
 v_exp_f32 v44, v44
 v_mfma_f32_16x16x32_bf16 a[220:223], v[88:91], a[236:239], a[220:223]
 s_add_u32 m0, s21, 73728
 s_add_u32 s25, s25, 14080
 v_cvt_pk_bf16_f32 v34, v36, v37
 v_mfma_f32_16x16x32_bf16 v[112:115], v[64:67], a[232:235], v[112:115]
 buffer_load_dwordx4 v4, s[4:7], s20 offen lds
 v_mfma_f32_16x16x32_bf16 v[120:123], v[72:75], a[232:235], v[120:123]
 ds_read_b64_tr_b16 a[232:233], v13 offset:26112
 v_cvt_pk_bf16_f32 v35, v38, v39
 v_mfma_f32_16x16x32_bf16 v[116:119], v[64:67], a[236:239], v[116:119]
 ds_read_b64_tr_b16 a[234:235], v13 offset:32256
 v_cvt_pk_bf16_f32 v40, v40, v41
 v_mfma_f32_16x16x32_bf16 v[124:127], v[72:75], a[236:239], v[124:127]
 s_waitcnt lgkmcnt(3)
 ds_read_b64_tr_b16 a[236:237], v13 offset:26368
 v_cvt_pk_bf16_f32 v41, v42, v43
 v_mfma_f32_16x16x32_bf16 v[128:131], v[64:67], a[224:227], v[128:131]
 ds_read_b64_tr_b16 a[238:239], v13 offset:32512
 v_fma_f32 v48, v48, s22, v18
 v_mfma_f32_16x16x32_bf16 v[136:139], v[72:75], a[224:227], v[136:139]
 s_waitcnt lgkmcnt(4)
 v_exp_f32 v45, v45
 v_mfma_f32_16x16x32_bf16 v[132:135], v[64:67], a[228:231], v[132:135]
 buffer_load_dwordx4 v5, s[4:7], s20 offen offset:1024 lds
 v_mfma_f32_16x16x32_bf16 v[140:143], v[72:75], a[228:231], v[140:143]
 v_exp_f32 v46, v46
 v_mfma_f32_16x16x32_bf16 v[144:147], v[80:83], a[224:227], v[144:147]
 v_exp_f32 v47, v47
 v_mfma_f32_16x16x32_bf16 v[152:155], v[88:91], a[224:227], v[152:155]
 ds_read_b64_tr_b16 a[224:225], v13 offset:26624
 v_cvt_pk_bf16_f32 v42, v44, v45
 v_mfma_f32_16x16x32_bf16 v[148:151], v[80:83], a[228:231], v[148:151]
 ds_read_b64_tr_b16 a[226:227], v13 offset:32768
 v_cvt_pk_bf16_f32 v43, v46, v47
 v_mfma_f32_16x16x32_bf16 v[156:159], v[88:91], a[228:231], v[156:159]
 s_waitcnt lgkmcnt(4)
 ds_read_b64_tr_b16 a[228:229], v13 offset:26880
 v_fma_f32 v49, v49, s22, v18
 v_mfma_f32_16x16x32_bf16 v[176:179], v[80:83], a[232:235], v[176:179]
 buffer_load_dwordx4 v6, s[4:7], s20 offen offset:2048 lds
 ds_read_b64_tr_b16 a[230:231], v13 offset:33024
 v_mfma_f32_16x16x32_bf16 v[184:187], v[88:91], a[232:235], v[184:187]
 s_waitcnt lgkmcnt(4)
 v_exp_f32 v48, v48
 v_mfma_f32_16x16x32_bf16 v[180:183], v[80:83], a[236:239], v[180:183]
 v_exp_f32 v49, v49
 v_mfma_f32_16x16x32_bf16 v[188:191], v[88:91], a[236:239], v[188:191]
 v_fma_f32 v50, v50, s22, v18
 v_fma_f32 v51, v51, s22, v18
 v_mfma_f32_16x16x32_bf16 v[160:163], v[64:67], a[232:235], v[160:163]
 v_exp_f32 v50, v50
 v_mfma_f32_16x16x32_bf16 v[168:171], v[72:75], a[232:235], v[168:171]
 s_add_u32 m0, s21, 86016
 ds_read_b64_tr_b16 a[232:233], v13 offset:27136
 v_fma_f32 v52, v52, s22, v18
 v_mfma_f32_16x16x32_bf16 v[164:167], v[64:67], a[236:239], v[164:167]
 buffer_load_dwordx4 v8, s[8:11], s25 offen lds
 ds_read_b64_tr_b16 a[234:235], v13 offset:33280
 v_mfma_f32_16x16x32_bf16 v[172:175], v[72:75], a[236:239], v[172:175]
 s_waitcnt lgkmcnt(3)
 ds_read_b64_tr_b16 a[236:237], v13 offset:27392
 s_sub_u32 s25, s25, 896
 v_mfma_f32_16x16x32_bf16 v[192:195], v[64:67], a[224:227], v[192:195]
 ds_read_b64_tr_b16 a[238:239], v13 offset:33536
 v_fma_f32 v53, v53, s22, v18
 v_mfma_f32_16x16x32_bf16 v[200:203], v[72:75], a[224:227], v[200:203]
 s_waitcnt lgkmcnt(4)
 v_exp_f32 v51, v51
 v_mfma_f32_16x16x32_bf16 v[196:199], v[64:67], a[228:231], v[196:199]
 v_exp_f32 v52, v52
 v_mfma_f32_16x16x32_bf16 v[204:207], v[72:75], a[228:231], v[204:207]
 v_exp_f32 v53, v53
 v_mfma_f32_16x16x32_bf16 v[208:211], v[80:83], a[224:227], v[208:211]
 buffer_load_dwordx4 v8, s[8:11], s25 offen offset:1024 lds
 v_mfma_f32_16x16x32_bf16 v[216:219], v[88:91], a[224:227], v[216:219]
 s_sub_u32 s25, s25, 896
 ds_read_b128 a[224:227], v1 offset:0
 v_fma_f32 v54, v54, s22, v18
 v_mfma_f32_16x16x32_bf16 v[212:215], v[80:83], a[228:231], v[212:215]
 v_exp_f32 v54, v54
 v_mfma_f32_16x16x32_bf16 v[220:223], v[88:91], a[228:231], v[220:223]
 s_waitcnt lgkmcnt(3)
 ds_read_b128 a[228:231], v1 offset:512
 v_fma_f32 v55, v55, s22, v18
 v_mfma_f32_16x16x32_bf16 v[240:243], v[80:83], a[232:235], v[240:243]
 v_exp_f32 v55, v55
 v_mfma_f32_16x16x32_bf16 v[248:251], v[88:91], a[232:235], v[248:251]
 s_waitcnt lgkmcnt(2)
 v_fma_f32 v56, v56, s22, v19
 v_fma_f32 v57, v57, s22, v19
 v_mfma_f32_16x16x32_bf16 v[244:247], v[80:83], a[236:239], v[244:247]
 buffer_load_dwordx4 v8, s[8:11], s25 offen offset:2048 lds
 v_mfma_f32_16x16x32_bf16 v[252:255], v[88:91], a[236:239], v[252:255]
 v_exp_f32 v56, v56
 v_mfma_f32_16x16x32_bf16 v[224:227], v[64:67], a[232:235], v[224:227]
 v_exp_f32 v57, v57
 v_mfma_f32_16x16x32_bf16 v[232:235], v[72:75], a[232:235], v[232:235]
 ds_read_b128 a[232:235], v1 offset:1024
 v_cvt_pk_bf16_f32 v48, v48, v49
 v_mfma_f32_16x16x32_bf16 v[228:231], v[64:67], a[236:239], v[228:231]
 v_fma_f32 v58, v58, s22, v19
 v_fma_f32 v59, v59, s22, v19
 v_mfma_f32_16x16x32_bf16 v[236:239], v[72:75], a[236:239], v[236:239]
 s_waitcnt lgkmcnt(2)
 ds_read_b128 a[236:239], v1 offset:1536
 v_cvt_pk_bf16_f32 v49, v50, v51
 v_mfma_f32_16x16x32_bf16 v[88:91], a[224:227], a[12:15], 0
 s_waitcnt lgkmcnt(2)
 v_exp_f32 v58, v58
 v_mfma_f32_16x16x32_bf16 v[88:91], a[228:231], a[28:31], v[88:91]
 v_exp_f32 v59, v59
 v_mfma_f32_16x16x32_bf16 v[80:83], a[224:227], a[8:11], 0
 v_fma_f32 v60, v60, s22, v19
 v_fma_f32 v61, v61, s22, v19
 v_mfma_f32_16x16x32_bf16 v[80:83], a[228:231], a[24:27], v[80:83]
 v_exp_f32 v60, v60
 v_mfma_f32_16x16x32_bf16 v[72:75], a[224:227], a[4:7], 0
 buffer_store_dwordx4 a[156:159], v10, s[16:19], s57 offen offset:128 nt
 v_mfma_f32_16x16x32_bf16 v[72:75], a[228:231], a[20:23], v[72:75]
 v_exp_f32 v61, v61
 v_mfma_f32_16x16x32_bf16 v[64:67], a[224:227], a[0:3], 0
 ds_read_b128 a[224:227], v1 offset:2048
 v_fma_f32 v62, v62, s22, v19
 v_mfma_f32_16x16x32_bf16 v[64:67], a[228:231], a[16:19], v[64:67]
 s_waitcnt lgkmcnt(1)
 ds_read_b128 a[228:231], v1 offset:2560
 v_fma_f32 v63, v63, s22, v19
 v_mfma_f32_16x16x32_bf16 v[64:67], a[232:235], a[32:35], v[64:67]
 v_exp_f32 v62, v62
 v_mfma_f32_16x16x32_bf16 v[64:67], a[236:239], a[48:51], v[64:67]
 v_exp_f32 v63, v63
 v_mfma_f32_16x16x32_bf16 v[72:75], a[232:235], a[36:39], v[72:75]
 v_cvt_pk_bf16_f32 v50, v52, v53
 v_cvt_pk_bf16_f32 v51, v54, v55
 v_mfma_f32_16x16x32_bf16 v[72:75], a[236:239], a[52:55], v[72:75]
 v_cvt_pk_bf16_f32 v56, v56, v57
 v_cvt_pk_bf16_f32 v57, v58, v59
 v_mfma_f32_16x16x32_bf16 v[80:83], a[232:235], a[40:43], v[80:83]
 v_cvt_pk_bf16_f32 v58, v60, v61
 v_cvt_pk_bf16_f32 v59, v62, v63
 v_mfma_f32_16x16x32_bf16 v[80:83], a[236:239], a[56:59], v[80:83]
 v_mfma_f32_16x16x32_bf16 v[88:91], a[232:235], a[44:47], v[88:91]
 ds_read_b128 a[232:235], v1 offset:8192
 v_mfma_f32_16x16x32_bf16 v[88:91], a[236:239], a[60:63], v[88:91]
 s_waitcnt lgkmcnt(2)
 ds_read_b128 a[236:239], v1 offset:8704
 v_mfma_f32_16x16x32_bf16 v[88:91], a[224:227], a[76:79], v[88:91]
 s_waitcnt lgkmcnt(2)
 v_mfma_f32_16x16x32_bf16 v[88:91], a[228:231], a[92:95], v[88:91]
 v_mfma_f32_16x16x32_bf16 v[80:83], a[224:227], a[72:75], v[80:83]
 v_mfma_f32_16x16x32_bf16 v[80:83], a[228:231], a[88:91], v[80:83]
 v_mfma_f32_16x16x32_bf16 v[72:75], a[224:227], a[68:71], v[72:75]
 v_mfma_f32_16x16x32_bf16 v[72:75], a[228:231], a[84:87], v[72:75]
 v_mfma_f32_16x16x32_bf16 v[64:67], a[224:227], a[64:67], v[64:67]
 ds_read_b128 a[224:227], v1 offset:7168
 v_mfma_f32_16x16x32_bf16 v[64:67], a[228:231], a[80:83], v[64:67]
 s_waitcnt lgkmcnt(2)
 ds_read_b128 a[228:231], v1 offset:7680
 v_mfma_f32_16x16x32_bf16 v[68:71], a[232:235], a[64:67], 0
 s_waitcnt lgkmcnt(2)
 v_mfma_f32_16x16x32_bf16 v[68:71], a[236:239], a[80:83], v[68:71]
 v_mfma_f32_16x16x32_bf16 v[76:79], a[232:235], a[68:71], 0
 v_mfma_f32_16x16x32_bf16 v[76:79], a[236:239], a[84:87], v[76:79]
 v_mfma_f32_16x16x32_bf16 v[84:87], a[232:235], a[72:75], 0
 v_mfma_f32_16x16x32_bf16 v[84:87], a[236:239], a[88:91], v[84:87]
 v_mfma_f32_16x16x32_bf16 v[92:95], a[232:235], a[76:79], 0
 ds_read_b128 a[232:235], v1 offset:6144
 v_fma_f32 v64, v64, s22, v16
 v_mfma_f32_16x16x32_bf16 v[92:95], a[236:239], a[92:95], v[92:95]
 s_waitcnt lgkmcnt(2)
 ds_read_b128 a[236:239], v1 offset:6656
 v_fma_f32 v65, v65, s22, v16
 v_mfma_f32_16x16x32_bf16 v[92:95], a[224:227], a[44:47], v[92:95]
 s_waitcnt lgkmcnt(2)
 v_exp_f32 v64, v64
 v_mfma_f32_16x16x32_bf16 v[92:95], a[228:231], a[60:63], v[92:95]
 v_exp_f32 v65, v65
 v_mfma_f32_16x16x32_bf16 v[84:87], a[224:227], a[40:43], v[84:87]
 v_fma_f32 v66, v66, s22, v16
 v_fma_f32 v67, v67, s22, v16
 v_mfma_f32_16x16x32_bf16 v[84:87], a[228:231], a[56:59], v[84:87]
 v_exp_f32 v66, v66
 v_mfma_f32_16x16x32_bf16 v[76:79], a[224:227], a[36:39], v[76:79]
 v_exp_f32 v67, v67
 v_mfma_f32_16x16x32_bf16 v[76:79], a[228:231], a[52:55], v[76:79]
 v_fma_f32 v72, v72, s22, v17
 v_fma_f32 v73, v73, s22, v17
 v_mfma_f32_16x16x32_bf16 v[68:71], a[224:227], a[32:35], v[68:71]
 ds_read_b64_tr_b16 a[224:225], v3 offset:24576
 v_cvt_pk_bf16_f32 v64, v64, v65
 v_mfma_f32_16x16x32_bf16 v[68:71], a[228:231], a[48:51], v[68:71]
 s_waitcnt lgkmcnt(2)
 ds_read_b64_tr_b16 a[226:227], v3 offset:30720
 v_fma_f32 v74, v74, s22, v17
 v_mfma_f32_16x16x32_bf16 v[68:71], a[232:235], a[0:3], v[68:71]
 s_waitcnt lgkmcnt(2)
 ds_read_b64_tr_b16 a[228:229], v3 offset:24832
 v_fma_f32 v75, v75, s22, v17
 v_mfma_f32_16x16x32_bf16 v[68:71], a[236:239], a[16:19], v[68:71]
 ds_read_b64_tr_b16 a[230:231], v3 offset:30976
 v_cvt_pk_bf16_f32 v65, v66, v67
 v_mfma_f32_16x16x32_bf16 v[76:79], a[232:235], a[4:7], v[76:79]
 s_waitcnt vmcnt(40)
 ds_read_b128 a[128:131], v11 offset:16384
 ds_read_b128 a[132:135], v11 offset:16896
 v_mfma_f32_16x16x32_bf16 v[76:79], a[236:239], a[20:23], v[76:79]
 v_exp_f32 v72, v72
 v_mfma_f32_16x16x32_bf16 v[84:87], a[232:235], a[8:11], v[84:87]
 v_exp_f32 v73, v73
 v_mfma_f32_16x16x32_bf16 v[84:87], a[236:239], a[24:27], v[84:87]
 v_exp_f32 v74, v74
 v_mfma_f32_16x16x32_bf16 v[92:95], a[232:235], a[12:15], v[92:95]
 ds_read_b64_tr_b16 a[232:233], v3 offset:25088
 v_fma_f32 v68, v68, s22, v16
 v_mfma_f32_16x16x32_bf16 v[92:95], a[236:239], a[28:31], v[92:95]
 ds_read_b64_tr_b16 a[234:235], v3 offset:31232
 v_fma_f32 v69, v69, s22, v16
 v_mfma_f32_16x16x32_bf16 v[28:31], a[240:243], v[32:35], v[28:31]
 ds_read_b64_tr_b16 a[236:237], v3 offset:25344
 v_fma_f32 v70, v70, s22, v16
 v_mfma_f32_16x16x32_bf16 a[244:247], a[240:243], v[40:43], a[244:247]
 s_waitcnt lgkmcnt(6)
 ds_read_b64_tr_b16 a[238:239], v3 offset:31488
 v_fma_f32 v71, v71, s22, v16
 v_mfma_f32_16x16x32_bf16 v[96:99], v[32:35], a[224:227], v[96:99]
 v_exp_f32 v68, v68
 v_mfma_f32_16x16x32_bf16 v[104:107], v[40:43], a[224:227], v[104:107]
 s_waitcnt lgkmcnt(4)
 v_exp_f32 v69, v69
 v_mfma_f32_16x16x32_bf16 v[100:103], v[32:35], a[228:231], v[100:103]
 v_exp_f32 v70, v70
 v_mfma_f32_16x16x32_bf16 v[108:111], v[40:43], a[228:231], v[108:111]
 s_add_u32 m0, s34, 14336
 v_exp_f32 v71, v71
 v_mfma_f32_16x16x32_bf16 a[192:195], v[48:51], a[224:227], a[192:195]
 buffer_load_dwordx4 v6, s[12:15], s56 offen offset:2048 nt lds
 v_mfma_f32_16x16x32_bf16 a[200:203], v[56:59], a[224:227], a[200:203]
 s_add_u32 m0, s34, 15360
 ds_read_b64_tr_b16 a[224:225], v3 offset:25600
 s_add_u32 s25, s25, 14080
 v_mfma_f32_16x16x32_bf16 a[196:199], v[48:51], a[228:231], a[196:199]
 buffer_load_dwordx4 v6, s[12:15], s57 offen offset:2048 nt lds
 v_mfma_f32_16x16x32_bf16 a[204:207], v[56:59], a[228:231], a[204:207]
 ds_read_b64_tr_b16 a[226:227], v3 offset:31744
 v_fma_f32 v76, v76, s22, v17
 v_mfma_f32_16x16x32_bf16 a[248:251], a[240:243], v[48:51], a[248:251]
 ds_read_b64_tr_b16 a[228:229], v3 offset:25856
 v_fma_f32 v77, v77, s22, v17
 v_mfma_f32_16x16x32_bf16 a[252:255], a[240:243], v[56:59], a[252:255]
 s_waitcnt lgkmcnt(3)
 ds_read_b64_tr_b16 a[230:231], v3 offset:32000
 v_fma_f32 v78, v78, s22, v17
 v_mfma_f32_16x16x32_bf16 a[208:211], v[48:51], a[232:235], a[208:211]
 s_waitcnt vmcnt(21)
 s_barrier
 v_fma_f32 v79, v79, s22, v17
 v_mfma_f32_16x16x32_bf16 a[216:219], v[56:59], a[232:235], a[216:219]
 v_exp_f32 v75, v75
 v_mfma_f32_16x16x32_bf16 a[212:215], v[48:51], a[236:239], a[212:215]
 v_exp_f32 v76, v76
 v_mfma_f32_16x16x32_bf16 a[220:223], v[56:59], a[236:239], a[220:223]
 s_add_u32 m0, s21, 110592
 v_exp_f32 v77, v77
 v_mfma_f32_16x16x32_bf16 v[112:115], v[32:35], a[232:235], v[112:115]
 buffer_load_dwordx4 v8, s[8:11], s25 offen nt lds
 v_mfma_f32_16x16x32_bf16 v[120:123], v[40:43], a[232:235], v[120:123]
 s_sub_u32 s25, s25, 896
 ds_read_b64_tr_b16 a[232:233], v3 offset:26112
 v_cvt_pk_bf16_f32 v66, v68, v69
 v_mfma_f32_16x16x32_bf16 v[116:119], v[32:35], a[236:239], v[116:119]
 ds_read_b64_tr_b16 a[234:235], v3 offset:32256
 v_cvt_pk_bf16_f32 v67, v70, v71
 v_mfma_f32_16x16x32_bf16 v[124:127], v[40:43], a[236:239], v[124:127]
 s_waitcnt lgkmcnt(3)
 ds_read_b64_tr_b16 a[236:237], v3 offset:26368
 v_cvt_pk_bf16_f32 v72, v72, v73
 v_mfma_f32_16x16x32_bf16 v[128:131], v[32:35], a[224:227], v[128:131]
 ds_read_b64_tr_b16 a[238:239], v3 offset:32512
 v_cvt_pk_bf16_f32 v73, v74, v75
 v_mfma_f32_16x16x32_bf16 v[136:139], v[40:43], a[224:227], v[136:139]
 s_waitcnt lgkmcnt(4)
 v_exp_f32 v78, v78
 v_mfma_f32_16x16x32_bf16 v[132:135], v[32:35], a[228:231], v[132:135]
 buffer_load_dwordx4 v8, s[8:11], s25 offen offset:1024 nt lds
 v_mfma_f32_16x16x32_bf16 v[140:143], v[40:43], a[228:231], v[140:143]
 s_sub_u32 s25, s25, 896
 v_exp_f32 v79, v79
 v_mfma_f32_16x16x32_bf16 v[144:147], v[48:51], a[224:227], v[144:147]
 v_cvt_pk_bf16_f32 v74, v76, v77
 v_cvt_pk_bf16_f32 v75, v78, v79
 v_mfma_f32_16x16x32_bf16 v[152:155], v[56:59], a[224:227], v[152:155]
 ds_read_b64_tr_b16 a[224:225], v3 offset:26624
 v_fma_f32 v80, v80, s22, v18
 v_mfma_f32_16x16x32_bf16 v[148:151], v[48:51], a[228:231], v[148:151]
 ds_read_b64_tr_b16 a[226:227], v3 offset:32768
 v_fma_f32 v81, v81, s22, v18
 v_mfma_f32_16x16x32_bf16 v[156:159], v[56:59], a[228:231], v[156:159]
 s_waitcnt lgkmcnt(4)
 ds_read_b64_tr_b16 a[228:229], v3 offset:26880
 v_fma_f32 v82, v82, s22, v18
 v_mfma_f32_16x16x32_bf16 v[176:179], v[48:51], a[232:235], v[176:179]
 buffer_load_dwordx4 v8, s[8:11], s25 offen offset:2048 nt lds
 ds_read_b64_tr_b16 a[230:231], v3 offset:33024
 v_mfma_f32_16x16x32_bf16 v[184:187], v[56:59], a[232:235], v[184:187]
 s_waitcnt lgkmcnt(4)
 v_exp_f32 v80, v80
 v_mfma_f32_16x16x32_bf16 v[180:183], v[48:51], a[236:239], v[180:183]
 v_exp_f32 v81, v81
 v_mfma_f32_16x16x32_bf16 v[188:191], v[56:59], a[236:239], v[188:191]
 v_exp_f32 v82, v82
 v_mfma_f32_16x16x32_bf16 v[160:163], v[32:35], a[232:235], v[160:163]
 v_fma_f32 v83, v83, s22, v18
 v_fma_f32 v84, v84, s22, v18
 v_mfma_f32_16x16x32_bf16 v[168:171], v[40:43], a[232:235], v[168:171]
 ds_read_b64_tr_b16 a[232:233], v3 offset:27136
 v_fma_f32 v85, v85, s22, v18
 v_mfma_f32_16x16x32_bf16 v[164:167], v[32:35], a[236:239], v[164:167]
 ds_read_b64_tr_b16 a[234:235], v3 offset:33280
 v_fma_f32 v86, v86, s22, v18
 v_mfma_f32_16x16x32_bf16 v[172:175], v[40:43], a[236:239], v[172:175]
 s_waitcnt lgkmcnt(4)
 ds_read_b64_tr_b16 a[236:237], v3 offset:27392
 v_fma_f32 v87, v87, s22, v18
 v_mfma_f32_16x16x32_bf16 v[192:195], v[32:35], a[224:227], v[192:195]
 ds_read_b64_tr_b16 a[238:239], v3 offset:33536
 v_fma_f32 v88, v88, s22, v19
 v_mfma_f32_16x16x32_bf16 v[200:203], v[40:43], a[224:227], v[200:203]
 s_waitcnt lgkmcnt(4)
 v_exp_f32 v83, v83
 v_mfma_f32_16x16x32_bf16 v[196:199], v[32:35], a[228:231], v[196:199]
 v_exp_f32 v84, v84
 v_mfma_f32_16x16x32_bf16 v[204:207], v[40:43], a[228:231], v[204:207]
 v_exp_f32 v85, v85
 v_mfma_f32_16x16x32_bf16 v[208:211], v[48:51], a[224:227], v[208:211]
 v_exp_f32 v86, v86
 v_mfma_f32_16x16x32_bf16 v[216:219], v[56:59], a[224:227], v[216:219]
 ds_read_b128 a[224:227], v1 offset:12288
 v_fma_f32 v89, v89, s22, v19
 v_mfma_f32_16x16x32_bf16 v[212:215], v[48:51], a[228:231], v[212:215]
 v_exp_f32 v87, v87
 v_mfma_f32_16x16x32_bf16 v[220:223], v[56:59], a[228:231], v[220:223]
 s_waitcnt lgkmcnt(3)
 ds_read_b128 a[228:231], v1 offset:12800
 v_cvt_pk_bf16_f32 v80, v80, v81
 v_mfma_f32_16x16x32_bf16 v[240:243], v[48:51], a[232:235], v[240:243]
 v_exp_f32 v88, v88
 v_mfma_f32_16x16x32_bf16 v[248:251], v[56:59], a[232:235], v[248:251]
 s_waitcnt lgkmcnt(2)
 v_exp_f32 v89, v89
 v_mfma_f32_16x16x32_bf16 v[244:247], v[48:51], a[236:239], v[244:247]
 v_fma_f32 v90, v90, s22, v19
 v_fma_f32 v91, v91, s22, v19
 v_mfma_f32_16x16x32_bf16 v[252:255], v[56:59], a[236:239], v[252:255]
 v_exp_f32 v90, v90
 v_mfma_f32_16x16x32_bf16 v[224:227], v[32:35], a[232:235], v[224:227]
 v_exp_f32 v91, v91
 v_mfma_f32_16x16x32_bf16 v[232:235], v[40:43], a[232:235], v[232:235]
 ds_read_b128 a[232:235], v1 offset:13312
 v_cvt_pk_bf16_f32 v81, v82, v83
 v_mfma_f32_16x16x32_bf16 v[228:231], v[32:35], a[236:239], v[228:231]
 v_fma_f32 v92, v92, s22, v19
 v_fma_f32 v93, v93, s22, v19
 v_mfma_f32_16x16x32_bf16 v[236:239], v[40:43], a[236:239], v[236:239]
 s_waitcnt lgkmcnt(2)
 ds_read_b128 a[236:239], v1 offset:13824
 v_fma_f32 v94, v94, s22, v19
 v_mfma_f32_16x16x32_bf16 v[56:59], a[224:227], a[12:15], 0
 s_waitcnt lgkmcnt(2)
 v_exp_f32 v92, v92
 v_mfma_f32_16x16x32_bf16 v[56:59], a[228:231], a[28:31], v[56:59]
 v_exp_f32 v93, v93
 v_mfma_f32_16x16x32_bf16 v[48:51], a[224:227], a[8:11], 0
 v_exp_f32 v94, v94
 v_mfma_f32_16x16x32_bf16 v[48:51], a[228:231], a[24:27], v[48:51]
 v_fma_f32 v95, v95, s22, v19
 v_cvt_pk_bf16_f32 v82, v84, v85
 v_mfma_f32_16x16x32_bf16 v[40:43], a[224:227], a[4:7], 0
 buffer_store_dwordx4 a[160:163], v10, s[16:19], s50 offen offset:256 nt
 v_mfma_f32_16x16x32_bf16 v[40:43], a[228:231], a[20:23], v[40:43]
 v_exp_f32 v95, v95
 v_mfma_f32_16x16x32_bf16 v[32:35], a[224:227], a[0:3], 0
 ds_read_b128 a[224:227], v1 offset:14336
 v_cvt_pk_bf16_f32 v83, v86, v87
 v_mfma_f32_16x16x32_bf16 v[32:35], a[228:231], a[16:19], v[32:35]
 s_waitcnt lgkmcnt(1)
 ds_read_b128 a[228:231], v1 offset:14848
 v_cvt_pk_bf16_f32 v88, v88, v89
 v_mfma_f32_16x16x32_bf16 v[32:35], a[232:235], a[32:35], v[32:35]
 v_cvt_pk_bf16_f32 v89, v90, v91
 v_cvt_pk_bf16_f32 v90, v92, v93
 v_mfma_f32_16x16x32_bf16 v[32:35], a[236:239], a[48:51], v[32:35]
 v_cvt_pk_bf16_f32 v91, v94, v95
 v_mfma_f32_16x16x32_bf16 v[40:43], a[232:235], a[36:39], v[40:43]
 v_mfma_f32_16x16x32_bf16 v[40:43], a[236:239], a[52:55], v[40:43]
 v_mfma_f32_16x16x32_bf16 v[48:51], a[232:235], a[40:43], v[48:51]
 v_mfma_f32_16x16x32_bf16 v[48:51], a[236:239], a[56:59], v[48:51]
 v_mfma_f32_16x16x32_bf16 v[56:59], a[232:235], a[44:47], v[56:59]
 ds_read_b128 a[232:235], v1 offset:20480
 v_mfma_f32_16x16x32_bf16 v[56:59], a[236:239], a[60:63], v[56:59]
 s_waitcnt lgkmcnt(2)
 ds_read_b128 a[236:239], v1 offset:20992
 v_mfma_f32_16x16x32_bf16 v[56:59], a[224:227], a[76:79], v[56:59]
 s_waitcnt lgkmcnt(2)
 v_mfma_f32_16x16x32_bf16 v[56:59], a[228:231], a[92:95], v[56:59]
 v_mfma_f32_16x16x32_bf16 v[48:51], a[224:227], a[72:75], v[48:51]
 v_mfma_f32_16x16x32_bf16 v[48:51], a[228:231], a[88:91], v[48:51]
 v_mfma_f32_16x16x32_bf16 v[40:43], a[224:227], a[68:71], v[40:43]
 v_mfma_f32_16x16x32_bf16 v[40:43], a[228:231], a[84:87], v[40:43]
 v_mfma_f32_16x16x32_bf16 v[32:35], a[224:227], a[64:67], v[32:35]
 ds_read_b128 a[224:227], v1 offset:19456
 v_mfma_f32_16x16x32_bf16 v[32:35], a[228:231], a[80:83], v[32:35]
 s_waitcnt lgkmcnt(2)
 ds_read_b128 a[228:231], v1 offset:19968
 v_mfma_f32_16x16x32_bf16 v[36:39], a[232:235], a[64:67], 0
 s_waitcnt lgkmcnt(2)
 v_mfma_f32_16x16x32_bf16 v[36:39], a[236:239], a[80:83], v[36:39]
 v_mfma_f32_16x16x32_bf16 v[44:47], a[232:235], a[68:71], 0
 v_mfma_f32_16x16x32_bf16 v[44:47], a[236:239], a[84:87], v[44:47]
 v_mfma_f32_16x16x32_bf16 v[52:55], a[232:235], a[72:75], 0
 v_mfma_f32_16x16x32_bf16 v[52:55], a[236:239], a[88:91], v[52:55]
 v_mfma_f32_16x16x32_bf16 v[60:63], a[232:235], a[76:79], 0
 ds_read_b128 a[232:235], v1 offset:18432
 v_fma_f32 v32, v32, s22, v16
 v_mfma_f32_16x16x32_bf16 v[60:63], a[236:239], a[92:95], v[60:63]
 s_waitcnt lgkmcnt(2)
 ds_read_b128 a[236:239], v1 offset:18944
 v_fma_f32 v33, v33, s22, v16
 v_mfma_f32_16x16x32_bf16 v[60:63], a[224:227], a[44:47], v[60:63]
 s_waitcnt lgkmcnt(2)
 v_exp_f32 v32, v32
 v_mfma_f32_16x16x32_bf16 v[60:63], a[228:231], a[60:63], v[60:63]
 v_exp_f32 v33, v33
 v_mfma_f32_16x16x32_bf16 v[52:55], a[224:227], a[40:43], v[52:55]
 v_fma_f32 v34, v34, s22, v16
 v_fma_f32 v35, v35, s22, v16
 v_mfma_f32_16x16x32_bf16 v[52:55], a[228:231], a[56:59], v[52:55]
 v_exp_f32 v34, v34
 v_mfma_f32_16x16x32_bf16 v[44:47], a[224:227], a[36:39], v[44:47]
 v_exp_f32 v35, v35
 v_mfma_f32_16x16x32_bf16 v[44:47], a[228:231], a[52:55], v[44:47]
 v_fma_f32 v40, v40, s22, v17
 v_fma_f32 v41, v41, s22, v17
 v_mfma_f32_16x16x32_bf16 v[36:39], a[224:227], a[32:35], v[36:39]
 ds_read_b64_tr_b16 a[224:225], v3 offset:0
 v_cvt_pk_bf16_f32 v32, v32, v33
 v_mfma_f32_16x16x32_bf16 v[36:39], a[228:231], a[48:51], v[36:39]
 s_waitcnt lgkmcnt(2)
 ds_read_b64_tr_b16 a[226:227], v3 offset:6144
 v_fma_f32 v42, v42, s22, v17
 v_mfma_f32_16x16x32_bf16 v[36:39], a[232:235], a[0:3], v[36:39]
 s_waitcnt lgkmcnt(2)
 ds_read_b64_tr_b16 a[228:229], v3 offset:256
 v_fma_f32 v43, v43, s22, v17
 v_mfma_f32_16x16x32_bf16 v[36:39], a[236:239], a[16:19], v[36:39]
 ds_read_b64_tr_b16 a[230:231], v3 offset:6400
 v_cvt_pk_bf16_f32 v33, v34, v35
 v_mfma_f32_16x16x32_bf16 v[44:47], a[232:235], a[4:7], v[44:47]
 s_waitcnt vmcnt(37)
 ds_read_b128 a[136:139], v11 offset:24576
 ds_read_b128 a[140:143], v11 offset:25088
 v_mfma_f32_16x16x32_bf16 v[44:47], a[236:239], a[20:23], v[44:47]
 v_exp_f32 v40, v40
 v_mfma_f32_16x16x32_bf16 v[52:55], a[232:235], a[8:11], v[52:55]
 v_exp_f32 v41, v41
 v_mfma_f32_16x16x32_bf16 v[52:55], a[236:239], a[24:27], v[52:55]
 v_exp_f32 v42, v42
 v_mfma_f32_16x16x32_bf16 v[60:63], a[232:235], a[12:15], v[60:63]
 ds_read_b64_tr_b16 a[232:233], v3 offset:512
 v_fma_f32 v36, v36, s22, v16
 v_mfma_f32_16x16x32_bf16 v[60:63], a[236:239], a[28:31], v[60:63]
 ds_read_b64_tr_b16 a[234:235], v3 offset:6656
 v_fma_f32 v37, v37, s22, v16
 v_mfma_f32_16x16x32_bf16 v[28:31], a[240:243], v[64:67], v[28:31]
 ds_read_b64_tr_b16 a[236:237], v3 offset:768
 v_fma_f32 v38, v38, s22, v16
 v_mfma_f32_16x16x32_bf16 a[244:247], a[240:243], v[72:75], a[244:247]
 s_waitcnt lgkmcnt(6)
 ds_read_b64_tr_b16 a[238:239], v3 offset:6912
 v_fma_f32 v39, v39, s22, v16
 v_mfma_f32_16x16x32_bf16 v[96:99], v[64:67], a[224:227], v[96:99]
 v_exp_f32 v36, v36
 v_mfma_f32_16x16x32_bf16 v[104:107], v[72:75], a[224:227], v[104:107]
 s_waitcnt lgkmcnt(4)
 v_exp_f32 v37, v37
 v_mfma_f32_16x16x32_bf16 v[100:103], v[64:67], a[228:231], v[100:103]
 v_exp_f32 v38, v38
 v_mfma_f32_16x16x32_bf16 v[108:111], v[72:75], a[228:231], v[108:111]
 s_add_u32 m0, s34, 24576
 v_exp_f32 v39, v39
 v_mfma_f32_16x16x32_bf16 a[192:195], v[80:83], a[224:227], a[192:195]
 buffer_load_dwordx4 v4, s[12:15], s50 offen nt lds
 v_mfma_f32_16x16x32_bf16 a[200:203], v[88:91], a[224:227], a[200:203]
 s_add_u32 m0, s34, 25600
 ds_read_b64_tr_b16 a[224:225], v3 offset:1024
 s_add_u32 s20, s20, 12288
 v_mfma_f32_16x16x32_bf16 a[196:199], v[80:83], a[228:231], a[196:199]
 buffer_load_dwordx4 v4, s[12:15], s51 offen nt lds
 v_mfma_f32_16x16x32_bf16 a[204:207], v[88:91], a[228:231], a[204:207]
 ds_read_b64_tr_b16 a[226:227], v3 offset:7168
 v_fma_f32 v44, v44, s22, v17
 v_mfma_f32_16x16x32_bf16 a[248:251], a[240:243], v[80:83], a[248:251]
 ds_read_b64_tr_b16 a[228:229], v3 offset:1280
 v_fma_f32 v45, v45, s22, v17
 v_mfma_f32_16x16x32_bf16 a[252:255], a[240:243], v[88:91], a[252:255]
 s_waitcnt lgkmcnt(3)
 ds_read_b64_tr_b16 a[230:231], v3 offset:7424
 v_fma_f32 v46, v46, s22, v17
 v_mfma_f32_16x16x32_bf16 a[208:211], v[80:83], a[232:235], a[208:211]
 s_waitcnt vmcnt(18)
 s_barrier
 v_fma_f32 v47, v47, s22, v17
 v_mfma_f32_16x16x32_bf16 a[216:219], v[88:91], a[232:235], a[216:219]
 v_exp_f32 v43, v43
 v_mfma_f32_16x16x32_bf16 a[212:215], v[80:83], a[236:239], a[212:215]
 v_exp_f32 v44, v44
 v_mfma_f32_16x16x32_bf16 a[220:223], v[88:91], a[236:239], a[220:223]
 s_add_u32 m0, s21, 98304
 s_add_u32 s25, s25, 14080
 v_cvt_pk_bf16_f32 v34, v36, v37
 v_mfma_f32_16x16x32_bf16 v[112:115], v[64:67], a[232:235], v[112:115]
 buffer_load_dwordx4 v4, s[4:7], s20 offen nt lds
 v_mfma_f32_16x16x32_bf16 v[120:123], v[72:75], a[232:235], v[120:123]
 ds_read_b64_tr_b16 a[232:233], v3 offset:1536
 v_cvt_pk_bf16_f32 v35, v38, v39
 v_mfma_f32_16x16x32_bf16 v[116:119], v[64:67], a[236:239], v[116:119]
 ds_read_b64_tr_b16 a[234:235], v3 offset:7680
 v_cvt_pk_bf16_f32 v40, v40, v41
 v_mfma_f32_16x16x32_bf16 v[124:127], v[72:75], a[236:239], v[124:127]
 s_waitcnt lgkmcnt(3)
 ds_read_b64_tr_b16 a[236:237], v3 offset:1792
 v_cvt_pk_bf16_f32 v41, v42, v43
 v_mfma_f32_16x16x32_bf16 v[128:131], v[64:67], a[224:227], v[128:131]
 ds_read_b64_tr_b16 a[238:239], v3 offset:7936
 v_fma_f32 v48, v48, s22, v18
 v_mfma_f32_16x16x32_bf16 v[136:139], v[72:75], a[224:227], v[136:139]
 s_waitcnt lgkmcnt(4)
 v_exp_f32 v45, v45
 v_mfma_f32_16x16x32_bf16 v[132:135], v[64:67], a[228:231], v[132:135]
 buffer_load_dwordx4 v5, s[4:7], s20 offen offset:1024 nt lds
 v_mfma_f32_16x16x32_bf16 v[140:143], v[72:75], a[228:231], v[140:143]
 v_exp_f32 v46, v46
 v_mfma_f32_16x16x32_bf16 v[144:147], v[80:83], a[224:227], v[144:147]
 v_exp_f32 v47, v47
 v_mfma_f32_16x16x32_bf16 v[152:155], v[88:91], a[224:227], v[152:155]
 ds_read_b64_tr_b16 a[224:225], v3 offset:2048
 v_cvt_pk_bf16_f32 v42, v44, v45
 v_mfma_f32_16x16x32_bf16 v[148:151], v[80:83], a[228:231], v[148:151]
 ds_read_b64_tr_b16 a[226:227], v3 offset:8192
 v_cvt_pk_bf16_f32 v43, v46, v47
 v_mfma_f32_16x16x32_bf16 v[156:159], v[88:91], a[228:231], v[156:159]
 s_waitcnt lgkmcnt(4)
 ds_read_b64_tr_b16 a[228:229], v3 offset:2304
 v_fma_f32 v49, v49, s22, v18
 v_mfma_f32_16x16x32_bf16 v[176:179], v[80:83], a[232:235], v[176:179]
 buffer_load_dwordx4 v6, s[4:7], s20 offen offset:2048 nt lds
 ds_read_b64_tr_b16 a[230:231], v3 offset:8448
 v_mfma_f32_16x16x32_bf16 v[184:187], v[88:91], a[232:235], v[184:187]
 s_waitcnt lgkmcnt(4)
 v_exp_f32 v48, v48
 v_mfma_f32_16x16x32_bf16 v[180:183], v[80:83], a[236:239], v[180:183]
 v_exp_f32 v49, v49
 v_mfma_f32_16x16x32_bf16 v[188:191], v[88:91], a[236:239], v[188:191]
 v_fma_f32 v50, v50, s22, v18
 v_fma_f32 v51, v51, s22, v18
 v_mfma_f32_16x16x32_bf16 v[160:163], v[64:67], a[232:235], v[160:163]
 v_exp_f32 v50, v50
 v_mfma_f32_16x16x32_bf16 v[168:171], v[72:75], a[232:235], v[168:171]
 s_add_u32 m0, s21, 61440
 ds_read_b64_tr_b16 a[232:233], v3 offset:2560
 v_fma_f32 v52, v52, s22, v18
 v_mfma_f32_16x16x32_bf16 v[164:167], v[64:67], a[236:239], v[164:167]
 buffer_load_dwordx4 v8, s[8:11], s25 offen lds
 ds_read_b64_tr_b16 a[234:235], v3 offset:8704
 v_mfma_f32_16x16x32_bf16 v[172:175], v[72:75], a[236:239], v[172:175]
 s_waitcnt lgkmcnt(3)
 ds_read_b64_tr_b16 a[236:237], v3 offset:2816
 s_sub_u32 s25, s25, 896
 v_mfma_f32_16x16x32_bf16 v[192:195], v[64:67], a[224:227], v[192:195]
 ds_read_b64_tr_b16 a[238:239], v3 offset:8960
 v_fma_f32 v53, v53, s22, v18
 v_mfma_f32_16x16x32_bf16 v[200:203], v[72:75], a[224:227], v[200:203]
 s_waitcnt lgkmcnt(4)
 v_exp_f32 v51, v51
 v_mfma_f32_16x16x32_bf16 v[196:199], v[64:67], a[228:231], v[196:199]
 v_exp_f32 v52, v52
 v_mfma_f32_16x16x32_bf16 v[204:207], v[72:75], a[228:231], v[204:207]
 v_exp_f32 v53, v53
 v_mfma_f32_16x16x32_bf16 v[208:211], v[80:83], a[224:227], v[208:211]
 buffer_load_dwordx4 v8, s[8:11], s25 offen offset:1024 lds
 v_mfma_f32_16x16x32_bf16 v[216:219], v[88:91], a[224:227], v[216:219]
 s_sub_u32 s25, s25, 896
 ds_read_b128 a[224:227], v1 offset:24576
 v_fma_f32 v54, v54, s22, v18
 v_mfma_f32_16x16x32_bf16 v[212:215], v[80:83], a[228:231], v[212:215]
 v_exp_f32 v54, v54
 v_mfma_f32_16x16x32_bf16 v[220:223], v[88:91], a[228:231], v[220:223]
 s_waitcnt lgkmcnt(3)
 ds_read_b128 a[228:231], v1 offset:25088
 v_fma_f32 v55, v55, s22, v18
 v_mfma_f32_16x16x32_bf16 v[240:243], v[80:83], a[232:235], v[240:243]
 v_exp_f32 v55, v55
 v_mfma_f32_16x16x32_bf16 v[248:251], v[88:91], a[232:235], v[248:251]
 s_waitcnt lgkmcnt(2)
 v_fma_f32 v56, v56, s22, v19
 v_fma_f32 v57, v57, s22, v19
 v_mfma_f32_16x16x32_bf16 v[244:247], v[80:83], a[236:239], v[244:247]
 buffer_load_dwordx4 v8, s[8:11], s25 offen offset:2048 lds
 v_mfma_f32_16x16x32_bf16 v[252:255], v[88:91], a[236:239], v[252:255]
 v_exp_f32 v56, v56
 v_mfma_f32_16x16x32_bf16 v[224:227], v[64:67], a[232:235], v[224:227]
 v_exp_f32 v57, v57
 v_mfma_f32_16x16x32_bf16 v[232:235], v[72:75], a[232:235], v[232:235]
 ds_read_b128 a[232:235], v1 offset:25600
 v_cvt_pk_bf16_f32 v48, v48, v49
 v_mfma_f32_16x16x32_bf16 v[228:231], v[64:67], a[236:239], v[228:231]
 v_fma_f32 v58, v58, s22, v19
 v_fma_f32 v59, v59, s22, v19
 v_mfma_f32_16x16x32_bf16 v[236:239], v[72:75], a[236:239], v[236:239]
 s_waitcnt lgkmcnt(2)
 ds_read_b128 a[236:239], v1 offset:26112
 v_cvt_pk_bf16_f32 v49, v50, v51
 v_mfma_f32_16x16x32_bf16 v[88:91], a[224:227], a[12:15], 0
 s_waitcnt lgkmcnt(2)
 v_exp_f32 v58, v58
 v_mfma_f32_16x16x32_bf16 v[88:91], a[228:231], a[28:31], v[88:91]
 v_exp_f32 v59, v59
 v_mfma_f32_16x16x32_bf16 v[80:83], a[224:227], a[8:11], 0
 v_fma_f32 v60, v60, s22, v19
 v_fma_f32 v61, v61, s22, v19
 v_mfma_f32_16x16x32_bf16 v[80:83], a[228:231], a[24:27], v[80:83]
 v_exp_f32 v60, v60
 v_mfma_f32_16x16x32_bf16 v[72:75], a[224:227], a[4:7], 0
 buffer_store_dwordx4 a[164:167], v10, s[16:19], s51 offen offset:256 nt
 v_mfma_f32_16x16x32_bf16 v[72:75], a[228:231], a[20:23], v[72:75]
 v_exp_f32 v61, v61
 v_mfma_f32_16x16x32_bf16 v[64:67], a[224:227], a[0:3], 0
 ds_read_b128 a[224:227], v1 offset:26624
 v_fma_f32 v62, v62, s22, v19
 v_mfma_f32_16x16x32_bf16 v[64:67], a[228:231], a[16:19], v[64:67]
 s_waitcnt lgkmcnt(1)
 ds_read_b128 a[228:231], v1 offset:27136
 v_fma_f32 v63, v63, s22, v19
 v_mfma_f32_16x16x32_bf16 v[64:67], a[232:235], a[32:35], v[64:67]
 v_exp_f32 v62, v62
 v_mfma_f32_16x16x32_bf16 v[64:67], a[236:239], a[48:51], v[64:67]
 v_exp_f32 v63, v63
 v_mfma_f32_16x16x32_bf16 v[72:75], a[232:235], a[36:39], v[72:75]
 v_cvt_pk_bf16_f32 v50, v52, v53
 v_cvt_pk_bf16_f32 v51, v54, v55
 v_mfma_f32_16x16x32_bf16 v[72:75], a[236:239], a[52:55], v[72:75]
 v_cvt_pk_bf16_f32 v56, v56, v57
 v_cvt_pk_bf16_f32 v57, v58, v59
 v_mfma_f32_16x16x32_bf16 v[80:83], a[232:235], a[40:43], v[80:83]
 v_cvt_pk_bf16_f32 v58, v60, v61
 v_cvt_pk_bf16_f32 v59, v62, v63
 v_mfma_f32_16x16x32_bf16 v[80:83], a[236:239], a[56:59], v[80:83]
 v_mfma_f32_16x16x32_bf16 v[88:91], a[232:235], a[44:47], v[88:91]
 ds_read_b128 a[232:235], v1 offset:32768
 v_mfma_f32_16x16x32_bf16 v[88:91], a[236:239], a[60:63], v[88:91]
 s_waitcnt lgkmcnt(2)
 ds_read_b128 a[236:239], v1 offset:33280
 v_mfma_f32_16x16x32_bf16 v[88:91], a[224:227], a[76:79], v[88:91]
 s_waitcnt lgkmcnt(2)
 v_mfma_f32_16x16x32_bf16 v[88:91], a[228:231], a[92:95], v[88:91]
 v_mfma_f32_16x16x32_bf16 v[80:83], a[224:227], a[72:75], v[80:83]
 v_mfma_f32_16x16x32_bf16 v[80:83], a[228:231], a[88:91], v[80:83]
 v_mfma_f32_16x16x32_bf16 v[72:75], a[224:227], a[68:71], v[72:75]
 v_mfma_f32_16x16x32_bf16 v[72:75], a[228:231], a[84:87], v[72:75]
 v_mfma_f32_16x16x32_bf16 v[64:67], a[224:227], a[64:67], v[64:67]
 ds_read_b128 a[224:227], v1 offset:31744
 v_mfma_f32_16x16x32_bf16 v[64:67], a[228:231], a[80:83], v[64:67]
 s_waitcnt lgkmcnt(2)
 ds_read_b128 a[228:231], v1 offset:32256
 v_mfma_f32_16x16x32_bf16 v[68:71], a[232:235], a[64:67], 0
 s_waitcnt lgkmcnt(2)
 v_mfma_f32_16x16x32_bf16 v[68:71], a[236:239], a[80:83], v[68:71]
 v_mfma_f32_16x16x32_bf16 v[76:79], a[232:235], a[68:71], 0
 v_mfma_f32_16x16x32_bf16 v[76:79], a[236:239], a[84:87], v[76:79]
 v_mfma_f32_16x16x32_bf16 v[84:87], a[232:235], a[72:75], 0
 v_mfma_f32_16x16x32_bf16 v[84:87], a[236:239], a[88:91], v[84:87]
 v_mfma_f32_16x16x32_bf16 v[92:95], a[232:235], a[76:79], 0
 ds_read_b128 a[232:235], v1 offset:30720
 v_fma_f32 v64, v64, s22, v16
 v_mfma_f32_16x16x32_bf16 v[92:95], a[236:239], a[92:95], v[92:95]
 s_waitcnt lgkmcnt(2)
 ds_read_b128 a[236:239], v1 offset:31232
 v_fma_f32 v65, v65, s22, v16
 v_mfma_f32_16x16x32_bf16 v[92:95], a[224:227], a[44:47], v[92:95]
 s_waitcnt lgkmcnt(2)
 v_exp_f32 v64, v64
 v_mfma_f32_16x16x32_bf16 v[92:95], a[228:231], a[60:63], v[92:95]
 v_exp_f32 v65, v65
 v_mfma_f32_16x16x32_bf16 v[84:87], a[224:227], a[40:43], v[84:87]
 v_fma_f32 v66, v66, s22, v16
 v_fma_f32 v67, v67, s22, v16
 v_mfma_f32_16x16x32_bf16 v[84:87], a[228:231], a[56:59], v[84:87]
 v_exp_f32 v66, v66
 v_mfma_f32_16x16x32_bf16 v[76:79], a[224:227], a[36:39], v[76:79]
 v_exp_f32 v67, v67
 v_mfma_f32_16x16x32_bf16 v[76:79], a[228:231], a[52:55], v[76:79]
 v_fma_f32 v72, v72, s22, v17
 v_fma_f32 v73, v73, s22, v17
 v_mfma_f32_16x16x32_bf16 v[68:71], a[224:227], a[32:35], v[68:71]
 ds_read_b64_tr_b16 a[224:225], v3 offset:12288
 v_cvt_pk_bf16_f32 v64, v64, v65
 v_mfma_f32_16x16x32_bf16 v[68:71], a[228:231], a[48:51], v[68:71]
 s_waitcnt lgkmcnt(2)
 ds_read_b64_tr_b16 a[226:227], v3 offset:18432
 v_fma_f32 v74, v74, s22, v17
 v_mfma_f32_16x16x32_bf16 v[68:71], a[232:235], a[0:3], v[68:71]
 s_waitcnt lgkmcnt(2)
 ds_read_b64_tr_b16 a[228:229], v3 offset:12544
 v_fma_f32 v75, v75, s22, v17
 v_mfma_f32_16x16x32_bf16 v[68:71], a[236:239], a[16:19], v[68:71]
 ds_read_b64_tr_b16 a[230:231], v3 offset:18688
 v_cvt_pk_bf16_f32 v65, v66, v67
 v_mfma_f32_16x16x32_bf16 v[76:79], a[232:235], a[4:7], v[76:79]
 s_waitcnt vmcnt(40)
 ds_read_b128 a[144:147], v11 offset:32768
 ds_read_b128 a[148:151], v11 offset:33280
 v_mfma_f32_16x16x32_bf16 v[76:79], a[236:239], a[20:23], v[76:79]
 v_exp_f32 v72, v72
 v_mfma_f32_16x16x32_bf16 v[84:87], a[232:235], a[8:11], v[84:87]
 v_exp_f32 v73, v73
 v_mfma_f32_16x16x32_bf16 v[84:87], a[236:239], a[24:27], v[84:87]
 v_exp_f32 v74, v74
 v_mfma_f32_16x16x32_bf16 v[92:95], a[232:235], a[12:15], v[92:95]
 ds_read_b64_tr_b16 a[232:233], v3 offset:12800
 v_fma_f32 v68, v68, s22, v16
 v_mfma_f32_16x16x32_bf16 v[92:95], a[236:239], a[28:31], v[92:95]
 ds_read_b64_tr_b16 a[234:235], v3 offset:18944
 v_fma_f32 v69, v69, s22, v16
 v_mfma_f32_16x16x32_bf16 v[28:31], a[240:243], v[32:35], v[28:31]
 ds_read_b64_tr_b16 a[236:237], v3 offset:13056
 v_fma_f32 v70, v70, s22, v16
 v_mfma_f32_16x16x32_bf16 a[244:247], a[240:243], v[40:43], a[244:247]
 s_waitcnt lgkmcnt(6)
 ds_read_b64_tr_b16 a[238:239], v3 offset:19200
 v_fma_f32 v71, v71, s22, v16
 v_mfma_f32_16x16x32_bf16 v[96:99], v[32:35], a[224:227], v[96:99]
 v_exp_f32 v68, v68
 v_mfma_f32_16x16x32_bf16 v[104:107], v[40:43], a[224:227], v[104:107]
 s_waitcnt lgkmcnt(4)
 v_exp_f32 v69, v69
 v_mfma_f32_16x16x32_bf16 v[100:103], v[32:35], a[228:231], v[100:103]
 v_exp_f32 v70, v70
 v_mfma_f32_16x16x32_bf16 v[108:111], v[40:43], a[228:231], v[108:111]
 s_add_u32 m0, s34, 32768
 v_exp_f32 v71, v71
 v_mfma_f32_16x16x32_bf16 a[192:195], v[48:51], a[224:227], a[192:195]
 buffer_load_dwordx4 v4, s[12:15], s52 offen nt lds
 v_mfma_f32_16x16x32_bf16 a[200:203], v[56:59], a[224:227], a[200:203]
 s_add_u32 m0, s34, 33792
 ds_read_b64_tr_b16 a[224:225], v3 offset:13312
 s_add_u32 s20, s20, 24981504
 v_mfma_f32_16x16x32_bf16 a[196:199], v[48:51], a[228:231], a[196:199]
 buffer_load_dwordx4 v4, s[12:15], s53 offen nt lds
 v_mfma_f32_16x16x32_bf16 a[204:207], v[56:59], a[228:231], a[204:207]
 ds_read_b64_tr_b16 a[226:227], v3 offset:19456
 v_fma_f32 v76, v76, s22, v17
 v_mfma_f32_16x16x32_bf16 a[248:251], a[240:243], v[48:51], a[248:251]
 ds_read_b64_tr_b16 a[228:229], v3 offset:13568
 v_fma_f32 v77, v77, s22, v17
 v_mfma_f32_16x16x32_bf16 a[252:255], a[240:243], v[56:59], a[252:255]
 s_waitcnt lgkmcnt(3)
 ds_read_b64_tr_b16 a[230:231], v3 offset:19712
 v_fma_f32 v78, v78, s22, v17
 v_mfma_f32_16x16x32_bf16 a[208:211], v[48:51], a[232:235], a[208:211]
 s_waitcnt vmcnt(18)
 s_barrier
 v_fma_f32 v79, v79, s22, v17
 v_mfma_f32_16x16x32_bf16 a[216:219], v[56:59], a[232:235], a[216:219]
 v_exp_f32 v75, v75
 v_mfma_f32_16x16x32_bf16 a[212:215], v[48:51], a[236:239], a[212:215]
 v_exp_f32 v76, v76
 v_mfma_f32_16x16x32_bf16 a[220:223], v[56:59], a[236:239], a[220:223]
 s_add_u32 m0, s21, 0
 s_add_u32 s25, s25, 24983296
 v_cvt_pk_bf16_f32 v66, v68, v69
 v_mfma_f32_16x16x32_bf16 v[112:115], v[32:35], a[232:235], v[112:115]
 buffer_load_dwordx4 v4, s[4:7], s20 offen lds
 v_mfma_f32_16x16x32_bf16 v[120:123], v[40:43], a[232:235], v[120:123]
 ds_read_b64_tr_b16 a[232:233], v3 offset:13824
 v_cvt_pk_bf16_f32 v67, v70, v71
 v_mfma_f32_16x16x32_bf16 v[116:119], v[32:35], a[236:239], v[116:119]
 ds_read_b64_tr_b16 a[234:235], v3 offset:19968
 v_cvt_pk_bf16_f32 v72, v72, v73
 v_mfma_f32_16x16x32_bf16 v[124:127], v[40:43], a[236:239], v[124:127]
 s_waitcnt lgkmcnt(3)
 ds_read_b64_tr_b16 a[236:237], v3 offset:14080
 v_cvt_pk_bf16_f32 v73, v74, v75
 v_mfma_f32_16x16x32_bf16 v[128:131], v[32:35], a[224:227], v[128:131]
 ds_read_b64_tr_b16 a[238:239], v3 offset:20224
 v_fma_f32 v80, v80, s22, v18
 v_mfma_f32_16x16x32_bf16 v[136:139], v[40:43], a[224:227], v[136:139]
 s_waitcnt lgkmcnt(4)
 v_exp_f32 v77, v77
 v_mfma_f32_16x16x32_bf16 v[132:135], v[32:35], a[228:231], v[132:135]
 buffer_load_dwordx4 v5, s[4:7], s20 offen offset:1024 lds
 v_mfma_f32_16x16x32_bf16 v[140:143], v[40:43], a[228:231], v[140:143]
 v_exp_f32 v78, v78
 v_mfma_f32_16x16x32_bf16 v[144:147], v[48:51], a[224:227], v[144:147]
 v_exp_f32 v79, v79
 v_mfma_f32_16x16x32_bf16 v[152:155], v[56:59], a[224:227], v[152:155]
 ds_read_b64_tr_b16 a[224:225], v3 offset:14336
 v_cvt_pk_bf16_f32 v74, v76, v77
 v_mfma_f32_16x16x32_bf16 v[148:151], v[48:51], a[228:231], v[148:151]
 ds_read_b64_tr_b16 a[226:227], v3 offset:20480
 v_cvt_pk_bf16_f32 v75, v78, v79
 v_mfma_f32_16x16x32_bf16 v[156:159], v[56:59], a[228:231], v[156:159]
 s_waitcnt lgkmcnt(4)
 ds_read_b64_tr_b16 a[228:229], v3 offset:14592
 v_fma_f32 v81, v81, s22, v18
 v_mfma_f32_16x16x32_bf16 v[176:179], v[48:51], a[232:235], v[176:179]
 buffer_load_dwordx4 v6, s[4:7], s20 offen offset:2048 lds
 ds_read_b64_tr_b16 a[230:231], v3 offset:20736
 v_mfma_f32_16x16x32_bf16 v[184:187], v[56:59], a[232:235], v[184:187]
 s_waitcnt lgkmcnt(4)
 v_exp_f32 v80, v80
 v_mfma_f32_16x16x32_bf16 v[180:183], v[48:51], a[236:239], v[180:183]
 v_exp_f32 v81, v81
 v_mfma_f32_16x16x32_bf16 v[188:191], v[56:59], a[236:239], v[188:191]
 v_fma_f32 v82, v82, s22, v18
 v_fma_f32 v83, v83, s22, v18
 v_mfma_f32_16x16x32_bf16 v[160:163], v[32:35], a[232:235], v[160:163]
 v_exp_f32 v82, v82
 v_mfma_f32_16x16x32_bf16 v[168:171], v[40:43], a[232:235], v[168:171]
 s_add_u32 m0, s21, 36864
 ds_read_b64_tr_b16 a[232:233], v3 offset:14848
 v_fma_f32 v84, v84, s22, v18
 v_mfma_f32_16x16x32_bf16 v[164:167], v[32:35], a[236:239], v[164:167]
 buffer_load_dwordx4 v8, s[8:11], s25 offen nt lds
 ds_read_b64_tr_b16 a[234:235], v3 offset:20992
 v_mfma_f32_16x16x32_bf16 v[172:175], v[40:43], a[236:239], v[172:175]
 s_waitcnt lgkmcnt(3)
 ds_read_b64_tr_b16 a[236:237], v3 offset:15104
 s_sub_u32 s25, s25, 896
 v_mfma_f32_16x16x32_bf16 v[192:195], v[32:35], a[224:227], v[192:195]
 ds_read_b64_tr_b16 a[238:239], v3 offset:21248
 v_fma_f32 v85, v85, s22, v18
 v_mfma_f32_16x16x32_bf16 v[200:203], v[40:43], a[224:227], v[200:203]
 s_waitcnt lgkmcnt(4)
 v_exp_f32 v83, v83
 v_mfma_f32_16x16x32_bf16 v[196:199], v[32:35], a[228:231], v[196:199]
 v_exp_f32 v84, v84
 v_mfma_f32_16x16x32_bf16 v[204:207], v[40:43], a[228:231], v[204:207]
 v_exp_f32 v85, v85
 v_mfma_f32_16x16x32_bf16 v[208:211], v[48:51], a[224:227], v[208:211]
 buffer_load_dwordx4 v8, s[8:11], s25 offen offset:1024 nt lds
 v_mfma_f32_16x16x32_bf16 v[216:219], v[56:59], a[224:227], v[216:219]
 s_sub_u32 s25, s25, 896
 ds_read_b128 a[224:227], v2 offset:0
 v_fma_f32 v86, v86, s22, v18
 v_mfma_f32_16x16x32_bf16 v[212:215], v[48:51], a[228:231], v[212:215]
 s_add_u32 s20, s20, 12288
 v_exp_f32 v86, v86
 v_mfma_f32_16x16x32_bf16 v[220:223], v[56:59], a[228:231], v[220:223]
 s_waitcnt lgkmcnt(3)
 ds_read_b128 a[228:231], v2 offset:512
 v_fma_f32 v87, v87, s22, v18
 v_mfma_f32_16x16x32_bf16 v[240:243], v[48:51], a[232:235], v[240:243]
 v_exp_f32 v87, v87
 v_mfma_f32_16x16x32_bf16 v[248:251], v[56:59], a[232:235], v[248:251]
 s_waitcnt lgkmcnt(2)
 v_fma_f32 v88, v88, s22, v19
 v_fma_f32 v89, v89, s22, v19
 v_mfma_f32_16x16x32_bf16 v[244:247], v[48:51], a[236:239], v[244:247]
 buffer_load_dwordx4 v8, s[8:11], s25 offen offset:2048 nt lds
 v_mfma_f32_16x16x32_bf16 v[252:255], v[56:59], a[236:239], v[252:255]
 v_exp_f32 v88, v88
 v_mfma_f32_16x16x32_bf16 v[224:227], v[32:35], a[232:235], v[224:227]
 v_exp_f32 v89, v89
 v_mfma_f32_16x16x32_bf16 v[232:235], v[40:43], a[232:235], v[232:235]
 ds_read_b128 a[232:235], v2 offset:1024
 v_cvt_pk_bf16_f32 v80, v80, v81
 v_mfma_f32_16x16x32_bf16 v[228:231], v[32:35], a[236:239], v[228:231]
 v_fma_f32 v90, v90, s22, v19
 v_fma_f32 v91, v91, s22, v19
 v_mfma_f32_16x16x32_bf16 v[236:239], v[40:43], a[236:239], v[236:239]
 s_waitcnt lgkmcnt(2)
 ds_read_b128 a[236:239], v2 offset:1536
 v_cvt_pk_bf16_f32 v81, v82, v83
 v_mfma_f32_16x16x32_bf16 v[56:59], a[224:227], a[12:15], 0
 s_waitcnt lgkmcnt(2)
 v_exp_f32 v90, v90
 v_mfma_f32_16x16x32_bf16 v[56:59], a[228:231], a[28:31], v[56:59]
 v_exp_f32 v91, v91
 v_mfma_f32_16x16x32_bf16 v[48:51], a[224:227], a[8:11], 0
 v_fma_f32 v92, v92, s22, v19
 v_fma_f32 v93, v93, s22, v19
 v_mfma_f32_16x16x32_bf16 v[48:51], a[228:231], a[24:27], v[48:51]
 v_exp_f32 v92, v92
 v_mfma_f32_16x16x32_bf16 v[40:43], a[224:227], a[4:7], 0
 buffer_store_dwordx4 a[168:171], v10, s[16:19], s52 offen offset:256 nt
 v_mfma_f32_16x16x32_bf16 v[40:43], a[228:231], a[20:23], v[40:43]
 v_exp_f32 v93, v93
 v_mfma_f32_16x16x32_bf16 v[32:35], a[224:227], a[0:3], 0
 ds_read_b128 a[224:227], v2 offset:2048
 v_fma_f32 v94, v94, s22, v19
 v_mfma_f32_16x16x32_bf16 v[32:35], a[228:231], a[16:19], v[32:35]
 s_waitcnt lgkmcnt(1)
 ds_read_b128 a[228:231], v2 offset:2560
 v_fma_f32 v95, v95, s22, v19
 v_mfma_f32_16x16x32_bf16 v[32:35], a[232:235], a[32:35], v[32:35]
 v_exp_f32 v94, v94
 v_mfma_f32_16x16x32_bf16 v[32:35], a[236:239], a[48:51], v[32:35]
 v_exp_f32 v95, v95
 v_mfma_f32_16x16x32_bf16 v[40:43], a[232:235], a[36:39], v[40:43]
 v_cvt_pk_bf16_f32 v82, v84, v85
 v_cvt_pk_bf16_f32 v83, v86, v87
 v_mfma_f32_16x16x32_bf16 v[40:43], a[236:239], a[52:55], v[40:43]
 v_cvt_pk_bf16_f32 v88, v88, v89
 v_cvt_pk_bf16_f32 v89, v90, v91
 v_mfma_f32_16x16x32_bf16 v[48:51], a[232:235], a[40:43], v[48:51]
 v_cvt_pk_bf16_f32 v90, v92, v93
 v_cvt_pk_bf16_f32 v91, v94, v95
 v_mfma_f32_16x16x32_bf16 v[48:51], a[236:239], a[56:59], v[48:51]
 v_mfma_f32_16x16x32_bf16 v[56:59], a[232:235], a[44:47], v[56:59]
 ds_read_b128 a[232:235], v2 offset:8192
 v_mfma_f32_16x16x32_bf16 v[56:59], a[236:239], a[60:63], v[56:59]
 s_waitcnt lgkmcnt(2)
 ds_read_b128 a[236:239], v2 offset:8704
 v_mfma_f32_16x16x32_bf16 v[56:59], a[224:227], a[76:79], v[56:59]
 s_waitcnt lgkmcnt(2)
 s_waitcnt vmcnt(40)
 ds_read_b128 a[152:155], v11 offset:0
 v_mfma_f32_16x16x32_bf16 v[56:59], a[228:231], a[92:95], v[56:59]
 ds_read_b128 a[156:159], v11 offset:512
 v_mfma_f32_16x16x32_bf16 v[48:51], a[224:227], a[72:75], v[48:51]
 v_mfma_f32_16x16x32_bf16 v[48:51], a[228:231], a[88:91], v[48:51]
 v_mfma_f32_16x16x32_bf16 v[40:43], a[224:227], a[68:71], v[40:43]
 v_mfma_f32_16x16x32_bf16 v[40:43], a[228:231], a[84:87], v[40:43]
 v_mfma_f32_16x16x32_bf16 v[32:35], a[224:227], a[64:67], v[32:35]
 ds_read_b128 a[224:227], v2 offset:7168
 v_mfma_f32_16x16x32_bf16 v[32:35], a[228:231], a[80:83], v[32:35]
 s_waitcnt lgkmcnt(4)
 ds_read_b128 a[228:231], v2 offset:7680
 v_mfma_f32_16x16x32_bf16 v[36:39], a[232:235], a[64:67], 0
 s_waitcnt lgkmcnt(4)
 v_mfma_f32_16x16x32_bf16 v[36:39], a[236:239], a[80:83], v[36:39]
 v_mfma_f32_16x16x32_bf16 v[44:47], a[232:235], a[68:71], 0
 s_waitcnt vmcnt(31)
 ds_read_b128 a[160:163], v11 offset:8192
 ds_read_b128 a[164:167], v11 offset:8704
 v_mfma_f32_16x16x32_bf16 v[44:47], a[236:239], a[84:87], v[44:47]
 v_mfma_f32_16x16x32_bf16 v[52:55], a[232:235], a[72:75], 0
 v_mfma_f32_16x16x32_bf16 v[52:55], a[236:239], a[88:91], v[52:55]
 v_mfma_f32_16x16x32_bf16 v[60:63], a[232:235], a[76:79], 0
 buffer_store_dwordx4 a[172:175], v10, s[16:19], s53 offen offset:256 nt
 ds_read_b128 a[232:235], v2 offset:6144
 v_mfma_f32_16x16x32_bf16 v[60:63], a[236:239], a[92:95], v[60:63]
 s_waitcnt lgkmcnt(3)
 ds_read_b128 a[236:239], v2 offset:6656
 v_fma_f32 v32, v32, s22, v16
 v_mfma_f32_16x16x32_bf16 v[60:63], a[224:227], a[44:47], v[60:63]
 v_exp_f32 v32, v32
 v_mfma_f32_16x16x32_bf16 v[60:63], a[228:231], a[60:63], v[60:63]
 v_fma_f32 v33, v33, s22, v16
 v_fma_f32 v40, v40, s22, v17
 v_mfma_f32_16x16x32_bf16 v[52:55], a[224:227], a[40:43], v[52:55]
 v_exp_f32 v33, v33
 v_mfma_f32_16x16x32_bf16 v[52:55], a[228:231], a[56:59], v[52:55]
 v_exp_f32 v40, v40
 v_mfma_f32_16x16x32_bf16 v[44:47], a[224:227], a[36:39], v[44:47]
 v_fma_f32 v41, v41, s22, v17
 v_fma_f32 v34, v34, s22, v16
 v_mfma_f32_16x16x32_bf16 v[44:47], a[228:231], a[52:55], v[44:47]
 v_exp_f32 v41, v41
 v_mfma_f32_16x16x32_bf16 v[36:39], a[224:227], a[32:35], v[36:39]
 ds_read_b64_tr_b16 a[224:225], v13 offset:0
 v_fma_f32 v35, v35, s22, v16
 v_mfma_f32_16x16x32_bf16 v[36:39], a[228:231], a[48:51], v[36:39]
 s_waitcnt lgkmcnt(2)
 ds_read_b64_tr_b16 a[226:227], v13 offset:6144
 v_fma_f32 v42, v42, s22, v17
 v_mfma_f32_16x16x32_bf16 v[36:39], a[232:235], a[0:3], v[36:39]
 s_waitcnt lgkmcnt(2)
 ds_read_b64_tr_b16 a[228:229], v13 offset:256
 v_fma_f32 v43, v43, s22, v17
 v_mfma_f32_16x16x32_bf16 v[36:39], a[236:239], a[16:19], v[36:39]
 ds_read_b64_tr_b16 a[230:231], v13 offset:6400
 v_cvt_pk_bf16_f32 v32, v32, v33
 v_mfma_f32_16x16x32_bf16 v[44:47], a[232:235], a[4:7], v[44:47]
 v_exp_f32 v34, v34
 v_mfma_f32_16x16x32_bf16 v[44:47], a[236:239], a[20:23], v[44:47]
 v_exp_f32 v35, v35
 v_mfma_f32_16x16x32_bf16 v[52:55], a[232:235], a[8:11], v[52:55]
 v_exp_f32 v42, v42
 v_mfma_f32_16x16x32_bf16 v[52:55], a[236:239], a[24:27], v[52:55]
 v_exp_f32 v43, v43
 v_mfma_f32_16x16x32_bf16 v[60:63], a[232:235], a[12:15], v[60:63]
 ds_read_b64_tr_b16 a[232:233], v13 offset:512
 v_fma_f32 v36, v36, s22, v16
 v_mfma_f32_16x16x32_bf16 v[60:63], a[236:239], a[28:31], v[60:63]
 ds_read_b64_tr_b16 a[234:235], v13 offset:6656
 v_fma_f32 v37, v37, s22, v16
 v_mfma_f32_16x16x32_bf16 v[28:31], a[240:243], v[64:67], v[28:31]
 ds_read_b64_tr_b16 a[236:237], v13 offset:768
 v_fma_f32 v38, v38, s22, v16
 v_mfma_f32_16x16x32_bf16 a[244:247], a[240:243], v[72:75], a[244:247]
 s_waitcnt lgkmcnt(4)
 ds_read_b64_tr_b16 a[238:239], v13 offset:6912
 v_fma_f32 v39, v39, s22, v16
 v_mfma_f32_16x16x32_bf16 v[96:99], v[64:67], a[224:227], v[96:99]
 v_exp_f32 v36, v36
 v_mfma_f32_16x16x32_bf16 v[104:107], v[72:75], a[224:227], v[104:107]
 s_waitcnt lgkmcnt(4)
 v_exp_f32 v37, v37
 v_mfma_f32_16x16x32_bf16 v[100:103], v[64:67], a[228:231], v[100:103]
 v_exp_f32 v38, v38
 v_mfma_f32_16x16x32_bf16 v[108:111], v[72:75], a[228:231], v[108:111]
 v_exp_f32 v39, v39
 v_mfma_f32_16x16x32_bf16 a[192:195], v[80:83], a[224:227], a[192:195]
 v_fma_f32 v44, v44, s22, v17
 v_fma_f32 v45, v45, s22, v17
 v_mfma_f32_16x16x32_bf16 a[200:203], v[88:91], a[224:227], a[200:203]
 ds_read_b64_tr_b16 a[224:225], v13 offset:1024
 v_fma_f32 v46, v46, s22, v17
 v_mfma_f32_16x16x32_bf16 a[196:199], v[80:83], a[228:231], a[196:199]
 ds_read_b64_tr_b16 a[226:227], v13 offset:7168
 v_fma_f32 v47, v47, s22, v17
 v_mfma_f32_16x16x32_bf16 a[204:207], v[88:91], a[228:231], a[204:207]
 ds_read_b64_tr_b16 a[228:229], v13 offset:1280
 v_cvt_pk_bf16_f32 v40, v40, v41
 v_mfma_f32_16x16x32_bf16 a[248:251], a[240:243], v[80:83], a[248:251]
 ds_read_b64_tr_b16 a[230:231], v13 offset:7424
 v_cvt_pk_bf16_f32 v33, v34, v35
 v_mfma_f32_16x16x32_bf16 a[252:255], a[240:243], v[88:91], a[252:255]
 s_waitcnt lgkmcnt(4)
 v_exp_f32 v44, v44
 v_mfma_f32_16x16x32_bf16 a[208:211], v[80:83], a[232:235], a[208:211]
 s_waitcnt vmcnt(14)
 s_barrier
 v_cvt_pk_bf16_f32 v41, v42, v43
 v_mfma_f32_16x16x32_bf16 a[216:219], v[88:91], a[232:235], a[216:219]
 v_exp_f32 v45, v45
 v_mfma_f32_16x16x32_bf16 a[212:215], v[80:83], a[236:239], a[212:215]
 v_exp_f32 v46, v46
 v_mfma_f32_16x16x32_bf16 a[220:223], v[88:91], a[236:239], a[220:223]
 s_add_u32 m0, s21, 12288
 v_exp_f32 v47, v47
 v_mfma_f32_16x16x32_bf16 v[112:115], v[64:67], a[232:235], v[112:115]
 s_add_u32 s25, s25, 14080
 buffer_load_dwordx4 v4, s[4:7], s20 offen nt lds
 v_mfma_f32_16x16x32_bf16 v[120:123], v[72:75], a[232:235], v[120:123]
 ds_read_b64_tr_b16 a[232:233], v13 offset:1536
 v_fma_f32 v48, v48, s22, v18
 v_mfma_f32_16x16x32_bf16 v[116:119], v[64:67], a[236:239], v[116:119]
 ds_read_b64_tr_b16 a[234:235], v13 offset:7680
 v_fma_f32 v49, v49, s22, v18
 v_mfma_f32_16x16x32_bf16 v[124:127], v[72:75], a[236:239], v[124:127]
 s_waitcnt lgkmcnt(2)
 ds_read_b64_tr_b16 a[236:237], v13 offset:1792
 v_fma_f32 v50, v50, s22, v18
 v_mfma_f32_16x16x32_bf16 v[128:131], v[64:67], a[224:227], v[128:131]
 ds_read_b64_tr_b16 a[238:239], v13 offset:7936
 v_fma_f32 v51, v51, s22, v18
 v_mfma_f32_16x16x32_bf16 v[136:139], v[72:75], a[224:227], v[136:139]
 v_fma_f32 v52, v52, s22, v18
 v_fma_f32 v53, v53, s22, v18
 v_mfma_f32_16x16x32_bf16 v[132:135], v[64:67], a[228:231], v[132:135]
 buffer_load_dwordx4 v5, s[4:7], s20 offen offset:1024 nt lds
 v_mfma_f32_16x16x32_bf16 v[140:143], v[72:75], a[228:231], v[140:143]
 v_fma_f32 v54, v54, s22, v18
 v_fma_f32 v55, v55, s22, v18
 v_mfma_f32_16x16x32_bf16 v[144:147], v[80:83], a[224:227], v[144:147]
 v_fma_f32 v56, v56, s22, v19
 v_fma_f32 v57, v57, s22, v19
 v_mfma_f32_16x16x32_bf16 v[152:155], v[88:91], a[224:227], v[152:155]
 ds_read_b64_tr_b16 a[224:225], v13 offset:2048
 v_fma_f32 v58, v58, s22, v19
 v_mfma_f32_16x16x32_bf16 v[148:151], v[80:83], a[228:231], v[148:151]
 ds_read_b64_tr_b16 a[226:227], v13 offset:8192
 v_fma_f32 v59, v59, s22, v19
 v_mfma_f32_16x16x32_bf16 v[156:159], v[88:91], a[228:231], v[156:159]
 s_waitcnt lgkmcnt(4)
 ds_read_b64_tr_b16 a[228:229], v13 offset:2304
 v_fma_f32 v60, v60, s22, v19
 v_mfma_f32_16x16x32_bf16 v[176:179], v[80:83], a[232:235], v[176:179]
 buffer_load_dwordx4 v6, s[4:7], s20 offen offset:2048 nt lds
 ds_read_b64_tr_b16 a[230:231], v13 offset:8448
 v_mfma_f32_16x16x32_bf16 v[184:187], v[88:91], a[232:235], v[184:187]
 s_waitcnt lgkmcnt(4)
 v_fma_f32 v61, v61, s22, v19
 v_fma_f32 v62, v62, s22, v19
 v_mfma_f32_16x16x32_bf16 v[180:183], v[80:83], a[236:239], v[180:183]
 v_fma_f32 v63, v63, s22, v19
 v_cvt_pk_bf16_f32 v34, v36, v37
 v_mfma_f32_16x16x32_bf16 v[188:191], v[88:91], a[236:239], v[188:191]
 v_cvt_pk_bf16_f32 v35, v38, v39
 v_cvt_pk_bf16_f32 v42, v44, v45
 v_mfma_f32_16x16x32_bf16 v[160:163], v[64:67], a[232:235], v[160:163]
 v_cvt_pk_bf16_f32 v43, v46, v47
 v_mfma_f32_16x16x32_bf16 v[168:171], v[72:75], a[232:235], v[168:171]
 s_add_u32 m0, s21, 49152
 ds_read_b64_tr_b16 a[232:233], v13 offset:2560
 v_mfma_f32_16x16x32_bf16 v[164:167], v[64:67], a[236:239], v[164:167]
 buffer_load_dwordx4 v8, s[8:11], s25 offen lds
 ds_read_b64_tr_b16 a[234:235], v13 offset:8704
 v_mfma_f32_16x16x32_bf16 v[172:175], v[72:75], a[236:239], v[172:175]
 s_waitcnt lgkmcnt(3)
 ds_read_b64_tr_b16 a[236:237], v13 offset:2816
 s_sub_u32 s25, s25, 896
 v_mfma_f32_16x16x32_bf16 v[192:195], v[64:67], a[224:227], v[192:195]
 ds_read_b64_tr_b16 a[238:239], v13 offset:8960
 v_mfma_f32_16x16x32_bf16 v[200:203], v[72:75], a[224:227], v[200:203]
 s_waitcnt lgkmcnt(4)
 v_mfma_f32_16x16x32_bf16 v[196:199], v[64:67], a[228:231], v[196:199]
 v_mfma_f32_16x16x32_bf16 v[204:207], v[72:75], a[228:231], v[204:207]
 v_mfma_f32_16x16x32_bf16 v[208:211], v[80:83], a[224:227], v[208:211]
 buffer_load_dwordx4 v8, s[8:11], s25 offen offset:1024 lds
 v_mfma_f32_16x16x32_bf16 v[216:219], v[88:91], a[224:227], v[216:219]
 s_sub_u32 s25, s25, 896
 ds_read_b128 a[224:227], v2 offset:24576
 v_mfma_f32_16x16x32_bf16 v[212:215], v[80:83], a[228:231], v[212:215]
 v_mfma_f32_16x16x32_bf16 v[220:223], v[88:91], a[228:231], v[220:223]
 s_waitcnt lgkmcnt(3)
 ds_read_b128 a[228:231], v2 offset:25088
 v_mfma_f32_16x16x32_bf16 v[240:243], v[80:83], a[232:235], v[240:243]
 v_mfma_f32_16x16x32_bf16 v[248:251], v[88:91], a[232:235], v[248:251]
 s_waitcnt lgkmcnt(2)
 v_mfma_f32_16x16x32_bf16 v[244:247], v[80:83], a[236:239], v[244:247]
 buffer_load_dwordx4 v8, s[8:11], s25 offen offset:2048 lds
 v_mfma_f32_16x16x32_bf16 v[252:255], v[88:91], a[236:239], v[252:255]
 v_mfma_f32_16x16x32_bf16 v[224:227], v[64:67], a[232:235], v[224:227]
 v_mfma_f32_16x16x32_bf16 v[232:235], v[72:75], a[232:235], v[232:235]
 ds_read_b128 a[232:235], v2 offset:25600
 v_mfma_f32_16x16x32_bf16 v[228:231], v[64:67], a[236:239], v[228:231]
 v_mfma_f32_16x16x32_bf16 v[236:239], v[72:75], a[236:239], v[236:239]
 s_cmp_eq_u32 s3, 3
 s_cbranch_scc1 L_tail
 ds_read_b128 a[236:239], v2 offset:26112
 s_waitcnt lgkmcnt(2)
 v_mfma_f32_16x16x32_bf16 v[88:91], a[224:227], a[12:15], 0
 s_add_u32 s20, s20, 12288
 v_exp_f32 v48, v48
 v_mfma_f32_16x16x32_bf16 v[88:91], a[228:231], a[28:31], v[88:91]
 v_exp_f32 v49, v49
 v_mfma_f32_16x16x32_bf16 v[80:83], a[224:227], a[8:11], 0
 v_exp_f32 v50, v50
 v_mfma_f32_16x16x32_bf16 v[80:83], a[228:231], a[24:27], v[80:83]
 v_exp_f32 v51, v51
 v_mfma_f32_16x16x32_bf16 v[72:75], a[224:227], a[4:7], 0
 buffer_store_dwordx4 a[176:179], v10, s[16:19], s54 offen offset:256 nt
 v_mfma_f32_16x16x32_bf16 v[72:75], a[228:231], a[20:23], v[72:75]
 v_exp_f32 v52, v52
 v_mfma_f32_16x16x32_bf16 v[64:67], a[224:227], a[0:3], 0
 ds_read_b128 a[224:227], v2 offset:26624
 v_cvt_pk_bf16_f32 v48, v48, v49
 v_mfma_f32_16x16x32_bf16 v[64:67], a[228:231], a[16:19], v[64:67]
 s_waitcnt lgkmcnt(1)
 ds_read_b128 a[228:231], v2 offset:27136
 v_cvt_pk_bf16_f32 v49, v50, v51
 v_mfma_f32_16x16x32_bf16 v[64:67], a[232:235], a[32:35], v[64:67]
 v_exp_f32 v53, v53
 v_mfma_f32_16x16x32_bf16 v[64:67], a[236:239], a[48:51], v[64:67]
 v_exp_f32 v54, v54
 v_mfma_f32_16x16x32_bf16 v[72:75], a[232:235], a[36:39], v[72:75]
 v_exp_f32 v55, v55
 v_mfma_f32_16x16x32_bf16 v[72:75], a[236:239], a[52:55], v[72:75]
 v_exp_f32 v56, v56
 v_mfma_f32_16x16x32_bf16 v[80:83], a[232:235], a[40:43], v[80:83]
 v_exp_f32 v57, v57
 v_mfma_f32_16x16x32_bf16 v[80:83], a[236:239], a[56:59], v[80:83]
 v_exp_f32 v58, v58
 v_mfma_f32_16x16x32_bf16 v[88:91], a[232:235], a[44:47], v[88:91]
 ds_read_b128 a[232:235], v2 offset:32768
 v_cvt_pk_bf16_f32 v50, v52, v53
 v_mfma_f32_16x16x32_bf16 v[88:91], a[236:239], a[60:63], v[88:91]
 s_waitcnt lgkmcnt(2)
 ds_read_b128 a[236:239], v2 offset:33280
 v_cvt_pk_bf16_f32 v51, v54, v55
 v_mfma_f32_16x16x32_bf16 v[88:91], a[224:227], a[76:79], v[88:91]
 s_waitcnt lgkmcnt(2)
 v_exp_f32 v59, v59
 v_mfma_f32_16x16x32_bf16 v[88:91], a[228:231], a[92:95], v[88:91]
 v_exp_f32 v60, v60
 v_mfma_f32_16x16x32_bf16 v[80:83], a[224:227], a[72:75], v[80:83]
 v_exp_f32 v61, v61
 v_mfma_f32_16x16x32_bf16 v[80:83], a[228:231], a[88:91], v[80:83]
 v_exp_f32 v62, v62
 v_mfma_f32_16x16x32_bf16 v[72:75], a[224:227], a[68:71], v[72:75]
 s_waitcnt vmcnt(30)
 ds_read_b128 a[168:171], v11 offset:16384
 ds_read_b128 a[172:175], v11 offset:16896
 v_mfma_f32_16x16x32_bf16 v[72:75], a[228:231], a[84:87], v[72:75]
 v_exp_f32 v63, v63
 v_mfma_f32_16x16x32_bf16 v[64:67], a[224:227], a[64:67], v[64:67]
 ds_read_b128 a[224:227], v2 offset:31744
 v_cvt_pk_bf16_f32 v56, v56, v57
 v_mfma_f32_16x16x32_bf16 v[64:67], a[228:231], a[80:83], v[64:67]
 s_waitcnt lgkmcnt(4)
 ds_read_b128 a[228:231], v2 offset:32256
 v_cvt_pk_bf16_f32 v57, v58, v59
 v_mfma_f32_16x16x32_bf16 v[68:71], a[232:235], a[64:67], 0
 s_waitcnt lgkmcnt(4)
 v_cvt_pk_bf16_f32 v58, v60, v61
 v_cvt_pk_bf16_f32 v59, v62, v63
 v_mfma_f32_16x16x32_bf16 v[68:71], a[236:239], a[80:83], v[68:71]
 v_mfma_f32_16x16x32_bf16 v[76:79], a[232:235], a[68:71], 0
 v_mfma_f32_16x16x32_bf16 v[76:79], a[236:239], a[84:87], v[76:79]
 v_mfma_f32_16x16x32_bf16 v[84:87], a[232:235], a[72:75], 0
 v_mfma_f32_16x16x32_bf16 v[84:87], a[236:239], a[88:91], v[84:87]
 v_mfma_f32_16x16x32_bf16 v[92:95], a[232:235], a[76:79], 0
 buffer_store_dwordx4 a[180:183], v10, s[16:19], s55 offen offset:256 nt
 s_waitcnt lgkmcnt(1)
 ds_read_b128 a[232:235], v2 offset:30720
 v_mfma_f32_16x16x32_bf16 v[92:95], a[236:239], a[92:95], v[92:95]
 ds_read_b128 a[236:239], v2 offset:31232
 v_accvgpr_mov_b32 a64, a144
 v_mfma_f32_16x16x32_bf16 v[92:95], a[224:227], a[44:47], v[92:95]
 s_waitcnt lgkmcnt(2)
 v_accvgpr_mov_b32 a44, a136
 v_accvgpr_mov_b32 a45, a137
 v_mfma_f32_16x16x32_bf16 v[92:95], a[228:231], a[60:63], v[92:95]
 v_accvgpr_mov_b32 a46, a138
 v_accvgpr_mov_b32 a47, a139
 v_mfma_f32_16x16x32_bf16 v[84:87], a[224:227], a[40:43], v[84:87]
 v_accvgpr_mov_b32 a40, a128
 v_accvgpr_mov_b32 a41, a129
 v_mfma_f32_16x16x32_bf16 v[84:87], a[228:231], a[56:59], v[84:87]
 v_accvgpr_mov_b32 a42, a130
 v_accvgpr_mov_b32 a43, a131
 v_mfma_f32_16x16x32_bf16 v[76:79], a[224:227], a[36:39], v[76:79]
 v_accvgpr_mov_b32 a36, a120
 v_accvgpr_mov_b32 a37, a121
 v_mfma_f32_16x16x32_bf16 v[76:79], a[228:231], a[52:55], v[76:79]
 v_accvgpr_mov_b32 a38, a122
 v_accvgpr_mov_b32 a39, a123
 v_mfma_f32_16x16x32_bf16 v[68:71], a[224:227], a[32:35], v[68:71]
 ds_read_b64_tr_b16 a[224:225], v13 offset:24576
 v_accvgpr_mov_b32 a32, a112
 v_mfma_f32_16x16x32_bf16 v[68:71], a[228:231], a[48:51], v[68:71]
 s_waitcnt lgkmcnt(2)
 ds_read_b64_tr_b16 a[226:227], v13 offset:30720
 v_accvgpr_mov_b32 a33, a113
 v_mfma_f32_16x16x32_bf16 v[68:71], a[232:235], a[0:3], v[68:71]
 s_waitcnt lgkmcnt(2)
 ds_read_b64_tr_b16 a[228:229], v13 offset:24832
 v_accvgpr_mov_b32 a34, a114
 v_mfma_f32_16x16x32_bf16 v[68:71], a[236:239], a[16:19], v[68:71]
 s_waitcnt vmcnt(25)
 ds_read_b64_tr_b16 a[230:231], v13 offset:30976
 v_accvgpr_mov_b32 a35, a115
 v_mfma_f32_16x16x32_bf16 v[76:79], a[232:235], a[4:7], v[76:79]
 ds_read_b128 a[0:3], v11 offset:24576
 ds_read_b128 a[16:19], v11 offset:25088
 v_mfma_f32_16x16x32_bf16 v[76:79], a[236:239], a[20:23], v[76:79]
 v_accvgpr_mov_b32 a48, a116
 v_accvgpr_mov_b32 a49, a117
 v_mfma_f32_16x16x32_bf16 v[84:87], a[232:235], a[8:11], v[84:87]
 v_accvgpr_mov_b32 a8, a96
 v_accvgpr_mov_b32 a9, a97
 v_mfma_f32_16x16x32_bf16 v[84:87], a[236:239], a[24:27], v[84:87]
 v_accvgpr_mov_b32 a10, a98
 v_accvgpr_mov_b32 a11, a99
 v_mfma_f32_16x16x32_bf16 v[92:95], a[232:235], a[12:15], v[92:95]
 ds_read_b64_tr_b16 a[232:233], v13 offset:25088
 v_accvgpr_mov_b32 a12, a104
 v_mfma_f32_16x16x32_bf16 v[92:95], a[236:239], a[28:31], v[92:95]
 ds_read_b64_tr_b16 a[234:235], v13 offset:31232
 v_accvgpr_mov_b32 a13, a105
 v_mfma_f32_16x16x32_bf16 v[28:31], a[240:243], v[32:35], v[28:31]
 ds_read_b64_tr_b16 a[236:237], v13 offset:25344
 v_accvgpr_mov_b32 a14, a106
 v_mfma_f32_16x16x32_bf16 a[244:247], a[240:243], v[40:43], a[244:247]
 s_waitcnt lgkmcnt(6)
 ds_read_b64_tr_b16 a[238:239], v13 offset:31488
 v_accvgpr_mov_b32 a15, a107
 v_mfma_f32_16x16x32_bf16 v[96:99], v[32:35], a[224:227], v[96:99]
 v_accvgpr_mov_b32 a28, a108
 v_accvgpr_mov_b32 a29, a109
 v_mfma_f32_16x16x32_bf16 v[104:107], v[40:43], a[224:227], v[104:107]
 s_waitcnt lgkmcnt(4)
 v_accvgpr_mov_b32 a30, a110
 v_accvgpr_mov_b32 a31, a111
 v_mfma_f32_16x16x32_bf16 v[100:103], v[32:35], a[228:231], v[100:103]
 v_accvgpr_mov_b32 a24, a100
 v_accvgpr_mov_b32 a25, a101
 v_mfma_f32_16x16x32_bf16 v[108:111], v[40:43], a[228:231], v[108:111]
 v_accvgpr_mov_b32 a26, a102
 v_accvgpr_mov_b32 a27, a103
 v_mfma_f32_16x16x32_bf16 a[192:195], v[48:51], a[224:227], a[192:195]
 v_accvgpr_mov_b32 a50, a118
 v_accvgpr_mov_b32 a51, a119
 v_mfma_f32_16x16x32_bf16 a[200:203], v[56:59], a[224:227], a[200:203]
 ds_read_b64_tr_b16 a[224:225], v13 offset:25600
 v_accvgpr_mov_b32 a52, a124
 v_mfma_f32_16x16x32_bf16 a[196:199], v[48:51], a[228:231], a[196:199]
 ds_read_b64_tr_b16 a[226:227], v13 offset:31744
 v_accvgpr_mov_b32 a53, a125
 v_mfma_f32_16x16x32_bf16 a[204:207], v[56:59], a[228:231], a[204:207]
 ds_read_b64_tr_b16 a[228:229], v13 offset:25856
 v_accvgpr_mov_b32 a54, a126
 v_mfma_f32_16x16x32_bf16 a[248:251], a[240:243], v[48:51], a[248:251]
 ds_read_b64_tr_b16 a[230:231], v13 offset:32000
 v_accvgpr_mov_b32 a55, a127
 v_mfma_f32_16x16x32_bf16 a[252:255], a[240:243], v[56:59], a[252:255]
 s_waitcnt lgkmcnt(4)
 v_accvgpr_mov_b32 a56, a132
 v_accvgpr_mov_b32 a57, a133
 v_mfma_f32_16x16x32_bf16 a[208:211], v[48:51], a[232:235], a[208:211]
 s_waitcnt vmcnt(13)
 s_barrier
 v_accvgpr_mov_b32 a58, a134
 v_mfma_f32_16x16x32_bf16 a[216:219], v[56:59], a[232:235], a[216:219]
 v_accvgpr_mov_b32 a59, a135
 v_accvgpr_mov_b32 a60, a140
 v_mfma_f32_16x16x32_bf16 a[212:215], v[48:51], a[236:239], a[212:215]
 v_accvgpr_mov_b32 a61, a141
 v_accvgpr_mov_b32 a62, a142
 v_mfma_f32_16x16x32_bf16 a[220:223], v[56:59], a[236:239], a[220:223]
 s_add_u32 m0, s21, 24576
 v_accvgpr_mov_b32 a63, a143
 v_accvgpr_mov_b32 a65, a145
 v_mfma_f32_16x16x32_bf16 v[112:115], v[32:35], a[232:235], v[112:115]
 s_add_u32 s25, s25, 14080
 buffer_load_dwordx4 v4, s[4:7], s20 offen lds
 v_mfma_f32_16x16x32_bf16 v[120:123], v[40:43], a[232:235], v[120:123]
 ds_read_b64_tr_b16 a[232:233], v13 offset:26112
 v_accvgpr_mov_b32 a66, a146
 v_mfma_f32_16x16x32_bf16 v[116:119], v[32:35], a[236:239], v[116:119]
 ds_read_b64_tr_b16 a[234:235], v13 offset:32256
 v_accvgpr_mov_b32 a67, a147
 v_mfma_f32_16x16x32_bf16 v[124:127], v[40:43], a[236:239], v[124:127]
 s_waitcnt lgkmcnt(2)
 ds_read_b64_tr_b16 a[236:237], v13 offset:26368
 v_accvgpr_mov_b32 a80, a148
 v_mfma_f32_16x16x32_bf16 v[128:131], v[32:35], a[224:227], v[128:131]
 ds_read_b64_tr_b16 a[238:239], v13 offset:32512
 v_accvgpr_mov_b32 a81, a149
 v_mfma_f32_16x16x32_bf16 v[136:139], v[40:43], a[224:227], v[136:139]
 v_accvgpr_mov_b32 a82, a150
 v_accvgpr_mov_b32 a83, a151
 v_mfma_f32_16x16x32_bf16 v[132:135], v[32:35], a[228:231], v[132:135]
 s_waitcnt vmcnt(17)
 buffer_load_dwordx4 v5, s[4:7], s20 offen offset:1024 lds
 v_mfma_f32_16x16x32_bf16 v[140:143], v[40:43], a[228:231], v[140:143]
 ds_read_b128 a[4:7], v11 offset:32768
 ds_read_b128 a[20:23], v11 offset:33280
 v_mfma_f32_16x16x32_bf16 v[144:147], v[48:51], a[224:227], v[144:147]
 v_accvgpr_mov_b32 a68, a152
 v_accvgpr_mov_b32 a69, a153
 v_mfma_f32_16x16x32_bf16 v[152:155], v[56:59], a[224:227], v[152:155]
 ds_read_b64_tr_b16 a[224:225], v13 offset:26624
 v_accvgpr_mov_b32 a70, a154
 v_mfma_f32_16x16x32_bf16 v[148:151], v[48:51], a[228:231], v[148:151]
 ds_read_b64_tr_b16 a[226:227], v13 offset:32768
 v_accvgpr_mov_b32 a71, a155
 v_mfma_f32_16x16x32_bf16 v[156:159], v[56:59], a[228:231], v[156:159]
 s_waitcnt lgkmcnt(6)
 ds_read_b64_tr_b16 a[228:229], v13 offset:26880
 v_accvgpr_mov_b32 a84, a156
 v_mfma_f32_16x16x32_bf16 v[176:179], v[48:51], a[232:235], v[176:179]
 buffer_load_dwordx4 v6, s[4:7], s20 offen offset:2048 lds
 ds_read_b64_tr_b16 a[230:231], v13 offset:33024
 v_mfma_f32_16x16x32_bf16 v[184:187], v[56:59], a[232:235], v[184:187]
 s_waitcnt lgkmcnt(6)
 v_accvgpr_mov_b32 a85, a157
 v_accvgpr_mov_b32 a86, a158
 v_mfma_f32_16x16x32_bf16 v[180:183], v[48:51], a[236:239], v[180:183]
 v_accvgpr_mov_b32 a87, a159
 v_accvgpr_mov_b32 a72, a160
 v_mfma_f32_16x16x32_bf16 v[188:191], v[56:59], a[236:239], v[188:191]
 v_accvgpr_mov_b32 a73, a161
 v_accvgpr_mov_b32 a74, a162
 v_mfma_f32_16x16x32_bf16 v[160:163], v[32:35], a[232:235], v[160:163]
 v_accvgpr_mov_b32 a75, a163
 v_accvgpr_mov_b32 a88, a164
 v_mfma_f32_16x16x32_bf16 v[168:171], v[40:43], a[232:235], v[168:171]
 s_add_u32 m0, s21, 135168
 ds_read_b64_tr_b16 a[232:233], v13 offset:27136
 v_accvgpr_mov_b32 a89, a165
 v_mfma_f32_16x16x32_bf16 v[164:167], v[32:35], a[236:239], v[164:167]
 buffer_load_dwordx4 v8, s[8:11], s25 offen nt lds
 ds_read_b64_tr_b16 a[234:235], v13 offset:33280
 v_mfma_f32_16x16x32_bf16 v[172:175], v[40:43], a[236:239], v[172:175]
 s_waitcnt lgkmcnt(3)
 ds_read_b64_tr_b16 a[236:237], v13 offset:27392
 v_accvgpr_mov_b32 a90, a166
 v_mfma_f32_16x16x32_bf16 v[192:195], v[32:35], a[224:227], v[192:195]
 s_sub_u32 s25, s25, 896
 ds_read_b64_tr_b16 a[238:239], v13 offset:33536
 v_accvgpr_mov_b32 a91, a167
 v_mfma_f32_16x16x32_bf16 v[200:203], v[40:43], a[224:227], v[200:203]
 s_waitcnt lgkmcnt(4)
 v_accvgpr_mov_b32 a76, a168
 v_accvgpr_mov_b32 a77, a169
 v_mfma_f32_16x16x32_bf16 v[196:199], v[32:35], a[228:231], v[196:199]
 v_accvgpr_mov_b32 a78, a170
 v_accvgpr_mov_b32 a79, a171
 v_mfma_f32_16x16x32_bf16 v[204:207], v[40:43], a[228:231], v[204:207]
 v_accvgpr_mov_b32 a92, a172
 v_accvgpr_mov_b32 a93, a173
 v_mfma_f32_16x16x32_bf16 v[208:211], v[48:51], a[224:227], v[208:211]
 buffer_load_dwordx4 v8, s[8:11], s25 offen offset:1024 nt lds
 v_mfma_f32_16x16x32_bf16 v[216:219], v[56:59], a[224:227], v[216:219]
 s_sub_u32 s25, s25, 896
 ds_read_b128 a[224:227], v1 offset:0
 v_accvgpr_mov_b32 a94, a174
 v_mfma_f32_16x16x32_bf16 v[212:215], v[48:51], a[228:231], v[212:215]
 s_add_u32 s20, s20, 12288
 v_accvgpr_mov_b32 a95, a175
 v_fma_f32 v64, v64, s22, v16
 v_mfma_f32_16x16x32_bf16 v[220:223], v[56:59], a[228:231], v[220:223]
 s_waitcnt lgkmcnt(3)
 ds_read_b128 a[228:231], v1 offset:512
 v_fma_f32 v65, v65, s22, v16
 v_mfma_f32_16x16x32_bf16 v[240:243], v[48:51], a[232:235], v[240:243]
 v_exp_f32 v64, v64
 v_mfma_f32_16x16x32_bf16 v[248:251], v[56:59], a[232:235], v[248:251]
 s_waitcnt lgkmcnt(2)
 v_exp_f32 v65, v65
 v_mfma_f32_16x16x32_bf16 v[244:247], v[48:51], a[236:239], v[244:247]
 buffer_load_dwordx4 v8, s[8:11], s25 offen offset:2048 nt lds
 v_mfma_f32_16x16x32_bf16 v[252:255], v[56:59], a[236:239], v[252:255]
 v_fma_f32 v66, v66, s22, v16
 v_fma_f32 v67, v67, s22, v16
 v_mfma_f32_16x16x32_bf16 v[224:227], v[32:35], a[232:235], v[224:227]
 v_exp_f32 v66, v66
 v_mfma_f32_16x16x32_bf16 v[232:235], v[40:43], a[232:235], v[232:235]
 ds_read_b128 a[232:235], v1 offset:1024
 v_fma_f32 v68, v68, s22, v16
 v_mfma_f32_16x16x32_bf16 v[228:231], v[32:35], a[236:239], v[228:231]
 v_exp_f32 v67, v67
 v_mfma_f32_16x16x32_bf16 v[236:239], v[40:43], a[236:239], v[236:239]
 s_waitcnt lgkmcnt(2)
 ds_read_b128 a[236:239], v1 offset:1536
 v_fma_f32 v69, v69, s22, v16
 v_mfma_f32_16x16x32_bf16 v[56:59], a[224:227], a[12:15], 0
 s_waitcnt lgkmcnt(2)
 v_exp_f32 v68, v68
 v_mfma_f32_16x16x32_bf16 v[56:59], a[228:231], a[28:31], v[56:59]
 v_exp_f32 v69, v69
 v_mfma_f32_16x16x32_bf16 v[48:51], a[224:227], a[8:11], 0
 v_fma_f32 v70, v70, s22, v16
 v_fma_f32 v71, v71, s22, v16
 v_mfma_f32_16x16x32_bf16 v[48:51], a[228:231], a[24:27], v[48:51]
 v_exp_f32 v70, v70
 v_mfma_f32_16x16x32_bf16 v[40:43], a[224:227], a[4:7], 0
 buffer_store_dwordx4 a[184:187], v10, s[16:19], s56 offen offset:256 nt
 v_mfma_f32_16x16x32_bf16 v[40:43], a[228:231], a[20:23], v[40:43]
 v_exp_f32 v71, v71
 v_mfma_f32_16x16x32_bf16 v[32:35], a[224:227], a[0:3], 0
 ds_read_b128 a[224:227], v1 offset:2048
 v_fma_f32 v72, v72, s22, v17
 v_mfma_f32_16x16x32_bf16 v[32:35], a[228:231], a[16:19], v[32:35]
 s_waitcnt lgkmcnt(1)
 ds_read_b128 a[228:231], v1 offset:2560
 s_add_u32 m0, s21, 122880
 v_mfma_f32_16x16x32_bf16 v[32:35], a[232:235], a[32:35], v[32:35]
 buffer_load_dwordx4 v4, s[4:7], s20 offen nt lds
 v_mfma_f32_16x16x32_bf16 v[32:35], a[236:239], a[48:51], v[32:35]
 v_exp_f32 v72, v72
 v_mfma_f32_16x16x32_bf16 v[40:43], a[232:235], a[36:39], v[40:43]
 v_fma_f32 v73, v73, s22, v17
 v_cvt_pk_bf16_f32 v64, v64, v65
 v_mfma_f32_16x16x32_bf16 v[40:43], a[236:239], a[52:55], v[40:43]
 v_exp_f32 v73, v73
 v_mfma_f32_16x16x32_bf16 v[48:51], a[232:235], a[40:43], v[48:51]
 v_fma_f32 v74, v74, s22, v17
 v_fma_f32 v75, v75, s22, v17
 v_mfma_f32_16x16x32_bf16 v[48:51], a[236:239], a[56:59], v[48:51]
 v_exp_f32 v74, v74
 v_mfma_f32_16x16x32_bf16 v[56:59], a[232:235], a[44:47], v[56:59]
 buffer_load_dwordx4 v5, s[4:7], s20 offen offset:1024 nt lds
 ds_read_b128 a[232:235], v1 offset:8192
 v_mfma_f32_16x16x32_bf16 v[56:59], a[236:239], a[60:63], v[56:59]
 s_waitcnt lgkmcnt(2)
 ds_read_b128 a[236:239], v1 offset:8704
 v_cvt_pk_bf16_f32 v65, v66, v67
 v_mfma_f32_16x16x32_bf16 v[56:59], a[224:227], a[76:79], v[56:59]
 s_waitcnt lgkmcnt(2)
 v_exp_f32 v75, v75
 v_mfma_f32_16x16x32_bf16 v[56:59], a[228:231], a[92:95], v[56:59]
 v_fma_f32 v76, v76, s22, v17
 v_fma_f32 v77, v77, s22, v17
 v_mfma_f32_16x16x32_bf16 v[48:51], a[224:227], a[72:75], v[48:51]
 v_exp_f32 v76, v76
 v_mfma_f32_16x16x32_bf16 v[48:51], a[228:231], a[88:91], v[48:51]
 v_exp_f32 v77, v77
 v_mfma_f32_16x16x32_bf16 v[40:43], a[224:227], a[68:71], v[40:43]
 buffer_load_dwordx4 v6, s[4:7], s20 offen offset:2048 nt lds
 v_mfma_f32_16x16x32_bf16 v[40:43], a[228:231], a[84:87], v[40:43]
 v_fma_f32 v78, v78, s22, v17
 v_fma_f32 v79, v79, s22, v17
 v_mfma_f32_16x16x32_bf16 v[32:35], a[224:227], a[64:67], v[32:35]
 ds_read_b128 a[224:227], v1 offset:7168
 v_cvt_pk_bf16_f32 v66, v68, v69
 v_mfma_f32_16x16x32_bf16 v[32:35], a[228:231], a[80:83], v[32:35]
 s_waitcnt lgkmcnt(2)
 ds_read_b128 a[228:231], v1 offset:7680
 v_cvt_pk_bf16_f32 v67, v70, v71
 v_mfma_f32_16x16x32_bf16 v[36:39], a[232:235], a[64:67], 0
 s_waitcnt lgkmcnt(2)
 v_exp_f32 v78, v78
 v_mfma_f32_16x16x32_bf16 v[36:39], a[236:239], a[80:83], v[36:39]
 v_exp_f32 v79, v79
 v_mfma_f32_16x16x32_bf16 v[44:47], a[232:235], a[68:71], 0
 v_cvt_pk_bf16_f32 v72, v72, v73
 v_cvt_pk_bf16_f32 v73, v74, v75
 v_mfma_f32_16x16x32_bf16 v[44:47], a[236:239], a[84:87], v[44:47]
 v_cvt_pk_bf16_f32 v74, v76, v77
 v_cvt_pk_bf16_f32 v75, v78, v79
 v_mfma_f32_16x16x32_bf16 v[52:55], a[232:235], a[72:75], 0
 v_fma_f32 v80, v80, s22, v18
 v_fma_f32 v81, v81, s22, v18
 v_mfma_f32_16x16x32_bf16 v[52:55], a[236:239], a[88:91], v[52:55]
 v_exp_f32 v80, v80
 v_mfma_f32_16x16x32_bf16 v[60:63], a[232:235], a[76:79], 0
 buffer_store_dwordx4 a[188:191], v10, s[16:19], s57 offen offset:256 nt
 ds_read_b128 a[232:235], v1 offset:6144
 v_mfma_f32_16x16x32_bf16 v[60:63], a[236:239], a[92:95], v[60:63]
 s_waitcnt lgkmcnt(1)
 ds_read_b128 a[236:239], v1 offset:6656
 v_fma_f32 v82, v82, s22, v18
 v_mfma_f32_16x16x32_bf16 v[60:63], a[224:227], a[44:47], v[60:63]
 v_exp_f32 v81, v81
 v_mfma_f32_16x16x32_bf16 v[60:63], a[228:231], a[60:63], v[60:63]
 v_exp_f32 v82, v82
 v_mfma_f32_16x16x32_bf16 v[52:55], a[224:227], a[40:43], v[52:55]
 v_fma_f32 v83, v83, s22, v18
 v_fma_f32 v84, v84, s22, v18
 v_mfma_f32_16x16x32_bf16 v[52:55], a[228:231], a[56:59], v[52:55]
 v_exp_f32 v83, v83
 v_mfma_f32_16x16x32_bf16 v[44:47], a[224:227], a[36:39], v[44:47]
 v_exp_f32 v84, v84
 v_mfma_f32_16x16x32_bf16 v[44:47], a[228:231], a[52:55], v[44:47]
 v_fma_f32 v85, v85, s22, v18
 v_fma_f32 v86, v86, s22, v18
 v_mfma_f32_16x16x32_bf16 v[36:39], a[224:227], a[32:35], v[36:39]
 ds_read_b64_tr_b16 a[224:225], v3 offset:24576
 v_fma_f32 v87, v87, s22, v18
 v_mfma_f32_16x16x32_bf16 v[36:39], a[228:231], a[48:51], v[36:39]
 s_waitcnt lgkmcnt(2)
 ds_read_b64_tr_b16 a[226:227], v3 offset:30720
 v_fma_f32 v88, v88, s22, v19
 v_mfma_f32_16x16x32_bf16 v[36:39], a[232:235], a[0:3], v[36:39]
 s_waitcnt lgkmcnt(2)
 ds_read_b64_tr_b16 a[228:229], v3 offset:24832
 v_fma_f32 v89, v89, s22, v19
 v_mfma_f32_16x16x32_bf16 v[36:39], a[236:239], a[16:19], v[36:39]
 ds_read_b64_tr_b16 a[230:231], v3 offset:30976
 v_cvt_pk_bf16_f32 v80, v80, v81
 v_mfma_f32_16x16x32_bf16 v[44:47], a[232:235], a[4:7], v[44:47]
 v_exp_f32 v85, v85
 v_mfma_f32_16x16x32_bf16 v[44:47], a[236:239], a[20:23], v[44:47]
 v_exp_f32 v86, v86
 v_mfma_f32_16x16x32_bf16 v[52:55], a[232:235], a[8:11], v[52:55]
 v_exp_f32 v87, v87
 v_mfma_f32_16x16x32_bf16 v[52:55], a[236:239], a[24:27], v[52:55]
 v_exp_f32 v88, v88
 v_mfma_f32_16x16x32_bf16 v[60:63], a[232:235], a[12:15], v[60:63]
 ds_read_b64_tr_b16 a[232:233], v3 offset:25088
 v_fma_f32 v90, v90, s22, v19
 v_mfma_f32_16x16x32_bf16 v[60:63], a[236:239], a[28:31], v[60:63]
 ds_read_b64_tr_b16 a[234:235], v3 offset:31232
 v_fma_f32 v91, v91, s22, v19
 v_mfma_f32_16x16x32_bf16 v[28:31], a[240:243], v[64:67], v[28:31]
 v_exp_f32 v89, v89
 v_mfma_f32_16x16x32_bf16 a[244:247], a[240:243], v[72:75], a[244:247]
 s_waitcnt lgkmcnt(3)
 v_exp_f32 v90, v90
 v_mfma_f32_16x16x32_bf16 v[96:99], v[64:67], a[224:227], v[96:99]
 v_exp_f32 v91, v91
 v_mfma_f32_16x16x32_bf16 v[104:107], v[72:75], a[224:227], v[104:107]
 s_waitcnt lgkmcnt(2)
 ds_read_b64_tr_b16 a[236:237], v3 offset:25344
 v_cvt_pk_bf16_f32 v81, v82, v83
 v_mfma_f32_16x16x32_bf16 v[100:103], v[64:67], a[228:231], v[100:103]
 ds_read_b64_tr_b16 a[238:239], v3 offset:31488
 v_fma_f32 v92, v92, s22, v19
 v_fma_f32 v93, v93, s22, v19
 v_fma_f32 v94, v94, s22, v19
 v_fma_f32 v95, v95, s22, v19
 v_cvt_pk_bf16_f32 v82, v84, v85
 v_cvt_pk_bf16_f32 v83, v86, v87
 v_mfma_f32_16x16x32_bf16 v[108:111], v[72:75], a[228:231], v[108:111]
 v_exp_f32 v92, v92
 v_exp_f32 v93, v93
 v_exp_f32 v94, v94
 v_exp_f32 v95, v95
 v_cvt_pk_bf16_f32 v88, v88, v89
 v_cvt_pk_bf16_f32 v89, v90, v91
 v_cvt_pk_bf16_f32 v90, v92, v93
 v_cvt_pk_bf16_f32 v91, v94, v95
 v_mfma_f32_16x16x32_bf16 a[192:195], v[80:83], a[224:227], a[192:195]
 v_mov_b32 v22, v28
 v_accvgpr_read_b32 v23, a244
 v_mfma_f32_16x16x32_bf16 a[200:203], v[88:91], a[224:227], a[200:203]
 ds_read_b64_tr_b16 a[224:225], v3 offset:25600
 v_add_f32 v0, v22, v23
 v_mfma_f32_16x16x32_bf16 a[196:199], v[80:83], a[228:231], a[196:199]
 ds_read_b64_tr_b16 a[226:227], v3 offset:31744
 v_max3_f32 v20, v32, v33, v34
 v_mfma_f32_16x16x32_bf16 a[204:207], v[88:91], a[228:231], a[204:207]
 ds_read_b64_tr_b16 a[228:229], v3 offset:25856
 v_max3_f32 v20, v20, v35, v36
 v_mfma_f32_16x16x32_bf16 a[248:251], a[240:243], v[80:83], a[248:251]
 ds_read_b64_tr_b16 a[230:231], v3 offset:32000
 v_max3_f32 v20, v20, v37, v38
 v_mfma_f32_16x16x32_bf16 a[252:255], a[240:243], v[88:91], a[252:255]
 s_waitcnt lgkmcnt(4)
 v_rcp_f32 v22, v22
 v_mfma_f32_16x16x32_bf16 a[208:211], v[80:83], a[232:235], a[208:211]
 s_waitcnt vmcnt(16)
 s_barrier
 v_mov_b32_dpp v22, v22 row_shl:4 row_mask:0x2 bank_mask:0xf
 v_mfma_f32_16x16x32_bf16 a[216:219], v[88:91], a[232:235], a[216:219]
 v_rcp_f32 v23, v23
 v_accvgpr_read_b32 v24, a248
 v_add_f32 v0, v0, v24
 v_mfma_f32_16x16x32_bf16 a[212:215], v[80:83], a[236:239], a[212:215]
 v_accvgpr_read_b32 v25, a252
 v_add_f32 v0, v0, v25
 v_cmp_ngt_f32 vcc, s24, v0
 s_cmp_lg_u64 vcc, 0
 s_cselect_b32 s28, s27, 0
 s_or_b32 s26, s26, s28
 s_lshl_b32 s27, s27, 1
 s_add_u32 s16, s16, 25165824
 s_addc_u32 s17, s17, 0
 s_mov_b32 s18, 24576
 s_add_u32 s12, s12, 25165824
 s_addc_u32 s13, s13, 0
 v_mfma_f32_16x16x32_bf16 a[220:223], v[88:91], a[236:239], a[220:223]
 s_add_u32 s3, s3, 1
 s_cmp_lt_u32 s3, 3
 s_cselect_b32 s14, s35, 0
 s_add_u32 s20, s20, 12288
 v_mfma_f32_16x16x32_bf16 v[112:115], v[64:67], a[232:235], v[112:115]
 s_add_u32 m0, s21, 73728
 v_mov_b32_dpp v22, v22 row_shl:8 row_mask:0x4 bank_mask:0xf
 v_mfma_f32_16x16x32_bf16 v[120:123], v[72:75], a[232:235], v[120:123]
 s_add_u32 s25, s25, 14080
 buffer_load_dwordx4 v4, s[4:7], s20 offen lds
 v_mov_b32_dpp v22, v22 row_shl:12 row_mask:0x8 bank_mask:0xf
 v_mfma_f32_16x16x32_bf16 v[116:119], v[64:67], a[236:239], v[116:119]
 ds_read_b64_tr_b16 a[232:233], v3 offset:26112
 ds_read_b64_tr_b16 a[234:235], v3 offset:32256
 v_mul_f32_dpp v96, v22, v96 row_newbcast:0 row_mask:0xf bank_mask:0xf
 v_mul_f32_dpp v98, v22, v98 row_newbcast:2 row_mask:0xf bank_mask:0xf
 v_mul_f32_dpp v100, v22, v100 row_newbcast:0 row_mask:0xf bank_mask:0xf
 v_mul_f32_dpp v102, v22, v102 row_newbcast:2 row_mask:0xf bank_mask:0xf
 v_mul_f32_dpp v97, v22, v97 row_newbcast:1 row_mask:0xf bank_mask:0xf
 v_mul_f32_dpp v99, v22, v99 row_newbcast:3 row_mask:0xf bank_mask:0xf
 v_mul_f32_dpp v101, v22, v101 row_newbcast:1 row_mask:0xf bank_mask:0xf
 v_mul_f32_dpp v103, v22, v103 row_newbcast:3 row_mask:0xf bank_mask:0xf
 v_cvt_pk_bf16_f32 v96, v96, v100
 v_cvt_pk_bf16_f32 v98, v98, v102
 v_cvt_pk_bf16_f32 v100, v97, v101
 v_cvt_pk_bf16_f32 v102, v99, v103
 v_mul_f32_dpp v112, v22, v112 row_newbcast:0 row_mask:0xf bank_mask:0xf
 v_mul_f32_dpp v114, v22, v114 row_newbcast:2 row_mask:0xf bank_mask:0xf
 v_mul_f32_dpp v116, v22, v116 row_newbcast:0 row_mask:0xf bank_mask:0xf
 v_mul_f32_dpp v118, v22, v118 row_newbcast:2 row_mask:0xf bank_mask:0xf
 v_cvt_pk_bf16_f32 v97, v112, v116
 v_cvt_pk_bf16_f32 v99, v114, v118
 v_mfma_f32_16x16x32_bf16 v[124:127], v[72:75], a[236:239], v[124:127]
 s_waitcnt lgkmcnt(2)
 ds_write_b128 v14, v[96:99] offset:24576
 v_mul_f32_dpp v113, v22, v113 row_newbcast:1 row_mask:0xf bank_mask:0xf
 v_mul_f32_dpp v115, v22, v115 row_newbcast:3 row_mask:0xf bank_mask:0xf
 v_mul_f32_dpp v117, v22, v117 row_newbcast:1 row_mask:0xf bank_mask:0xf
 v_mul_f32_dpp v119, v22, v119 row_newbcast:3 row_mask:0xf bank_mask:0xf
 v_mfma_f32_16x16x32_bf16 v[128:131], v[64:67], a[224:227], v[128:131]
 ds_read_b64_tr_b16 a[236:237], v3 offset:26368
 ds_read_b64_tr_b16 a[238:239], v3 offset:32512
 v_cvt_pk_bf16_f32 v101, v113, v117
 v_cvt_pk_bf16_f32 v103, v115, v119
 v_mfma_f32_16x16x32_bf16 v[136:139], v[72:75], a[224:227], v[136:139]
 ds_write_b128 v15, v[100:103] offset:24576
 v_mov_b32_dpp v23, v23 row_shl:4 row_mask:0x2 bank_mask:0xf
 v_mfma_f32_16x16x32_bf16 v[132:135], v[64:67], a[228:231], v[132:135]
 ds_read_b64_tr_b16 a[96:97], v12 offset:24576
 buffer_load_dwordx4 v5, s[4:7], s20 offen offset:1024 lds
 v_mov_b32_dpp v23, v23 row_shl:8 row_mask:0x4 bank_mask:0xf
 v_mfma_f32_16x16x32_bf16 v[140:143], v[72:75], a[228:231], v[140:143]
 ds_read_b64_tr_b16 a[98:99], v7 offset:24576
 ds_read_b64_tr_b16 a[100:101], v12 offset:25088
 v_mov_b32_dpp v23, v23 row_shl:12 row_mask:0x8 bank_mask:0xf
 v_mfma_f32_16x16x32_bf16 v[144:147], v[80:83], a[224:227], v[144:147]
 ds_read_b64_tr_b16 a[102:103], v7 offset:25088
 v_mul_f32_dpp v104, v23, v104 row_newbcast:0 row_mask:0xf bank_mask:0xf
 v_mul_f32_dpp v106, v23, v106 row_newbcast:2 row_mask:0xf bank_mask:0xf
 v_mul_f32_dpp v108, v23, v108 row_newbcast:0 row_mask:0xf bank_mask:0xf
 v_mul_f32_dpp v110, v23, v110 row_newbcast:2 row_mask:0xf bank_mask:0xf
 v_mul_f32_dpp v105, v23, v105 row_newbcast:1 row_mask:0xf bank_mask:0xf
 v_mul_f32_dpp v107, v23, v107 row_newbcast:3 row_mask:0xf bank_mask:0xf
 v_mul_f32_dpp v109, v23, v109 row_newbcast:1 row_mask:0xf bank_mask:0xf
 v_mul_f32_dpp v111, v23, v111 row_newbcast:3 row_mask:0xf bank_mask:0xf
 v_cvt_pk_bf16_f32 v104, v104, v108
 v_cvt_pk_bf16_f32 v106, v106, v110
 v_cvt_pk_bf16_f32 v108, v105, v109
 v_cvt_pk_bf16_f32 v110, v107, v111
 v_mul_f32_dpp v120, v23, v120 row_newbcast:0 row_mask:0xf bank_mask:0xf
 v_mul_f32_dpp v122, v23, v122 row_newbcast:2 row_mask:0xf bank_mask:0xf
 v_mul_f32_dpp v124, v23, v124 row_newbcast:0 row_mask:0xf bank_mask:0xf
 v_mul_f32_dpp v126, v23, v126 row_newbcast:2 row_mask:0xf bank_mask:0xf
 v_cvt_pk_bf16_f32 v105, v120, v124
 v_cvt_pk_bf16_f32 v107, v122, v126
 v_mfma_f32_16x16x32_bf16 v[152:155], v[88:91], a[224:227], v[152:155]
 ds_write_b128 v14, v[104:107] offset:32768
 v_mul_f32_dpp v121, v23, v121 row_newbcast:1 row_mask:0xf bank_mask:0xf
 v_mul_f32_dpp v123, v23, v123 row_newbcast:3 row_mask:0xf bank_mask:0xf
 v_mul_f32_dpp v125, v23, v125 row_newbcast:1 row_mask:0xf bank_mask:0xf
 v_mul_f32_dpp v127, v23, v127 row_newbcast:3 row_mask:0xf bank_mask:0xf
 v_mfma_f32_16x16x32_bf16 v[148:151], v[80:83], a[228:231], v[148:151]
 ds_read_b64_tr_b16 a[224:225], v3 offset:26624
 ds_read_b64_tr_b16 a[226:227], v3 offset:32768
 v_cvt_pk_bf16_f32 v109, v121, v125
 v_cvt_pk_bf16_f32 v111, v123, v127
 v_rcp_f32 v24, v24
 v_mfma_f32_16x16x32_bf16 v[156:159], v[88:91], a[228:231], v[156:159]
 s_waitcnt lgkmcnt(3)
 ds_write_b128 v15, v[108:111] offset:32768
 v_mov_b32_dpp v24, v24 row_shl:4 row_mask:0x2 bank_mask:0xf
 v_mfma_f32_16x16x32_bf16 v[176:179], v[80:83], a[232:235], v[176:179]
 ds_read_b64_tr_b16 a[104:105], v12 offset:32768
 buffer_load_dwordx4 v6, s[4:7], s20 offen offset:2048 lds
 ds_read_b64_tr_b16 a[228:229], v3 offset:26880
 ds_read_b64_tr_b16 a[230:231], v3 offset:33024
 v_mov_b32_dpp v24, v24 row_shl:8 row_mask:0x4 bank_mask:0xf
 v_mfma_f32_16x16x32_bf16 v[184:187], v[88:91], a[232:235], v[184:187]
 ds_read_b64_tr_b16 a[106:107], v7 offset:32768
 ds_read_b64_tr_b16 a[108:109], v12 offset:33280
 v_mov_b32_dpp v24, v24 row_shl:12 row_mask:0x8 bank_mask:0xf
 v_accvgpr_read_b32 v96, a192
 v_accvgpr_read_b32 v98, a194
 v_accvgpr_read_b32 v100, a196
 v_accvgpr_read_b32 v102, a198
 v_accvgpr_read_b32 v97, a193
 v_accvgpr_read_b32 v99, a195
 v_accvgpr_read_b32 v101, a197
 v_accvgpr_read_b32 v103, a199
 v_accvgpr_read_b32 v112, a208
 v_accvgpr_read_b32 v114, a210
 v_accvgpr_read_b32 v116, a212
 v_accvgpr_read_b32 v118, a214
 v_mfma_f32_16x16x32_bf16 v[180:183], v[80:83], a[236:239], v[180:183]
 ds_read_b64_tr_b16 a[110:111], v7 offset:33280
 v_mul_f32_dpp v96, v24, v96 row_newbcast:0 row_mask:0xf bank_mask:0xf
 v_mul_f32_dpp v98, v24, v98 row_newbcast:2 row_mask:0xf bank_mask:0xf
 v_mul_f32_dpp v100, v24, v100 row_newbcast:0 row_mask:0xf bank_mask:0xf
 v_mul_f32_dpp v102, v24, v102 row_newbcast:2 row_mask:0xf bank_mask:0xf
 v_mul_f32_dpp v97, v24, v97 row_newbcast:1 row_mask:0xf bank_mask:0xf
 v_mul_f32_dpp v99, v24, v99 row_newbcast:3 row_mask:0xf bank_mask:0xf
 v_mul_f32_dpp v101, v24, v101 row_newbcast:1 row_mask:0xf bank_mask:0xf
 v_mul_f32_dpp v103, v24, v103 row_newbcast:3 row_mask:0xf bank_mask:0xf
 v_cvt_pk_bf16_f32 v96, v96, v100
 v_cvt_pk_bf16_f32 v98, v98, v102
 v_cvt_pk_bf16_f32 v100, v97, v101
 v_cvt_pk_bf16_f32 v102, v99, v103
 v_mul_f32_dpp v112, v24, v112 row_newbcast:0 row_mask:0xf bank_mask:0xf
 v_mul_f32_dpp v114, v24, v114 row_newbcast:2 row_mask:0xf bank_mask:0xf
 v_mul_f32_dpp v116, v24, v116 row_newbcast:0 row_mask:0xf bank_mask:0xf
 v_mul_f32_dpp v118, v24, v118 row_newbcast:2 row_mask:0xf bank_mask:0xf
 v_cvt_pk_bf16_f32 v97, v112, v116
 v_cvt_pk_bf16_f32 v99, v114, v118
 v_mfma_f32_16x16x32_bf16 v[188:191], v[88:91], a[236:239], v[188:191]
 ds_write_b128 v14, v[96:99] offset:24576
 v_accvgpr_read_b32 v113, a209
 v_accvgpr_read_b32 v115, a211
 v_accvgpr_read_b32 v117, a213
 v_accvgpr_read_b32 v119, a215
 v_mul_f32_dpp v113, v24, v113 row_newbcast:1 row_mask:0xf bank_mask:0xf
 v_mul_f32_dpp v115, v24, v115 row_newbcast:3 row_mask:0xf bank_mask:0xf
 v_mul_f32_dpp v117, v24, v117 row_newbcast:1 row_mask:0xf bank_mask:0xf
 v_mul_f32_dpp v119, v24, v119 row_newbcast:3 row_mask:0xf bank_mask:0xf
 v_mfma_f32_16x16x32_bf16 v[160:163], v[64:67], a[232:235], v[160:163]
 v_cvt_pk_bf16_f32 v101, v113, v117
 v_cvt_pk_bf16_f32 v103, v115, v119
 v_rcp_f32 v25, v25
 v_mfma_f32_16x16x32_bf16 v[168:171], v[72:75], a[232:235], v[168:171]
 s_add_u32 m0, s21, 86016
 ds_write_b128 v15, v[100:103] offset:24576
 v_mov_b32_dpp v25, v25 row_shl:4 row_mask:0x2 bank_mask:0xf
 v_mfma_f32_16x16x32_bf16 v[164:167], v[64:67], a[236:239], v[164:167]
 ds_read_b64_tr_b16 a[112:113], v12 offset:24576
 buffer_load_dwordx4 v8, s[8:11], s25 offen lds
 ds_read_b64_tr_b16 a[232:233], v3 offset:27136
 ds_read_b64_tr_b16 a[234:235], v3 offset:33280
 v_mov_b32_dpp v25, v25 row_shl:8 row_mask:0x4 bank_mask:0xf
 v_mfma_f32_16x16x32_bf16 v[172:175], v[72:75], a[236:239], v[172:175]
 s_waitcnt lgkmcnt(4)
 ds_read_b64_tr_b16 a[114:115], v7 offset:24576
 ds_read_b64_tr_b16 a[116:117], v12 offset:25088
 v_mov_b32_dpp v25, v25 row_shl:12 row_mask:0x8 bank_mask:0xf
 v_accvgpr_read_b32 v104, a200
 v_accvgpr_read_b32 v106, a202
 v_accvgpr_read_b32 v108, a204
 v_accvgpr_read_b32 v110, a206
 v_accvgpr_read_b32 v105, a201
 v_accvgpr_read_b32 v107, a203
 v_accvgpr_read_b32 v109, a205
 v_accvgpr_read_b32 v111, a207
 v_accvgpr_read_b32 v120, a216
 v_accvgpr_read_b32 v122, a218
 v_accvgpr_read_b32 v124, a220
 v_accvgpr_read_b32 v126, a222
 v_mfma_f32_16x16x32_bf16 v[192:195], v[64:67], a[224:227], v[192:195]
 s_sub_u32 s25, s25, 896
 ds_read_b64_tr_b16 a[118:119], v7 offset:25088
 ds_read_b64_tr_b16 a[236:237], v3 offset:27392
 ds_read_b64_tr_b16 a[238:239], v3 offset:33536
 v_mul_f32_dpp v104, v25, v104 row_newbcast:0 row_mask:0xf bank_mask:0xf
 v_mul_f32_dpp v106, v25, v106 row_newbcast:2 row_mask:0xf bank_mask:0xf
 v_mul_f32_dpp v108, v25, v108 row_newbcast:0 row_mask:0xf bank_mask:0xf
 v_mul_f32_dpp v110, v25, v110 row_newbcast:2 row_mask:0xf bank_mask:0xf
 v_mul_f32_dpp v105, v25, v105 row_newbcast:1 row_mask:0xf bank_mask:0xf
 v_mul_f32_dpp v107, v25, v107 row_newbcast:3 row_mask:0xf bank_mask:0xf
 v_mul_f32_dpp v109, v25, v109 row_newbcast:1 row_mask:0xf bank_mask:0xf
 v_mul_f32_dpp v111, v25, v111 row_newbcast:3 row_mask:0xf bank_mask:0xf
 v_cvt_pk_bf16_f32 v104, v104, v108
 v_cvt_pk_bf16_f32 v106, v106, v110
 v_cvt_pk_bf16_f32 v108, v105, v109
 v_cvt_pk_bf16_f32 v110, v107, v111
 v_mul_f32_dpp v120, v25, v120 row_newbcast:0 row_mask:0xf bank_mask:0xf
 v_mul_f32_dpp v122, v25, v122 row_newbcast:2 row_mask:0xf bank_mask:0xf
 v_mul_f32_dpp v124, v25, v124 row_newbcast:0 row_mask:0xf bank_mask:0xf
 v_mul_f32_dpp v126, v25, v126 row_newbcast:2 row_mask:0xf bank_mask:0xf
 v_cvt_pk_bf16_f32 v105, v120, v124
 v_cvt_pk_bf16_f32 v107, v122, v126
 v_mfma_f32_16x16x32_bf16 v[200:203], v[72:75], a[224:227], v[200:203]
 ds_write_b128 v14, v[104:107] offset:32768
 v_accvgpr_read_b32 v121, a217
 v_accvgpr_read_b32 v123, a219
 v_accvgpr_read_b32 v125, a221
 v_accvgpr_read_b32 v127, a223
 v_mul_f32_dpp v121, v25, v121 row_newbcast:1 row_mask:0xf bank_mask:0xf
 v_mul_f32_dpp v123, v25, v123 row_newbcast:3 row_mask:0xf bank_mask:0xf
 v_mul_f32_dpp v125, v25, v125 row_newbcast:1 row_mask:0xf bank_mask:0xf
 v_mul_f32_dpp v127, v25, v127 row_newbcast:3 row_mask:0xf bank_mask:0xf
 v_mfma_f32_16x16x32_bf16 v[196:199], v[64:67], a[228:231], v[196:199]
 v_cvt_pk_bf16_f32 v109, v121, v125
 v_cvt_pk_bf16_f32 v111, v123, v127
 v_mfma_f32_16x16x32_bf16 v[204:207], v[72:75], a[228:231], v[204:207]
 ds_write_b128 v15, v[108:111] offset:32768
 v_mfma_f32_16x16x32_bf16 v[208:211], v[80:83], a[224:227], v[208:211]
 ds_read_b64_tr_b16 a[120:121], v12 offset:32768
 buffer_load_dwordx4 v8, s[8:11], s25 offen offset:1024 lds
 v_mfma_f32_16x16x32_bf16 v[216:219], v[88:91], a[224:227], v[216:219]
 s_sub_u32 s25, s25, 896
 ds_read_b64_tr_b16 a[122:123], v7 offset:32768
 ds_read_b64_tr_b16 a[124:125], v12 offset:33280
 v_mfma_f32_16x16x32_bf16 v[212:215], v[80:83], a[228:231], v[212:215]
 s_add_u32 s20, s20, 12288
 ds_read_b64_tr_b16 a[126:127], v7 offset:33280
 ds_read_b128 a[224:227], v1 offset:12288
 v_mul_f32_dpp v128, v22, v128 row_newbcast:0 row_mask:0xf bank_mask:0xf
 v_mul_f32_dpp v130, v22, v130 row_newbcast:2 row_mask:0xf bank_mask:0xf
 v_mul_f32_dpp v132, v22, v132 row_newbcast:0 row_mask:0xf bank_mask:0xf
 v_mul_f32_dpp v134, v22, v134 row_newbcast:2 row_mask:0xf bank_mask:0xf
 v_mul_f32_dpp v129, v22, v129 row_newbcast:1 row_mask:0xf bank_mask:0xf
 v_mul_f32_dpp v131, v22, v131 row_newbcast:3 row_mask:0xf bank_mask:0xf
 v_mul_f32_dpp v133, v22, v133 row_newbcast:1 row_mask:0xf bank_mask:0xf
 v_mul_f32_dpp v135, v22, v135 row_newbcast:3 row_mask:0xf bank_mask:0xf
 v_cvt_pk_bf16_f32 v128, v128, v132
 v_cvt_pk_bf16_f32 v130, v130, v134
 v_cvt_pk_bf16_f32 v132, v129, v133
 v_cvt_pk_bf16_f32 v134, v131, v135
 v_mul_f32_dpp v160, v22, v160 row_newbcast:0 row_mask:0xf bank_mask:0xf
 v_mul_f32_dpp v162, v22, v162 row_newbcast:2 row_mask:0xf bank_mask:0xf
 v_mul_f32_dpp v164, v22, v164 row_newbcast:0 row_mask:0xf bank_mask:0xf
 v_mul_f32_dpp v166, v22, v166 row_newbcast:2 row_mask:0xf bank_mask:0xf
 v_cvt_pk_bf16_f32 v129, v160, v164
 v_cvt_pk_bf16_f32 v131, v162, v166
 v_mfma_f32_16x16x32_bf16 v[220:223], v[88:91], a[228:231], v[220:223]
 s_waitcnt lgkmcnt(5)
 ds_write_b128 v14, v[128:131] offset:24576
 ds_read_b128 a[228:231], v1 offset:12800
 v_mul_f32_dpp v161, v22, v161 row_newbcast:1 row_mask:0xf bank_mask:0xf
 v_mul_f32_dpp v163, v22, v163 row_newbcast:3 row_mask:0xf bank_mask:0xf
 v_mul_f32_dpp v165, v22, v165 row_newbcast:1 row_mask:0xf bank_mask:0xf
 v_mul_f32_dpp v167, v22, v167 row_newbcast:3 row_mask:0xf bank_mask:0xf
 v_mfma_f32_16x16x32_bf16 v[240:243], v[80:83], a[232:235], v[240:243]
 v_cvt_pk_bf16_f32 v133, v161, v165
 v_cvt_pk_bf16_f32 v135, v163, v167
 v_mfma_f32_16x16x32_bf16 v[248:251], v[88:91], a[232:235], v[248:251]
 ds_write_b128 v15, v[132:135] offset:24576
 v_mfma_f32_16x16x32_bf16 v[244:247], v[80:83], a[236:239], v[244:247]
 ds_read_b64_tr_b16 a[128:129], v12 offset:24576
 buffer_load_dwordx4 v8, s[8:11], s25 offen offset:2048 lds
 v_mfma_f32_16x16x32_bf16 v[252:255], v[88:91], a[236:239], v[252:255]
 ds_read_b64_tr_b16 a[130:131], v7 offset:24576
 ds_read_b64_tr_b16 a[132:133], v12 offset:25088
 v_mfma_f32_16x16x32_bf16 v[224:227], v[64:67], a[232:235], v[224:227]
 ds_read_b64_tr_b16 a[134:135], v7 offset:25088
 v_mul_f32_dpp v136, v23, v136 row_newbcast:0 row_mask:0xf bank_mask:0xf
 v_mul_f32_dpp v138, v23, v138 row_newbcast:2 row_mask:0xf bank_mask:0xf
 v_mul_f32_dpp v140, v23, v140 row_newbcast:0 row_mask:0xf bank_mask:0xf
 v_mul_f32_dpp v142, v23, v142 row_newbcast:2 row_mask:0xf bank_mask:0xf
 v_mul_f32_dpp v137, v23, v137 row_newbcast:1 row_mask:0xf bank_mask:0xf
 v_mul_f32_dpp v139, v23, v139 row_newbcast:3 row_mask:0xf bank_mask:0xf
 v_mul_f32_dpp v141, v23, v141 row_newbcast:1 row_mask:0xf bank_mask:0xf
 v_mul_f32_dpp v143, v23, v143 row_newbcast:3 row_mask:0xf bank_mask:0xf
 v_cvt_pk_bf16_f32 v136, v136, v140
 v_cvt_pk_bf16_f32 v138, v138, v142
 v_cvt_pk_bf16_f32 v140, v137, v141
 v_cvt_pk_bf16_f32 v142, v139, v143
 v_mul_f32_dpp v168, v23, v168 row_newbcast:0 row_mask:0xf bank_mask:0xf
 v_mul_f32_dpp v170, v23, v170 row_newbcast:2 row_mask:0xf bank_mask:0xf
 v_mul_f32_dpp v172, v23, v172 row_newbcast:0 row_mask:0xf bank_mask:0xf
 v_mul_f32_dpp v174, v23, v174 row_newbcast:2 row_mask:0xf bank_mask:0xf
 v_cvt_pk_bf16_f32 v137, v168, v172
 v_cvt_pk_bf16_f32 v139, v170, v174
 v_mfma_f32_16x16x32_bf16 v[232:235], v[72:75], a[232:235], v[232:235]
 ds_write_b128 v14, v[136:139] offset:32768
 v_mul_f32_dpp v169, v23, v169 row_newbcast:1 row_mask:0xf bank_mask:0xf
 v_mul_f32_dpp v171, v23, v171 row_newbcast:3 row_mask:0xf bank_mask:0xf
 v_mul_f32_dpp v173, v23, v173 row_newbcast:1 row_mask:0xf bank_mask:0xf
 v_mul_f32_dpp v175, v23, v175 row_newbcast:3 row_mask:0xf bank_mask:0xf
 v_mfma_f32_16x16x32_bf16 v[228:231], v[64:67], a[236:239], v[228:231]
 ds_read_b128 a[232:235], v1 offset:13312
 v_cvt_pk_bf16_f32 v141, v169, v173
 v_cvt_pk_bf16_f32 v143, v171, v175
 v_mfma_f32_16x16x32_bf16 v[236:239], v[72:75], a[236:239], v[236:239]
 s_waitcnt lgkmcnt(2)
 ds_write_b128 v15, v[140:143] offset:32768
 ds_read_b128 a[236:239], v1 offset:13824
 v_mfma_f32_16x16x32_bf16 v[88:91], a[224:227], a[12:15], 0
 ds_read_b64_tr_b16 a[136:137], v12 offset:32768
 buffer_store_dwordx4 a[96:99], v10, s[16:19], s50 offen nt
 v_mfma_f32_16x16x32_bf16 v[88:91], a[228:231], a[28:31], v[88:91]
 ds_read_b64_tr_b16 a[138:139], v7 offset:32768
 ds_read_b64_tr_b16 a[140:141], v12 offset:33280
 v_mfma_f32_16x16x32_bf16 v[80:83], a[224:227], a[8:11], 0
 ds_read_b64_tr_b16 a[142:143], v7 offset:33280
 v_mul_f32_dpp v144, v24, v144 row_newbcast:0 row_mask:0xf bank_mask:0xf
 v_mul_f32_dpp v146, v24, v146 row_newbcast:2 row_mask:0xf bank_mask:0xf
 v_mul_f32_dpp v148, v24, v148 row_newbcast:0 row_mask:0xf bank_mask:0xf
 v_mul_f32_dpp v150, v24, v150 row_newbcast:2 row_mask:0xf bank_mask:0xf
 v_mul_f32_dpp v145, v24, v145 row_newbcast:1 row_mask:0xf bank_mask:0xf
 v_mul_f32_dpp v147, v24, v147 row_newbcast:3 row_mask:0xf bank_mask:0xf
 v_mul_f32_dpp v149, v24, v149 row_newbcast:1 row_mask:0xf bank_mask:0xf
 v_mul_f32_dpp v151, v24, v151 row_newbcast:3 row_mask:0xf bank_mask:0xf
 v_cvt_pk_bf16_f32 v144, v144, v148
 v_cvt_pk_bf16_f32 v146, v146, v150
 v_cvt_pk_bf16_f32 v148, v145, v149
 v_cvt_pk_bf16_f32 v150, v147, v151
 v_mul_f32_dpp v176, v24, v176 row_newbcast:0 row_mask:0xf bank_mask:0xf
 v_mul_f32_dpp v178, v24, v178 row_newbcast:2 row_mask:0xf bank_mask:0xf
 v_mul_f32_dpp v180, v24, v180 row_newbcast:0 row_mask:0xf bank_mask:0xf
 v_mul_f32_dpp v182, v24, v182 row_newbcast:2 row_mask:0xf bank_mask:0xf
 v_cvt_pk_bf16_f32 v145, v176, v180
 v_cvt_pk_bf16_f32 v147, v178, v182
 v_mfma_f32_16x16x32_bf16 v[80:83], a[228:231], a[24:27], v[80:83]
 ds_write_b128 v14, v[144:147] offset:24576
 v_mul_f32_dpp v177, v24, v177 row_newbcast:1 row_mask:0xf bank_mask:0xf
 v_mul_f32_dpp v179, v24, v179 row_newbcast:3 row_mask:0xf bank_mask:0xf
 v_mul_f32_dpp v181, v24, v181 row_newbcast:1 row_mask:0xf bank_mask:0xf
 v_mul_f32_dpp v183, v24, v183 row_newbcast:3 row_mask:0xf bank_mask:0xf
 v_mfma_f32_16x16x32_bf16 v[72:75], a[224:227], a[4:7], 0
 v_cvt_pk_bf16_f32 v149, v177, v181
 v_cvt_pk_bf16_f32 v151, v179, v183
 v_mfma_f32_16x16x32_bf16 v[72:75], a[228:231], a[20:23], v[72:75]
 ds_write_b128 v15, v[148:151] offset:24576
 v_mfma_f32_16x16x32_bf16 v[64:67], a[224:227], a[0:3], 0
 ds_read_b64_tr_b16 a[144:145], v12 offset:24576
 ds_read_b128 a[224:227], v1 offset:14336
 v_mfma_f32_16x16x32_bf16 v[64:67], a[228:231], a[16:19], v[64:67]
 s_waitcnt lgkmcnt(4)
 ds_read_b64_tr_b16 a[146:147], v7 offset:24576
 ds_read_b64_tr_b16 a[148:149], v12 offset:25088
 ds_read_b128 a[228:231], v1 offset:14848
 v_mfma_f32_16x16x32_bf16 v[64:67], a[232:235], a[32:35], v[64:67]
 s_add_u32 m0, s21, 98304
 ds_read_b64_tr_b16 a[150:151], v7 offset:25088
 buffer_load_dwordx4 v4, s[4:7], s20 offen nt lds
 v_mul_f32_dpp v152, v25, v152 row_newbcast:0 row_mask:0xf bank_mask:0xf
 v_mul_f32_dpp v154, v25, v154 row_newbcast:2 row_mask:0xf bank_mask:0xf
 v_mul_f32_dpp v156, v25, v156 row_newbcast:0 row_mask:0xf bank_mask:0xf
 v_mul_f32_dpp v158, v25, v158 row_newbcast:2 row_mask:0xf bank_mask:0xf
 v_mul_f32_dpp v153, v25, v153 row_newbcast:1 row_mask:0xf bank_mask:0xf
 v_mul_f32_dpp v155, v25, v155 row_newbcast:3 row_mask:0xf bank_mask:0xf
 v_mul_f32_dpp v157, v25, v157 row_newbcast:1 row_mask:0xf bank_mask:0xf
 v_mul_f32_dpp v159, v25, v159 row_newbcast:3 row_mask:0xf bank_mask:0xf
 v_cvt_pk_bf16_f32 v152, v152, v156
 v_cvt_pk_bf16_f32 v154, v154, v158
 v_cvt_pk_bf16_f32 v156, v153, v157
 v_cvt_pk_bf16_f32 v158, v155, v159
 v_mul_f32_dpp v184, v25, v184 row_newbcast:0 row_mask:0xf bank_mask:0xf
 v_mul_f32_dpp v186, v25, v186 row_newbcast:2 row_mask:0xf bank_mask:0xf
 v_mul_f32_dpp v188, v25, v188 row_newbcast:0 row_mask:0xf bank_mask:0xf
 v_mul_f32_dpp v190, v25, v190 row_newbcast:2 row_mask:0xf bank_mask:0xf
 v_cvt_pk_bf16_f32 v153, v184, v188
 v_cvt_pk_bf16_f32 v155, v186, v190
 v_mfma_f32_16x16x32_bf16 v[64:67], a[236:239], a[48:51], v[64:67]
 ds_write_b128 v14, v[152:155] offset:32768
 v_mul_f32_dpp v185, v25, v185 row_newbcast:1 row_mask:0xf bank_mask:0xf
 v_mul_f32_dpp v187, v25, v187 row_newbcast:3 row_mask:0xf bank_mask:0xf
 v_mul_f32_dpp v189, v25, v189 row_newbcast:1 row_mask:0xf bank_mask:0xf
 v_mul_f32_dpp v191, v25, v191 row_newbcast:3 row_mask:0xf bank_mask:0xf
 v_mfma_f32_16x16x32_bf16 v[72:75], a[232:235], a[36:39], v[72:75]
 v_cvt_pk_bf16_f32 v157, v185, v189
 v_cvt_pk_bf16_f32 v159, v187, v191
 v_mfma_f32_16x16x32_bf16 v[72:75], a[236:239], a[52:55], v[72:75]
 ds_write_b128 v15, v[156:159] offset:32768
 v_mfma_f32_16x16x32_bf16 v[80:83], a[232:235], a[40:43], v[80:83]
 ds_read_b64_tr_b16 a[152:153], v12 offset:32768
 v_mul_f32_dpp v192, v22, v192 row_newbcast:0 row_mask:0xf bank_mask:0xf
 v_mfma_f32_16x16x32_bf16 v[80:83], a[236:239], a[56:59], v[80:83]
 ds_read_b64_tr_b16 a[154:155], v7 offset:32768
 ds_read_b64_tr_b16 a[156:157], v12 offset:33280
 v_mfma_f32_16x16x32_bf16 v[88:91], a[232:235], a[44:47], v[88:91]
 ds_read_b64_tr_b16 a[158:159], v7 offset:33280
 buffer_load_dwordx4 v5, s[4:7], s20 offen offset:1024 nt lds
 ds_read_b128 a[232:235], v1 offset:20480
 v_mul_f32_dpp v194, v22, v194 row_newbcast:2 row_mask:0xf bank_mask:0xf
 v_mul_f32_dpp v196, v22, v196 row_newbcast:0 row_mask:0xf bank_mask:0xf
 v_mul_f32_dpp v198, v22, v198 row_newbcast:2 row_mask:0xf bank_mask:0xf
 v_mul_f32_dpp v193, v22, v193 row_newbcast:1 row_mask:0xf bank_mask:0xf
 v_mul_f32_dpp v195, v22, v195 row_newbcast:3 row_mask:0xf bank_mask:0xf
 v_mul_f32_dpp v197, v22, v197 row_newbcast:1 row_mask:0xf bank_mask:0xf
 v_mul_f32_dpp v199, v22, v199 row_newbcast:3 row_mask:0xf bank_mask:0xf
 v_cvt_pk_bf16_f32 v192, v192, v196
 v_cvt_pk_bf16_f32 v194, v194, v198
 v_cvt_pk_bf16_f32 v196, v193, v197
 v_cvt_pk_bf16_f32 v198, v195, v199
 v_mul_f32_dpp v224, v22, v224 row_newbcast:0 row_mask:0xf bank_mask:0xf
 v_mul_f32_dpp v226, v22, v226 row_newbcast:2 row_mask:0xf bank_mask:0xf
 v_mul_f32_dpp v228, v22, v228 row_newbcast:0 row_mask:0xf bank_mask:0xf
 v_mul_f32_dpp v230, v22, v230 row_newbcast:2 row_mask:0xf bank_mask:0xf
 v_cvt_pk_bf16_f32 v193, v224, v228
 v_cvt_pk_bf16_f32 v195, v226, v230
 v_mfma_f32_16x16x32_bf16 v[88:91], a[236:239], a[60:63], v[88:91]
 s_waitcnt lgkmcnt(5)
 ds_write_b128 v14, v[192:195] offset:24576
 ds_read_b128 a[236:239], v1 offset:20992
 v_mul_f32_dpp v225, v22, v225 row_newbcast:1 row_mask:0xf bank_mask:0xf
 v_mul_f32_dpp v227, v22, v227 row_newbcast:3 row_mask:0xf bank_mask:0xf
 v_mul_f32_dpp v229, v22, v229 row_newbcast:1 row_mask:0xf bank_mask:0xf
 v_mul_f32_dpp v231, v22, v231 row_newbcast:3 row_mask:0xf bank_mask:0xf
 v_mfma_f32_16x16x32_bf16 v[88:91], a[224:227], a[76:79], v[88:91]
 buffer_store_dwordx4 a[100:103], v10, s[16:19], s51 offen nt
 v_cvt_pk_bf16_f32 v197, v225, v229
 v_cvt_pk_bf16_f32 v199, v227, v231
 v_mfma_f32_16x16x32_bf16 v[88:91], a[228:231], a[92:95], v[88:91]
 ds_write_b128 v15, v[196:199] offset:24576
 v_mfma_f32_16x16x32_bf16 v[80:83], a[224:227], a[72:75], v[80:83]
 ds_read_b64_tr_b16 a[160:161], v12 offset:24576
 v_mul_f32_dpp v200, v23, v200 row_newbcast:0 row_mask:0xf bank_mask:0xf
 v_mfma_f32_16x16x32_bf16 v[80:83], a[228:231], a[88:91], v[80:83]
 ds_read_b64_tr_b16 a[162:163], v7 offset:24576
 ds_read_b64_tr_b16 a[164:165], v12 offset:25088
 v_mfma_f32_16x16x32_bf16 v[72:75], a[224:227], a[68:71], v[72:75]
 ds_read_b64_tr_b16 a[166:167], v7 offset:25088
 buffer_load_dwordx4 v6, s[4:7], s20 offen offset:2048 nt lds
 v_mul_f32_dpp v202, v23, v202 row_newbcast:2 row_mask:0xf bank_mask:0xf
 v_mul_f32_dpp v204, v23, v204 row_newbcast:0 row_mask:0xf bank_mask:0xf
 v_mul_f32_dpp v206, v23, v206 row_newbcast:2 row_mask:0xf bank_mask:0xf
 v_mul_f32_dpp v201, v23, v201 row_newbcast:1 row_mask:0xf bank_mask:0xf
 v_mul_f32_dpp v203, v23, v203 row_newbcast:3 row_mask:0xf bank_mask:0xf
 v_mul_f32_dpp v205, v23, v205 row_newbcast:1 row_mask:0xf bank_mask:0xf
 v_mul_f32_dpp v207, v23, v207 row_newbcast:3 row_mask:0xf bank_mask:0xf
 v_cvt_pk_bf16_f32 v200, v200, v204
 v_cvt_pk_bf16_f32 v202, v202, v206
 v_cvt_pk_bf16_f32 v204, v201, v205
 v_cvt_pk_bf16_f32 v206, v203, v207
 v_mul_f32_dpp v232, v23, v232 row_newbcast:0 row_mask:0xf bank_mask:0xf
 v_mul_f32_dpp v234, v23, v234 row_newbcast:2 row_mask:0xf bank_mask:0xf
 v_mul_f32_dpp v236, v23, v236 row_newbcast:0 row_mask:0xf bank_mask:0xf
 v_mul_f32_dpp v238, v23, v238 row_newbcast:2 row_mask:0xf bank_mask:0xf
 v_cvt_pk_bf16_f32 v201, v232, v236
 v_cvt_pk_bf16_f32 v203, v234, v238
 v_mfma_f32_16x16x32_bf16 v[72:75], a[228:231], a[84:87], v[72:75]
 s_add_u32 s20, s20, 12288
 ds_write_b128 v14, v[200:203] offset:32768
 v_mul_f32_dpp v233, v23, v233 row_newbcast:1 row_mask:0xf bank_mask:0xf
 v_mul_f32_dpp v235, v23, v235 row_newbcast:3 row_mask:0xf bank_mask:0xf
 v_mul_f32_dpp v237, v23, v237 row_newbcast:1 row_mask:0xf bank_mask:0xf
 v_mul_f32_dpp v239, v23, v239 row_newbcast:3 row_mask:0xf bank_mask:0xf
 v_mfma_f32_16x16x32_bf16 v[64:67], a[224:227], a[64:67], v[64:67]
 ds_read_b128 a[224:227], v1 offset:19456
 v_cvt_pk_bf16_f32 v205, v233, v237
 v_cvt_pk_bf16_f32 v207, v235, v239
 v_mfma_f32_16x16x32_bf16 v[64:67], a[228:231], a[80:83], v[64:67]
 s_waitcnt lgkmcnt(2)
 ds_write_b128 v15, v[204:207] offset:32768
 ds_read_b128 a[228:231], v1 offset:19968
 v_mfma_f32_16x16x32_bf16 v[68:71], a[232:235], a[64:67], 0
 ds_read_b64_tr_b16 a[168:169], v12 offset:32768
 v_mul_f32_dpp v208, v24, v208 row_newbcast:0 row_mask:0xf bank_mask:0xf
 v_mfma_f32_16x16x32_bf16 v[68:71], a[236:239], a[80:83], v[68:71]
 ds_read_b64_tr_b16 a[170:171], v7 offset:32768
 ds_read_b64_tr_b16 a[172:173], v12 offset:33280
 v_mfma_f32_16x16x32_bf16 v[76:79], a[232:235], a[68:71], 0
 ds_read_b64_tr_b16 a[174:175], v7 offset:33280
 v_mul_f32_dpp v210, v24, v210 row_newbcast:2 row_mask:0xf bank_mask:0xf
 v_mul_f32_dpp v212, v24, v212 row_newbcast:0 row_mask:0xf bank_mask:0xf
 v_mul_f32_dpp v214, v24, v214 row_newbcast:2 row_mask:0xf bank_mask:0xf
 v_mul_f32_dpp v209, v24, v209 row_newbcast:1 row_mask:0xf bank_mask:0xf
 v_mul_f32_dpp v211, v24, v211 row_newbcast:3 row_mask:0xf bank_mask:0xf
 v_mul_f32_dpp v213, v24, v213 row_newbcast:1 row_mask:0xf bank_mask:0xf
 v_mul_f32_dpp v215, v24, v215 row_newbcast:3 row_mask:0xf bank_mask:0xf
 v_cvt_pk_bf16_f32 v208, v208, v212
 v_cvt_pk_bf16_f32 v210, v210, v214
 v_cvt_pk_bf16_f32 v212, v209, v213
 v_cvt_pk_bf16_f32 v214, v211, v215
 v_mul_f32_dpp v240, v24, v240 row_newbcast:0 row_mask:0xf bank_mask:0xf
 v_mul_f32_dpp v242, v24, v242 row_newbcast:2 row_mask:0xf bank_mask:0xf
 v_mul_f32_dpp v244, v24, v244 row_newbcast:0 row_mask:0xf bank_mask:0xf
 v_mul_f32_dpp v246, v24, v246 row_newbcast:2 row_mask:0xf bank_mask:0xf
 v_cvt_pk_bf16_f32 v209, v240, v244
 v_cvt_pk_bf16_f32 v211, v242, v246
 v_mfma_f32_16x16x32_bf16 v[76:79], a[236:239], a[84:87], v[76:79]
 ds_write_b128 v14, v[208:211] offset:24576
 v_mul_f32_dpp v241, v24, v241 row_newbcast:1 row_mask:0xf bank_mask:0xf
 v_mul_f32_dpp v243, v24, v243 row_newbcast:3 row_mask:0xf bank_mask:0xf
 v_mul_f32_dpp v245, v24, v245 row_newbcast:1 row_mask:0xf bank_mask:0xf
 v_mul_f32_dpp v247, v24, v247 row_newbcast:3 row_mask:0xf bank_mask:0xf
 v_mfma_f32_16x16x32_bf16 v[84:87], a[232:235], a[72:75], 0
 v_cvt_pk_bf16_f32 v213, v241, v245
 v_cvt_pk_bf16_f32 v215, v243, v247
 v_mfma_f32_16x16x32_bf16 v[84:87], a[236:239], a[88:91], v[84:87]
 ds_write_b128 v15, v[212:215] offset:24576
 v_mfma_f32_16x16x32_bf16 v[92:95], a[232:235], a[76:79], 0
 ds_read_b64_tr_b16 a[176:177], v12 offset:24576
 ds_read_b128 a[232:235], v1 offset:18432
 v_mfma_f32_16x16x32_bf16 v[92:95], a[236:239], a[92:95], v[92:95]
 s_waitcnt lgkmcnt(4)
 ds_read_b64_tr_b16 a[178:179], v7 offset:24576
 ds_read_b64_tr_b16 a[180:181], v12 offset:25088
 ds_read_b128 a[236:239], v1 offset:18944
 v_mfma_f32_16x16x32_bf16 v[92:95], a[224:227], a[44:47], v[92:95]
 ds_read_b64_tr_b16 a[182:183], v7 offset:25088
 buffer_store_dwordx4 a[104:107], v10, s[16:19], s52 offen nt
 v_mul_f32_dpp v216, v25, v216 row_newbcast:0 row_mask:0xf bank_mask:0xf
 v_mul_f32_dpp v218, v25, v218 row_newbcast:2 row_mask:0xf bank_mask:0xf
 v_mul_f32_dpp v220, v25, v220 row_newbcast:0 row_mask:0xf bank_mask:0xf
 v_mul_f32_dpp v222, v25, v222 row_newbcast:2 row_mask:0xf bank_mask:0xf
 v_mul_f32_dpp v217, v25, v217 row_newbcast:1 row_mask:0xf bank_mask:0xf
 v_mul_f32_dpp v219, v25, v219 row_newbcast:3 row_mask:0xf bank_mask:0xf
 v_mul_f32_dpp v221, v25, v221 row_newbcast:1 row_mask:0xf bank_mask:0xf
 v_mul_f32_dpp v223, v25, v223 row_newbcast:3 row_mask:0xf bank_mask:0xf
 v_cvt_pk_bf16_f32 v216, v216, v220
 v_cvt_pk_bf16_f32 v218, v218, v222
 v_cvt_pk_bf16_f32 v220, v217, v221
 v_cvt_pk_bf16_f32 v222, v219, v223
 v_mul_f32_dpp v248, v25, v248 row_newbcast:0 row_mask:0xf bank_mask:0xf
 v_mul_f32_dpp v250, v25, v250 row_newbcast:2 row_mask:0xf bank_mask:0xf
 v_mul_f32_dpp v252, v25, v252 row_newbcast:0 row_mask:0xf bank_mask:0xf
 v_mul_f32_dpp v254, v25, v254 row_newbcast:2 row_mask:0xf bank_mask:0xf
 v_cvt_pk_bf16_f32 v217, v248, v252
 v_cvt_pk_bf16_f32 v219, v250, v254
 v_mfma_f32_16x16x32_bf16 v[92:95], a[228:231], a[60:63], v[92:95]
 ds_write_b128 v14, v[216:219] offset:32768
 v_mul_f32_dpp v249, v25, v249 row_newbcast:1 row_mask:0xf bank_mask:0xf
 v_mul_f32_dpp v251, v25, v251 row_newbcast:3 row_mask:0xf bank_mask:0xf
 v_mul_f32_dpp v253, v25, v253 row_newbcast:1 row_mask:0xf bank_mask:0xf
 v_mul_f32_dpp v255, v25, v255 row_newbcast:3 row_mask:0xf bank_mask:0xf
 v_mfma_f32_16x16x32_bf16 v[84:87], a[224:227], a[40:43], v[84:87]
 v_cvt_pk_bf16_f32 v221, v249, v253
 v_cvt_pk_bf16_f32 v223, v251, v255
 v_mfma_f32_16x16x32_bf16 v[84:87], a[228:231], a[56:59], v[84:87]
 ds_write_b128 v15, v[220:223] offset:32768
 v_mfma_f32_16x16x32_bf16 v[76:79], a[224:227], a[36:39], v[76:79]
 ds_read_b64_tr_b16 a[184:185], v12 offset:32768
 v_max_f32 v20, v20, v39
 v_mfma_f32_16x16x32_bf16 v[76:79], a[228:231], a[52:55], v[76:79]
 ds_read_b64_tr_b16 a[186:187], v7 offset:32768
 ds_read_b64_tr_b16 a[188:189], v12 offset:33280
 v_mfma_f32_16x16x32_bf16 v[68:71], a[224:227], a[32:35], v[68:71]
 ds_read_b64_tr_b16 a[190:191], v7 offset:33280
 ds_read_b64_tr_b16 a[224:225], v3 offset:0
 ds_read_b64_tr_b16 a[226:227], v3 offset:6144
 v_mfma_f32_16x16x32_bf16 v[68:71], a[228:231], a[48:51], v[68:71]
 s_waitcnt lgkmcnt(7)
 ds_read_b64_tr_b16 a[228:229], v3 offset:256
 v_mov_b32 v26, v20
 v_mfma_f32_16x16x32_bf16 v[68:71], a[232:235], a[0:3], v[68:71]
 ds_read_b64_tr_b16 a[230:231], v3 offset:6400
 v_max3_f32 v21, v40, v41, v42
 v_mfma_f32_16x16x32_bf16 v[68:71], a[236:239], a[16:19], v[68:71]
 v_max3_f32 v21, v21, v43, v44
 v_max3_f32 v21, v21, v45, v46
 v_mfma_f32_16x16x32_bf16 v[76:79], a[232:235], a[4:7], v[76:79]
 v_permlane16_swap_b32 v20, v26
 v_max_f32 v21, v21, v47
 v_mfma_f32_16x16x32_bf16 v[76:79], a[236:239], a[20:23], v[76:79]
 v_max_f32 v20, v20, v26
 v_mov_b32 v27, v21
 v_mov_b32 v26, v20
 v_mfma_f32_16x16x32_bf16 v[84:87], a[232:235], a[8:11], v[84:87]
 v_permlane16_swap_b32 v21, v27
 v_permlane32_swap_b32 v20, v26
 v_max_f32 v21, v21, v27
 v_max_f32 v20, v20, v26
 v_mov_b32 v27, v21
 v_mfma_f32_16x16x32_bf16 v[84:87], a[236:239], a[24:27], v[84:87]
 v_mul_f32 v16, s23, v20
 v_fma_f32 v32, v32, s22, v16
 v_fma_f32 v33, v33, s22, v16
 v_permlane32_swap_b32 v21, v27
 v_max3_f32 v20, v48, v49, v50
 v_fma_f32 v34, v34, s22, v16
 v_fma_f32 v35, v35, s22, v16
 v_exp_f32 v32, v32
 v_exp_f32 v33, v33
 v_max_f32 v21, v21, v27
 v_max3_f32 v20, v20, v51, v52
 v_fma_f32 v36, v36, s22, v16
 v_fma_f32 v37, v37, s22, v16
 v_fma_f32 v38, v38, s22, v16
 v_fma_f32 v39, v39, s22, v16
 v_exp_f32 v34, v34
 v_exp_f32 v35, v35
 v_mfma_f32_16x16x32_bf16 v[92:95], a[232:235], a[12:15], v[92:95]
 ds_read_b64_tr_b16 a[232:233], v3 offset:512
 ds_read_b64_tr_b16 a[234:235], v3 offset:6656
 v_mul_f32 v17, s23, v21
 v_max3_f32 v20, v20, v53, v54
 v_exp_f32 v36, v36
 v_exp_f32 v37, v37
 v_exp_f32 v38, v38
 v_exp_f32 v39, v39
 v_max_f32 v20, v20, v55
 v_fma_f32 v40, v40, s22, v17
 v_fma_f32 v41, v41, s22, v17
 v_cvt_pk_bf16_f32 v32, v32, v33
 v_mov_b32 v26, v20
 v_max3_f32 v21, v56, v57, v58
 v_fma_f32 v42, v42, s22, v17
 v_fma_f32 v43, v43, s22, v17
 v_cvt_pk_bf16_f32 v33, v34, v35
 v_exp_f32 v40, v40
 v_exp_f32 v41, v41
 v_max3_f32 v21, v21, v59, v60
 v_fma_f32 v44, v44, s22, v17
 v_fma_f32 v45, v45, s22, v17
 v_fma_f32 v46, v46, s22, v17
 v_fma_f32 v47, v47, s22, v17
 v_cvt_pk_bf16_f32 v34, v36, v37
 v_cvt_pk_bf16_f32 v35, v38, v39
 v_exp_f32 v42, v42
 v_exp_f32 v43, v43
 v_mfma_f32_16x16x32_bf16 v[92:95], a[236:239], a[28:31], v[92:95]
 s_waitcnt lgkmcnt(0)
 v_max3_f32 v21, v21, v61, v62
 v_exp_f32 v44, v44
 v_exp_f32 v45, v45
 v_exp_f32 v46, v46
 v_exp_f32 v47, v47
 v_permlane16_swap_b32 v20, v26
 v_max_f32 v21, v21, v63
 v_cvt_pk_bf16_f32 v40, v40, v41
 v_max_f32 v20, v20, v26
 v_mov_b32 v27, v21
 v_cvt_pk_bf16_f32 v41, v42, v43
 v_mov_b32 v26, v20
 v_cvt_pk_bf16_f32 v42, v44, v45
 v_cvt_pk_bf16_f32 v43, v46, v47
 v_mfma_f32_16x16x32_bf16 v[96:99], v[32:35], a[224:227], 0
 buffer_store_dwordx4 a[108:111], v10, s[16:19], s53 offen nt
 ds_read_b64_tr_b16 a[236:237], v3 offset:768
 ds_read_b64_tr_b16 a[238:239], v3 offset:6912
 v_permlane16_swap_b32 v21, v27
 v_permlane32_swap_b32 v20, v26
 v_max_f32 v21, v21, v27
 v_max_f32 v20, v20, v26
 v_mov_b32 v27, v21
 v_mfma_f32_16x16x32_bf16 v[104:107], v[40:43], a[224:227], 0
 v_mul_f32 v18, s23, v20
 v_fma_f32 v48, v48, s22, v18
 v_fma_f32 v49, v49, s22, v18
 v_permlane32_swap_b32 v21, v27
 v_fma_f32 v50, v50, s22, v18
 v_fma_f32 v51, v51, s22, v18
 v_exp_f32 v48, v48
 v_exp_f32 v49, v49
 v_max_f32 v21, v21, v27
 v_fma_f32 v52, v52, s22, v18
 v_fma_f32 v53, v53, s22, v18
 v_fma_f32 v54, v54, s22, v18
 v_fma_f32 v55, v55, s22, v18
 v_exp_f32 v50, v50
 v_exp_f32 v51, v51
 v_mfma_f32_16x16x32_bf16 v[100:103], v[32:35], a[228:231], 0
 v_mul_f32 v19, s23, v21
 v_exp_f32 v52, v52
 v_exp_f32 v53, v53
 v_exp_f32 v54, v54
 v_exp_f32 v55, v55
 v_fma_f32 v56, v56, s22, v19
 v_fma_f32 v57, v57, s22, v19
 v_cvt_pk_bf16_f32 v48, v48, v49
 v_fma_f32 v58, v58, s22, v19
 v_fma_f32 v59, v59, s22, v19
 v_cvt_pk_bf16_f32 v49, v50, v51
 v_exp_f32 v56, v56
 v_exp_f32 v57, v57
 v_fma_f32 v60, v60, s22, v19
 v_fma_f32 v61, v61, s22, v19
 v_fma_f32 v62, v62, s22, v19
 v_fma_f32 v63, v63, s22, v19
 v_cvt_pk_bf16_f32 v50, v52, v53
 v_cvt_pk_bf16_f32 v51, v54, v55
 v_exp_f32 v58, v58
 v_exp_f32 v59, v59
 v_mfma_f32_16x16x32_bf16 v[108:111], v[40:43], a[228:231], 0
 v_exp_f32 v60, v60
 v_exp_f32 v61, v61
 v_exp_f32 v62, v62
 v_exp_f32 v63, v63
 v_cvt_pk_bf16_f32 v56, v56, v57
 v_cvt_pk_bf16_f32 v57, v58, v59
 v_cvt_pk_bf16_f32 v58, v60, v61
 v_cvt_pk_bf16_f32 v59, v62, v63
 v_mfma_f32_16x16x32_bf16 a[192:195], v[48:51], a[224:227], 0
 v_fma_f32 v64, v64, s22, v16
 v_fma_f32 v65, v65, s22, v16
 v_mfma_f32_16x16x32_bf16 a[200:203], v[56:59], a[224:227], 0
 ds_read_b64_tr_b16 a[224:225], v3 offset:1024
 v_fma_f32 v66, v66, s22, v16
 v_mfma_f32_16x16x32_bf16 a[196:199], v[48:51], a[228:231], 0
 ds_read_b64_tr_b16 a[226:227], v3 offset:7168
 v_fma_f32 v67, v67, s22, v16
 v_mfma_f32_16x16x32_bf16 a[204:207], v[56:59], a[228:231], 0
 ds_read_b64_tr_b16 a[228:229], v3 offset:1280
 v_fma_f32 v68, v68, s22, v16
 v_mfma_f32_16x16x32_bf16 a[208:211], v[48:51], a[232:235], 0
 ds_read_b64_tr_b16 a[230:231], v3 offset:7424
 v_fma_f32 v69, v69, s22, v16
 v_mfma_f32_16x16x32_bf16 a[216:219], v[56:59], a[232:235], 0
 s_waitcnt lgkmcnt(4)
 v_exp_f32 v64, v64
 v_mfma_f32_16x16x32_bf16 a[212:215], v[48:51], a[236:239], 0
 v_exp_f32 v65, v65
 v_mfma_f32_16x16x32_bf16 a[220:223], v[56:59], a[236:239], 0
 v_exp_f32 v66, v66
 v_mfma_f32_16x16x32_bf16 v[112:115], v[32:35], a[232:235], 0
 s_waitcnt vmcnt(21)
 s_barrier
 v_fma_f32 v70, v70, s22, v16
 v_mfma_f32_16x16x32_bf16 v[120:123], v[40:43], a[232:235], 0
 ds_read_b64_tr_b16 a[232:233], v3 offset:1536
 v_fma_f32 v71, v71, s22, v16
 v_mfma_f32_16x16x32_bf16 v[116:119], v[32:35], a[236:239], 0
 ds_read_b64_tr_b16 a[234:235], v3 offset:7680
 v_fma_f32 v72, v72, s22, v17
 v_mfma_f32_16x16x32_bf16 v[124:127], v[40:43], a[236:239], 0
 s_waitcnt lgkmcnt(4)
 ds_read_b64_tr_b16 a[236:237], v3 offset:1792
 s_add_u32 m0, s21, 0
 v_mfma_f32_16x16x32_bf16 v[128:131], v[32:35], a[224:227], 0
 s_add_u32 s25, s25, 14080
 buffer_store_dwordx4 a[112:115], v10, s[16:19], s54 offen nt
 buffer_load_dwordx4 v4, s[4:7], s20 offen lds
 ds_read_b64_tr_b16 a[238:239], v3 offset:7936
 v_mfma_f32_16x16x32_bf16 v[136:139], v[40:43], a[224:227], 0
 s_waitcnt lgkmcnt(4)
 v_exp_f32 v67, v67
 v_mfma_f32_16x16x32_bf16 v[132:135], v[32:35], a[228:231], 0
 v_exp_f32 v68, v68
 v_mfma_f32_16x16x32_bf16 v[140:143], v[40:43], a[228:231], 0
 v_exp_f32 v69, v69
 v_mfma_f32_16x16x32_bf16 v[144:147], v[48:51], a[224:227], 0
 v_exp_f32 v70, v70
 v_mfma_f32_16x16x32_bf16 v[152:155], v[56:59], a[224:227], 0
 ds_read_b64_tr_b16 a[224:225], v3 offset:2048
 v_fma_f32 v73, v73, s22, v17
 v_mfma_f32_16x16x32_bf16 v[148:151], v[48:51], a[228:231], 0
 buffer_load_dwordx4 v5, s[4:7], s20 offen offset:1024 lds
 ds_read_b64_tr_b16 a[226:227], v3 offset:8192
 v_mfma_f32_16x16x32_bf16 v[156:159], v[56:59], a[228:231], 0
 s_waitcnt lgkmcnt(3)
 ds_read_b64_tr_b16 a[228:229], v3 offset:2304
 v_cvt_pk_bf16_f32 v64, v64, v65
 v_mfma_f32_16x16x32_bf16 v[176:179], v[48:51], a[232:235], 0
 ds_read_b64_tr_b16 a[230:231], v3 offset:8448
 v_fma_f32 v74, v74, s22, v17
 v_mfma_f32_16x16x32_bf16 v[184:187], v[56:59], a[232:235], 0
 s_waitcnt lgkmcnt(4)
 v_exp_f32 v71, v71
 v_mfma_f32_16x16x32_bf16 v[180:183], v[48:51], a[236:239], 0
 v_exp_f32 v72, v72
 v_mfma_f32_16x16x32_bf16 v[188:191], v[56:59], a[236:239], 0
 v_exp_f32 v73, v73
 v_mfma_f32_16x16x32_bf16 v[160:163], v[32:35], a[232:235], 0
 buffer_load_dwordx4 v6, s[4:7], s20 offen offset:2048 lds
 v_mfma_f32_16x16x32_bf16 v[168:171], v[40:43], a[232:235], 0
 ds_read_b64_tr_b16 a[232:233], v3 offset:2560
 v_fma_f32 v75, v75, s22, v17
 v_mfma_f32_16x16x32_bf16 v[164:167], v[32:35], a[236:239], 0
 ds_read_b64_tr_b16 a[234:235], v3 offset:8704
 v_cvt_pk_bf16_f32 v65, v66, v67
 v_mfma_f32_16x16x32_bf16 v[172:175], v[40:43], a[236:239], 0
 s_waitcnt lgkmcnt(4)
 ds_read_b64_tr_b16 a[236:237], v3 offset:2816
 v_fma_f32 v76, v76, s22, v17
 v_mfma_f32_16x16x32_bf16 v[192:195], v[32:35], a[224:227], 0
 buffer_store_dwordx4 a[116:119], v10, s[16:19], s55 offen nt
 ds_read_b64_tr_b16 a[238:239], v3 offset:8960
 v_mfma_f32_16x16x32_bf16 v[200:203], v[40:43], a[224:227], 0
 s_waitcnt lgkmcnt(4)
 s_add_u32 m0, s21, 110592
 v_fma_f32 v77, v77, s22, v17
 v_mfma_f32_16x16x32_bf16 v[196:199], v[32:35], a[228:231], 0
 buffer_load_dwordx4 v8, s[8:11], s25 offen nt lds
 v_mfma_f32_16x16x32_bf16 v[204:207], v[40:43], a[228:231], 0
 s_sub_u32 s25, s25, 896
 v_exp_f32 v74, v74
 v_mfma_f32_16x16x32_bf16 v[208:211], v[48:51], a[224:227], 0
 v_exp_f32 v75, v75
 v_mfma_f32_16x16x32_bf16 v[216:219], v[56:59], a[224:227], 0
 ds_read_b128 a[224:227], v1 offset:24576
 v_fma_f32 v78, v78, s22, v17
 v_mfma_f32_16x16x32_bf16 v[212:215], v[48:51], a[228:231], 0
 v_exp_f32 v76, v76
 v_mfma_f32_16x16x32_bf16 v[220:223], v[56:59], a[228:231], 0
 s_waitcnt lgkmcnt(2)
 ds_read_b128 a[228:231], v1 offset:25088
 v_fma_f32 v79, v79, s22, v17
 v_mfma_f32_16x16x32_bf16 v[240:243], v[48:51], a[232:235], 0
 buffer_load_dwordx4 v8, s[8:11], s25 offen offset:1024 nt lds
 v_mfma_f32_16x16x32_bf16 v[248:251], v[56:59], a[232:235], 0
 s_waitcnt lgkmcnt(2)
 s_sub_u32 s25, s25, 896
 v_cvt_pk_bf16_f32 v66, v68, v69
 v_mfma_f32_16x16x32_bf16 v[244:247], v[48:51], a[236:239], 0
 v_exp_f32 v77, v77
 v_mfma_f32_16x16x32_bf16 v[252:255], v[56:59], a[236:239], 0
 v_exp_f32 v78, v78
 v_mfma_f32_16x16x32_bf16 v[224:227], v[32:35], a[232:235], 0
 v_exp_f32 v79, v79
 v_mfma_f32_16x16x32_bf16 v[232:235], v[40:43], a[232:235], 0
 ds_read_b128 a[232:235], v1 offset:25600
 v_cvt_pk_bf16_f32 v67, v70, v71
 v_mfma_f32_16x16x32_bf16 v[228:231], v[32:35], a[236:239], 0
 buffer_load_dwordx4 v8, s[8:11], s25 offen offset:2048 nt lds
 v_mfma_f32_16x16x32_bf16 v[236:239], v[40:43], a[236:239], 0
 ds_read_b128 a[236:239], v1 offset:26112
 v_cvt_pk_bf16_f32 v72, v72, v73
 v_mfma_f32_16x16x32_bf16 v[28:31], a[240:243], v[32:35], 0
 v_cvt_pk_bf16_f32 v73, v74, v75
 v_cvt_pk_bf16_f32 v74, v76, v77
 v_mfma_f32_16x16x32_bf16 a[244:247], a[240:243], v[40:43], 0
 v_cvt_pk_bf16_f32 v75, v78, v79
 v_fma_f32 v80, v80, s22, v18
 v_mfma_f32_16x16x32_bf16 a[248:251], a[240:243], v[48:51], 0
 v_exp_f32 v80, v80
 v_mfma_f32_16x16x32_bf16 a[252:255], a[240:243], v[56:59], 0
 s_waitcnt lgkmcnt(2)
 v_fma_f32 v81, v81, s22, v18
 v_fma_f32 v82, v82, s22, v18
 v_mfma_f32_16x16x32_bf16 v[56:59], a[224:227], a[12:15], 0
 v_exp_f32 v81, v81
 v_mfma_f32_16x16x32_bf16 v[56:59], a[228:231], a[28:31], v[56:59]
 v_exp_f32 v82, v82
 v_mfma_f32_16x16x32_bf16 v[48:51], a[224:227], a[8:11], 0
 v_fma_f32 v83, v83, s22, v18
 v_fma_f32 v84, v84, s22, v18
 v_mfma_f32_16x16x32_bf16 v[48:51], a[228:231], a[24:27], v[48:51]
 v_exp_f32 v83, v83
 v_mfma_f32_16x16x32_bf16 v[40:43], a[224:227], a[4:7], 0
 buffer_store_dwordx4 a[120:123], v10, s[16:19], s56 offen nt
 v_mfma_f32_16x16x32_bf16 v[40:43], a[228:231], a[20:23], v[40:43]
 v_exp_f32 v84, v84
 v_mfma_f32_16x16x32_bf16 v[32:35], a[224:227], a[0:3], 0
 ds_read_b128 a[224:227], v1 offset:26624
 v_fma_f32 v85, v85, s22, v18
 v_mfma_f32_16x16x32_bf16 v[32:35], a[228:231], a[16:19], v[32:35]
 s_waitcnt lgkmcnt(1)
 ds_read_b128 a[228:231], v1 offset:27136
 v_fma_f32 v86, v86, s22, v18
 v_mfma_f32_16x16x32_bf16 v[32:35], a[232:235], a[32:35], v[32:35]
 v_exp_f32 v85, v85
 v_mfma_f32_16x16x32_bf16 v[32:35], a[236:239], a[48:51], v[32:35]
 v_exp_f32 v86, v86
 v_mfma_f32_16x16x32_bf16 v[40:43], a[232:235], a[36:39], v[40:43]
 v_fma_f32 v87, v87, s22, v18
 v_fma_f32 v88, v88, s22, v19
 v_mfma_f32_16x16x32_bf16 v[40:43], a[236:239], a[52:55], v[40:43]
 v_exp_f32 v87, v87
 v_mfma_f32_16x16x32_bf16 v[48:51], a[232:235], a[40:43], v[48:51]
 v_exp_f32 v88, v88
 v_mfma_f32_16x16x32_bf16 v[48:51], a[236:239], a[56:59], v[48:51]
 v_fma_f32 v89, v89, s22, v19
 v_cvt_pk_bf16_f32 v80, v80, v81
 v_mfma_f32_16x16x32_bf16 v[56:59], a[232:235], a[44:47], v[56:59]
 ds_read_b128 a[232:235], v1 offset:32768
 v_fma_f32 v90, v90, s22, v19
 v_mfma_f32_16x16x32_bf16 v[56:59], a[236:239], a[60:63], v[56:59]
 s_waitcnt lgkmcnt(2)
 ds_read_b128 a[236:239], v1 offset:33280
 v_fma_f32 v91, v91, s22, v19
 v_mfma_f32_16x16x32_bf16 v[56:59], a[224:227], a[76:79], v[56:59]
 s_waitcnt lgkmcnt(2)
 v_exp_f32 v89, v89
 v_mfma_f32_16x16x32_bf16 v[56:59], a[228:231], a[92:95], v[56:59]
 v_exp_f32 v90, v90
 v_mfma_f32_16x16x32_bf16 v[48:51], a[224:227], a[72:75], v[48:51]
 v_exp_f32 v91, v91
 v_mfma_f32_16x16x32_bf16 v[48:51], a[228:231], a[88:91], v[48:51]
 v_cvt_pk_bf16_f32 v81, v82, v83
 v_fma_f32 v92, v92, s22, v19
 v_mfma_f32_16x16x32_bf16 v[40:43], a[224:227], a[68:71], v[40:43]
 v_exp_f32 v92, v92
 v_mfma_f32_16x16x32_bf16 v[40:43], a[228:231], a[84:87], v[40:43]
 v_fma_f32 v93, v93, s22, v19
 v_fma_f32 v94, v94, s22, v19
 v_mfma_f32_16x16x32_bf16 v[32:35], a[224:227], a[64:67], v[32:35]
 ds_read_b128 a[224:227], v1 offset:31744
 v_fma_f32 v95, v95, s22, v19
 v_mfma_f32_16x16x32_bf16 v[32:35], a[228:231], a[80:83], v[32:35]
 s_waitcnt lgkmcnt(2)
 ds_read_b128 a[228:231], v1 offset:32256
 v_cvt_pk_bf16_f32 v82, v84, v85
 v_mfma_f32_16x16x32_bf16 v[36:39], a[232:235], a[64:67], 0
 s_waitcnt lgkmcnt(2)
 v_exp_f32 v93, v93
 v_mfma_f32_16x16x32_bf16 v[36:39], a[236:239], a[80:83], v[36:39]
 v_exp_f32 v94, v94
 v_mfma_f32_16x16x32_bf16 v[44:47], a[232:235], a[68:71], 0
 v_exp_f32 v95, v95
 v_mfma_f32_16x16x32_bf16 v[44:47], a[236:239], a[84:87], v[44:47]
 v_cvt_pk_bf16_f32 v83, v86, v87
 v_cvt_pk_bf16_f32 v88, v88, v89
 v_mfma_f32_16x16x32_bf16 v[52:55], a[232:235], a[72:75], 0
 v_cvt_pk_bf16_f32 v89, v90, v91
 v_cvt_pk_bf16_f32 v90, v92, v93
 v_mfma_f32_16x16x32_bf16 v[52:55], a[236:239], a[88:91], v[52:55]
 v_cvt_pk_bf16_f32 v91, v94, v95
 v_mfma_f32_16x16x32_bf16 v[60:63], a[232:235], a[76:79], 0
 ds_read_b128 a[232:235], v1 offset:30720
 v_fma_f32 v32, v32, s22, v16
 v_mfma_f32_16x16x32_bf16 v[60:63], a[236:239], a[92:95], v[60:63]
 s_waitcnt lgkmcnt(2)
 ds_read_b128 a[236:239], v1 offset:31232
 v_fma_f32 v33, v33, s22, v16
 v_mfma_f32_16x16x32_bf16 v[60:63], a[224:227], a[44:47], v[60:63]
 s_waitcnt lgkmcnt(2)
 v_exp_f32 v32, v32
 v_mfma_f32_16x16x32_bf16 v[60:63], a[228:231], a[60:63], v[60:63]
 v_exp_f32 v33, v33
 v_mfma_f32_16x16x32_bf16 v[52:55], a[224:227], a[40:43], v[52:55]
 v_fma_f32 v34, v34, s22, v16
 v_fma_f32 v35, v35, s22, v16
 v_mfma_f32_16x16x32_bf16 v[52:55], a[228:231], a[56:59], v[52:55]
 v_exp_f32 v34, v34
 v_mfma_f32_16x16x32_bf16 v[44:47], a[224:227], a[36:39], v[44:47]
 v_exp_f32 v35, v35
 v_mfma_f32_16x16x32_bf16 v[44:47], a[228:231], a[52:55], v[44:47]
 v_fma_f32 v40, v40, s22, v17
 v_fma_f32 v41, v41, s22, v17
 v_mfma_f32_16x16x32_bf16 v[36:39], a[224:227], a[32:35], v[36:39]
 ds_read_b64_tr_b16 a[224:225], v3 offset:12288
 v_cvt_pk_bf16_f32 v32, v32, v33
 v_mfma_f32_16x16x32_bf16 v[36:39], a[228:231], a[48:51], v[36:39]
 s_waitcnt lgkmcnt(2)
 ds_read_b64_tr_b16 a[226:227], v3 offset:18432
 v_fma_f32 v42, v42, s22, v17
 v_mfma_f32_16x16x32_bf16 v[36:39], a[232:235], a[0:3], v[36:39]
 s_waitcnt lgkmcnt(2)
 ds_read_b64_tr_b16 a[228:229], v3 offset:12544
 v_fma_f32 v43, v43, s22, v17
 v_mfma_f32_16x16x32_bf16 v[36:39], a[236:239], a[16:19], v[36:39]
 ds_read_b64_tr_b16 a[230:231], v3 offset:18688
 v_cvt_pk_bf16_f32 v33, v34, v35
 v_mfma_f32_16x16x32_bf16 v[44:47], a[232:235], a[4:7], v[44:47]
 v_exp_f32 v40, v40
 v_mfma_f32_16x16x32_bf16 v[44:47], a[236:239], a[20:23], v[44:47]
 v_exp_f32 v41, v41
 v_mfma_f32_16x16x32_bf16 v[52:55], a[232:235], a[8:11], v[52:55]
 v_exp_f32 v42, v42
 v_mfma_f32_16x16x32_bf16 v[52:55], a[236:239], a[24:27], v[52:55]
 v_exp_f32 v43, v43
 v_mfma_f32_16x16x32_bf16 v[60:63], a[232:235], a[12:15], v[60:63]
 ds_read_b64_tr_b16 a[232:233], v3 offset:12800
 v_fma_f32 v36, v36, s22, v16
 v_mfma_f32_16x16x32_bf16 v[60:63], a[236:239], a[28:31], v[60:63]
 ds_read_b64_tr_b16 a[234:235], v3 offset:18944
 v_fma_f32 v37, v37, s22, v16
 v_mfma_f32_16x16x32_bf16 v[28:31], a[240:243], v[64:67], v[28:31]
 ds_read_b64_tr_b16 a[236:237], v3 offset:13056
 v_fma_f32 v38, v38, s22, v16
 v_mfma_f32_16x16x32_bf16 a[244:247], a[240:243], v[72:75], a[244:247]
 s_waitcnt lgkmcnt(4)
 ds_read_b64_tr_b16 a[238:239], v3 offset:19200
 v_fma_f32 v39, v39, s22, v16
 v_mfma_f32_16x16x32_bf16 v[96:99], v[64:67], a[224:227], v[96:99]
 v_exp_f32 v36, v36
 v_mfma_f32_16x16x32_bf16 v[104:107], v[72:75], a[224:227], v[104:107]
 s_waitcnt lgkmcnt(4)
 v_exp_f32 v37, v37
 v_mfma_f32_16x16x32_bf16 v[100:103], v[64:67], a[228:231], v[100:103]
 v_exp_f32 v38, v38
 v_mfma_f32_16x16x32_bf16 v[108:111], v[72:75], a[228:231], v[108:111]
 s_add_u32 m0, s34, 24576
 v_exp_f32 v39, v39
 v_mfma_f32_16x16x32_bf16 a[192:195], v[80:83], a[224:227], a[192:195]
 buffer_load_dwordx4 v4, s[12:15], s54 offen nt lds
 v_mfma_f32_16x16x32_bf16 a[200:203], v[88:91], a[224:227], a[200:203]
 s_add_u32 m0, s34, 25600
 ds_read_b64_tr_b16 a[224:225], v3 offset:13312
 s_add_u32 s20, s20, 12288
 v_mfma_f32_16x16x32_bf16 a[196:199], v[80:83], a[228:231], a[196:199]
 buffer_load_dwordx4 v4, s[12:15], s55 offen nt lds
 v_mfma_f32_16x16x32_bf16 a[204:207], v[88:91], a[228:231], a[204:207]
 ds_read_b64_tr_b16 a[226:227], v3 offset:19456
 v_fma_f32 v44, v44, s22, v17
 v_mfma_f32_16x16x32_bf16 a[248:251], a[240:243], v[80:83], a[248:251]
 ds_read_b64_tr_b16 a[228:229], v3 offset:13568
 v_fma_f32 v45, v45, s22, v17
 v_mfma_f32_16x16x32_bf16 a[252:255], a[240:243], v[88:91], a[252:255]
 s_waitcnt lgkmcnt(3)
 ds_read_b64_tr_b16 a[230:231], v3 offset:19712
 v_fma_f32 v46, v46, s22, v17
 v_mfma_f32_16x16x32_bf16 a[208:211], v[80:83], a[232:235], a[208:211]
 s_waitcnt vmcnt(25)
 s_barrier
 v_fma_f32 v47, v47, s22, v17
 v_mfma_f32_16x16x32_bf16 a[216:219], v[88:91], a[232:235], a[216:219]
 v_exp_f32 v44, v44
 v_mfma_f32_16x16x32_bf16 a[212:215], v[80:83], a[236:239], a[212:215]
 v_exp_f32 v45, v45
 v_mfma_f32_16x16x32_bf16 a[220:223], v[88:91], a[236:239], a[220:223]
 s_add_u32 m0, s21, 12288
 s_add_u32 s25, s25, 14080
 v_cvt_pk_bf16_f32 v34, v36, v37
 v_mfma_f32_16x16x32_bf16 v[112:115], v[64:67], a[232:235], v[112:115]
 buffer_load_dwordx4 v4, s[4:7], s20 offen nt lds
 v_mfma_f32_16x16x32_bf16 v[120:123], v[72:75], a[232:235], v[120:123]
 ds_read_b64_tr_b16 a[232:233], v3 offset:13824
 v_cvt_pk_bf16_f32 v35, v38, v39
 v_mfma_f32_16x16x32_bf16 v[116:119], v[64:67], a[236:239], v[116:119]
 ds_read_b64_tr_b16 a[234:235], v3 offset:19968
 v_cvt_pk_bf16_f32 v40, v40, v41
 v_mfma_f32_16x16x32_bf16 v[124:127], v[72:75], a[236:239], v[124:127]
 s_waitcnt lgkmcnt(3)
 ds_read_b64_tr_b16 a[236:237], v3 offset:14080
 v_cvt_pk_bf16_f32 v41, v42, v43
 v_mfma_f32_16x16x32_bf16 v[128:131], v[64:67], a[224:227], v[128:131]
 ds_read_b64_tr_b16 a[238:239], v3 offset:20224
 v_cvt_pk_bf16_f32 v42, v44, v45
 v_mfma_f32_16x16x32_bf16 v[136:139], v[72:75], a[224:227], v[136:139]
 s_waitcnt lgkmcnt(4)
 v_exp_f32 v46, v46
 v_mfma_f32_16x16x32_bf16 v[132:135], v[64:67], a[228:231], v[132:135]
 buffer_load_dwordx4 v5, s[4:7], s20 offen offset:1024 nt lds
 v_mfma_f32_16x16x32_bf16 v[140:143], v[72:75], a[228:231], v[140:143]
 v_exp_f32 v47, v47
 v_mfma_f32_16x16x32_bf16 v[144:147], v[80:83], a[224:227], v[144:147]
 v_cvt_pk_bf16_f32 v43, v46, v47
 v_fma_f32 v48, v48, s22, v18
 v_mfma_f32_16x16x32_bf16 v[152:155], v[88:91], a[224:227], v[152:155]
 ds_read_b64_tr_b16 a[224:225], v3 offset:14336
 v_fma_f32 v49, v49, s22, v18
 v_mfma_f32_16x16x32_bf16 v[148:151], v[80:83], a[228:231], v[148:151]
 ds_read_b64_tr_b16 a[226:227], v3 offset:20480
 v_fma_f32 v50, v50, s22, v18
 v_mfma_f32_16x16x32_bf16 v[156:159], v[88:91], a[228:231], v[156:159]
 s_waitcnt lgkmcnt(4)
 ds_read_b64_tr_b16 a[228:229], v3 offset:14592
 v_fma_f32 v51, v51, s22, v18
 v_mfma_f32_16x16x32_bf16 v[176:179], v[80:83], a[232:235], v[176:179]
 buffer_load_dwordx4 v6, s[4:7], s20 offen offset:2048 nt lds
 ds_read_b64_tr_b16 a[230:231], v3 offset:20736
 v_mfma_f32_16x16x32_bf16 v[184:187], v[88:91], a[232:235], v[184:187]
 s_waitcnt lgkmcnt(4)
 v_exp_f32 v48, v48
 v_mfma_f32_16x16x32_bf16 v[180:183], v[80:83], a[236:239], v[180:183]
 v_exp_f32 v49, v49
 v_mfma_f32_16x16x32_bf16 v[188:191], v[88:91], a[236:239], v[188:191]
 v_exp_f32 v50, v50
 v_mfma_f32_16x16x32_bf16 v[160:163], v[64:67], a[232:235], v[160:163]
 v_exp_f32 v51, v51
 v_mfma_f32_16x16x32_bf16 v[168:171], v[72:75], a[232:235], v[168:171]
 s_add_u32 m0, s21, 61440
 ds_read_b64_tr_b16 a[232:233], v3 offset:14848
 v_fma_f32 v52, v52, s22, v18
 v_mfma_f32_16x16x32_bf16 v[164:167], v[64:67], a[236:239], v[164:167]
 buffer_load_dwordx4 v8, s[8:11], s25 offen lds
 ds_read_b64_tr_b16 a[234:235], v3 offset:20992
 v_mfma_f32_16x16x32_bf16 v[172:175], v[72:75], a[236:239], v[172:175]
 s_waitcnt lgkmcnt(3)
 ds_read_b64_tr_b16 a[236:237], v3 offset:15104
 s_sub_u32 s25, s25, 896
 v_mfma_f32_16x16x32_bf16 v[192:195], v[64:67], a[224:227], v[192:195]
 ds_read_b64_tr_b16 a[238:239], v3 offset:21248
 v_fma_f32 v53, v53, s22, v18
 v_mfma_f32_16x16x32_bf16 v[200:203], v[72:75], a[224:227], v[200:203]
 s_waitcnt lgkmcnt(4)
 v_exp_f32 v52, v52
 v_mfma_f32_16x16x32_bf16 v[196:199], v[64:67], a[228:231], v[196:199]
 v_exp_f32 v53, v53
 v_mfma_f32_16x16x32_bf16 v[204:207], v[72:75], a[228:231], v[204:207]
 v_fma_f32 v54, v54, s22, v18
 v_fma_f32 v55, v55, s22, v18
 v_mfma_f32_16x16x32_bf16 v[208:211], v[80:83], a[224:227], v[208:211]
 buffer_load_dwordx4 v8, s[8:11], s25 offen offset:1024 lds
 v_mfma_f32_16x16x32_bf16 v[216:219], v[88:91], a[224:227], v[216:219]
 s_sub_u32 s25, s25, 896
 ds_read_b128 a[224:227], v2 offset:49152
 v_fma_f32 v56, v56, s22, v19
 v_mfma_f32_16x16x32_bf16 v[212:215], v[80:83], a[228:231], v[212:215]
 v_exp_f32 v54, v54
 v_mfma_f32_16x16x32_bf16 v[220:223], v[88:91], a[228:231], v[220:223]
 s_waitcnt lgkmcnt(3)
 ds_read_b128 a[228:231], v2 offset:49664
 v_fma_f32 v57, v57, s22, v19
 v_mfma_f32_16x16x32_bf16 v[240:243], v[80:83], a[232:235], v[240:243]
 v_exp_f32 v55, v55
 v_mfma_f32_16x16x32_bf16 v[248:251], v[88:91], a[232:235], v[248:251]
 s_waitcnt lgkmcnt(2)
 v_exp_f32 v56, v56
 v_mfma_f32_16x16x32_bf16 v[244:247], v[80:83], a[236:239], v[244:247]
 buffer_load_dwordx4 v8, s[8:11], s25 offen offset:2048 lds
 v_mfma_f32_16x16x32_bf16 v[252:255], v[88:91], a[236:239], v[252:255]
 v_exp_f32 v57, v57
 v_mfma_f32_16x16x32_bf16 v[224:227], v[64:67], a[232:235], v[224:227]
 v_cvt_pk_bf16_f32 v48, v48, v49
 v_fma_f32 v58, v58, s22, v19
 v_mfma_f32_16x16x32_bf16 v[232:235], v[72:75], a[232:235], v[232:235]
 ds_read_b128 a[232:235], v2 offset:50176
 v_fma_f32 v59, v59, s22, v19
 v_mfma_f32_16x16x32_bf16 v[228:231], v[64:67], a[236:239], v[228:231]
 v_exp_f32 v58, v58
 v_mfma_f32_16x16x32_bf16 v[236:239], v[72:75], a[236:239], v[236:239]
 s_waitcnt lgkmcnt(2)
 ds_read_b128 a[236:239], v2 offset:50688
 v_cvt_pk_bf16_f32 v49, v50, v51
 v_mfma_f32_16x16x32_bf16 v[88:91], a[224:227], a[12:15], 0
 s_waitcnt lgkmcnt(2)
 v_exp_f32 v59, v59
 v_mfma_f32_16x16x32_bf16 v[88:91], a[228:231], a[28:31], v[88:91]
 v_fma_f32 v60, v60, s22, v19
 v_fma_f32 v61, v61, s22, v19
 v_mfma_f32_16x16x32_bf16 v[80:83], a[224:227], a[8:11], 0
 v_exp_f32 v60, v60
 v_mfma_f32_16x16x32_bf16 v[80:83], a[228:231], a[24:27], v[80:83]
 v_exp_f32 v61, v61
 v_mfma_f32_16x16x32_bf16 v[72:75], a[224:227], a[4:7], 0
 buffer_store_dwordx4 a[124:127], v10, s[16:19], s57 offen nt
 v_mfma_f32_16x16x32_bf16 v[72:75], a[228:231], a[20:23], v[72:75]
 v_fma_f32 v62, v62, s22, v19
 v_fma_f32 v63, v63, s22, v19
 v_mfma_f32_16x16x32_bf16 v[64:67], a[224:227], a[0:3], 0
 ds_read_b128 a[224:227], v2 offset:51200
 v_cvt_pk_bf16_f32 v50, v52, v53
 v_mfma_f32_16x16x32_bf16 v[64:67], a[228:231], a[16:19], v[64:67]
 s_waitcnt lgkmcnt(1)
 ds_read_b128 a[228:231], v2 offset:51712
 v_cvt_pk_bf16_f32 v51, v54, v55
 v_mfma_f32_16x16x32_bf16 v[64:67], a[232:235], a[32:35], v[64:67]
 v_exp_f32 v62, v62
 v_mfma_f32_16x16x32_bf16 v[64:67], a[236:239], a[48:51], v[64:67]
 v_exp_f32 v63, v63
 v_mfma_f32_16x16x32_bf16 v[72:75], a[232:235], a[36:39], v[72:75]
 v_cvt_pk_bf16_f32 v56, v56, v57
 v_cvt_pk_bf16_f32 v57, v58, v59
 v_mfma_f32_16x16x32_bf16 v[72:75], a[236:239], a[52:55], v[72:75]
 v_cvt_pk_bf16_f32 v58, v60, v61
 v_cvt_pk_bf16_f32 v59, v62, v63
 v_mfma_f32_16x16x32_bf16 v[80:83], a[232:235], a[40:43], v[80:83]
 v_mfma_f32_16x16x32_bf16 v[80:83], a[236:239], a[56:59], v[80:83]
 v_mfma_f32_16x16x32_bf16 v[88:91], a[232:235], a[44:47], v[88:91]
 ds_read_b128 a[232:235], v2 offset:57344
 v_mfma_f32_16x16x32_bf16 v[88:91], a[236:239], a[60:63], v[88:91]
 s_waitcnt lgkmcnt(2)
 ds_read_b128 a[236:239], v2 offset:57856
 v_mfma_f32_16x16x32_bf16 v[88:91], a[224:227], a[76:79], v[88:91]
 s_waitcnt lgkmcnt(2)
 v_mfma_f32_16x16x32_bf16 v[88:91], a[228:231], a[92:95], v[88:91]
 v_mfma_f32_16x16x32_bf16 v[80:83], a[224:227], a[72:75], v[80:83]
 v_mfma_f32_16x16x32_bf16 v[80:83], a[228:231], a[88:91], v[80:83]
 v_mfma_f32_16x16x32_bf16 v[72:75], a[224:227], a[68:71], v[72:75]
 v_mfma_f32_16x16x32_bf16 v[72:75], a[228:231], a[84:87], v[72:75]
 v_mfma_f32_16x16x32_bf16 v[64:67], a[224:227], a[64:67], v[64:67]
 ds_read_b128 a[224:227], v2 offset:56320
 v_mfma_f32_16x16x32_bf16 v[64:67], a[228:231], a[80:83], v[64:67]
 s_waitcnt lgkmcnt(2)
 ds_read_b128 a[228:231], v2 offset:56832
 v_mfma_f32_16x16x32_bf16 v[68:71], a[232:235], a[64:67], 0
 s_waitcnt lgkmcnt(2)
 v_mfma_f32_16x16x32_bf16 v[68:71], a[236:239], a[80:83], v[68:71]
 v_mfma_f32_16x16x32_bf16 v[76:79], a[232:235], a[68:71], 0
 v_mfma_f32_16x16x32_bf16 v[76:79], a[236:239], a[84:87], v[76:79]
 v_mfma_f32_16x16x32_bf16 v[84:87], a[232:235], a[72:75], 0
 v_mfma_f32_16x16x32_bf16 v[84:87], a[236:239], a[88:91], v[84:87]
 v_mfma_f32_16x16x32_bf16 v[92:95], a[232:235], a[76:79], 0
 ds_read_b128 a[232:235], v2 offset:55296
 v_fma_f32 v64, v64, s22, v16
 v_mfma_f32_16x16x32_bf16 v[92:95], a[236:239], a[92:95], v[92:95]
 s_waitcnt lgkmcnt(2)
 ds_read_b128 a[236:239], v2 offset:55808
 v_fma_f32 v65, v65, s22, v16
 v_mfma_f32_16x16x32_bf16 v[92:95], a[224:227], a[44:47], v[92:95]
 s_waitcnt lgkmcnt(2)
 v_exp_f32 v64, v64
 v_mfma_f32_16x16x32_bf16 v[92:95], a[228:231], a[60:63], v[92:95]
 v_exp_f32 v65, v65
 v_mfma_f32_16x16x32_bf16 v[84:87], a[224:227], a[40:43], v[84:87]
 v_fma_f32 v72, v72, s22, v17
 v_fma_f32 v73, v73, s22, v17
 v_mfma_f32_16x16x32_bf16 v[84:87], a[228:231], a[56:59], v[84:87]
 v_exp_f32 v72, v72
 v_mfma_f32_16x16x32_bf16 v[76:79], a[224:227], a[36:39], v[76:79]
 v_exp_f32 v73, v73
 v_mfma_f32_16x16x32_bf16 v[76:79], a[228:231], a[52:55], v[76:79]
 v_fma_f32 v66, v66, s22, v16
 v_fma_f32 v67, v67, s22, v16
 v_mfma_f32_16x16x32_bf16 v[68:71], a[224:227], a[32:35], v[68:71]
 ds_read_b64_tr_b16 a[224:225], v13 offset:49152
 v_fma_f32 v74, v74, s22, v17
 v_mfma_f32_16x16x32_bf16 v[68:71], a[228:231], a[48:51], v[68:71]
 s_waitcnt lgkmcnt(2)
 ds_read_b64_tr_b16 a[226:227], v13 offset:55296
 v_fma_f32 v75, v75, s22, v17
 v_mfma_f32_16x16x32_bf16 v[68:71], a[232:235], a[0:3], v[68:71]
 s_waitcnt lgkmcnt(2)
 ds_read_b64_tr_b16 a[228:229], v13 offset:49408
 v_cvt_pk_bf16_f32 v64, v64, v65
 v_mfma_f32_16x16x32_bf16 v[68:71], a[236:239], a[16:19], v[68:71]
 ds_read_b64_tr_b16 a[230:231], v13 offset:55552
 v_cvt_pk_bf16_f32 v72, v72, v73
 v_mfma_f32_16x16x32_bf16 v[76:79], a[232:235], a[4:7], v[76:79]
 v_exp_f32 v66, v66
 v_mfma_f32_16x16x32_bf16 v[76:79], a[236:239], a[20:23], v[76:79]
 v_exp_f32 v67, v67
 v_mfma_f32_16x16x32_bf16 v[84:87], a[232:235], a[8:11], v[84:87]
 v_exp_f32 v74, v74
 v_mfma_f32_16x16x32_bf16 v[84:87], a[236:239], a[24:27], v[84:87]
 v_exp_f32 v75, v75
 v_mfma_f32_16x16x32_bf16 v[92:95], a[232:235], a[12:15], v[92:95]
 ds_read_b64_tr_b16 a[232:233], v13 offset:49664
 v_fma_f32 v68, v68, s22, v16
 v_mfma_f32_16x16x32_bf16 v[92:95], a[236:239], a[28:31], v[92:95]
 ds_read_b64_tr_b16 a[234:235], v13 offset:55808
 v_fma_f32 v69, v69, s22, v16
 v_mfma_f32_16x16x32_bf16 v[28:31], a[240:243], v[32:35], v[28:31]
 ds_read_b64_tr_b16 a[236:237], v13 offset:49920
 v_fma_f32 v70, v70, s22, v16
 v_mfma_f32_16x16x32_bf16 a[244:247], a[240:243], v[40:43], a[244:247]
 s_waitcnt lgkmcnt(4)
 ds_read_b64_tr_b16 a[238:239], v13 offset:56064
 v_fma_f32 v71, v71, s22, v16
 v_mfma_f32_16x16x32_bf16 v[96:99], v[32:35], a[224:227], v[96:99]
 v_exp_f32 v68, v68
 v_mfma_f32_16x16x32_bf16 v[104:107], v[40:43], a[224:227], v[104:107]
 s_waitcnt lgkmcnt(4)
 v_exp_f32 v69, v69
 v_mfma_f32_16x16x32_bf16 v[100:103], v[32:35], a[228:231], v[100:103]
 v_exp_f32 v70, v70
 v_mfma_f32_16x16x32_bf16 v[108:111], v[40:43], a[228:231], v[108:111]
 s_add_u32 m0, s34, 32768
 v_exp_f32 v71, v71
 v_mfma_f32_16x16x32_bf16 a[192:195], v[48:51], a[224:227], a[192:195]
 buffer_load_dwordx4 v4, s[12:15], s56 offen nt lds
 v_mfma_f32_16x16x32_bf16 a[200:203], v[56:59], a[224:227], a[200:203]
 s_add_u32 m0, s34, 33792
 ds_read_b64_tr_b16 a[224:225], v13 offset:50176
 s_add_u32 s20, s20, 12288
 v_mfma_f32_16x16x32_bf16 a[196:199], v[48:51], a[228:231], a[196:199]
 buffer_load_dwordx4 v4, s[12:15], s57 offen nt lds
 v_mfma_f32_16x16x32_bf16 a[204:207], v[56:59], a[228:231], a[204:207]
 ds_read_b64_tr_b16 a[226:227], v13 offset:56320
 v_fma_f32 v76, v76, s22, v17
 v_mfma_f32_16x16x32_bf16 a[248:251], a[240:243], v[48:51], a[248:251]
 ds_read_b64_tr_b16 a[228:229], v13 offset:50432
 v_fma_f32 v77, v77, s22, v17
 v_mfma_f32_16x16x32_bf16 a[252:255], a[240:243], v[56:59], a[252:255]
 s_waitcnt lgkmcnt(3)
 ds_read_b64_tr_b16 a[230:231], v13 offset:56576
 v_fma_f32 v78, v78, s22, v17
 v_mfma_f32_16x16x32_bf16 a[208:211], v[48:51], a[232:235], a[208:211]
 s_waitcnt vmcnt(27)
 s_barrier
 v_fma_f32 v79, v79, s22, v17
 v_mfma_f32_16x16x32_bf16 a[216:219], v[56:59], a[232:235], a[216:219]
 v_exp_f32 v76, v76
 v_mfma_f32_16x16x32_bf16 a[212:215], v[48:51], a[236:239], a[212:215]
 v_exp_f32 v77, v77
 v_mfma_f32_16x16x32_bf16 a[220:223], v[56:59], a[236:239], a[220:223]
 s_add_u32 m0, s21, 24576
 v_exp_f32 v78, v78
 v_mfma_f32_16x16x32_bf16 v[112:115], v[32:35], a[232:235], v[112:115]
 s_add_u32 s25, s25, 14080
 buffer_load_dwordx4 v4, s[4:7], s20 offen lds
 v_mfma_f32_16x16x32_bf16 v[120:123], v[40:43], a[232:235], v[120:123]
 ds_read_b64_tr_b16 a[232:233], v13 offset:50688
 v_cvt_pk_bf16_f32 v65, v66, v67
 v_mfma_f32_16x16x32_bf16 v[116:119], v[32:35], a[236:239], v[116:119]
 ds_read_b64_tr_b16 a[234:235], v13 offset:56832
 v_cvt_pk_bf16_f32 v73, v74, v75
 v_mfma_f32_16x16x32_bf16 v[124:127], v[40:43], a[236:239], v[124:127]
 s_waitcnt lgkmcnt(3)
 ds_read_b64_tr_b16 a[236:237], v13 offset:50944
 v_fma_f32 v80, v80, s22, v18
 v_mfma_f32_16x16x32_bf16 v[128:131], v[32:35], a[224:227], v[128:131]
 ds_read_b64_tr_b16 a[238:239], v13 offset:57088
 v_fma_f32 v81, v81, s22, v18
 v_mfma_f32_16x16x32_bf16 v[136:139], v[40:43], a[224:227], v[136:139]
 s_waitcnt lgkmcnt(4)
 v_exp_f32 v79, v79
 v_mfma_f32_16x16x32_bf16 v[132:135], v[32:35], a[228:231], v[132:135]
 buffer_load_dwordx4 v5, s[4:7], s20 offen offset:1024 lds
 v_mfma_f32_16x16x32_bf16 v[140:143], v[40:43], a[228:231], v[140:143]
 v_fma_f32 v82, v82, s22, v18
 v_fma_f32 v83, v83, s22, v18
 v_mfma_f32_16x16x32_bf16 v[144:147], v[48:51], a[224:227], v[144:147]
 v_fma_f32 v84, v84, s22, v18
 v_fma_f32 v85, v85, s22, v18
 v_mfma_f32_16x16x32_bf16 v[152:155], v[56:59], a[224:227], v[152:155]
 ds_read_b64_tr_b16 a[224:225], v13 offset:51200
 v_fma_f32 v86, v86, s22, v18
 v_mfma_f32_16x16x32_bf16 v[148:151], v[48:51], a[228:231], v[148:151]
 ds_read_b64_tr_b16 a[226:227], v13 offset:57344
 v_fma_f32 v87, v87, s22, v18
 v_mfma_f32_16x16x32_bf16 v[156:159], v[56:59], a[228:231], v[156:159]
 s_waitcnt lgkmcnt(4)
 ds_read_b64_tr_b16 a[228:229], v13 offset:51456
 v_fma_f32 v88, v88, s22, v19
 v_mfma_f32_16x16x32_bf16 v[176:179], v[48:51], a[232:235], v[176:179]
 buffer_load_dwordx4 v6, s[4:7], s20 offen offset:2048 lds
 ds_read_b64_tr_b16 a[230:231], v13 offset:57600
 v_mfma_f32_16x16x32_bf16 v[184:187], v[56:59], a[232:235], v[184:187]
 s_waitcnt lgkmcnt(4)
 v_fma_f32 v89, v89, s22, v19
 v_fma_f32 v90, v90, s22, v19
 v_mfma_f32_16x16x32_bf16 v[180:183], v[48:51], a[236:239], v[180:183]
 v_fma_f32 v91, v91, s22, v19
 v_fma_f32 v92, v92, s22, v19
 v_mfma_f32_16x16x32_bf16 v[188:191], v[56:59], a[236:239], v[188:191]
 v_fma_f32 v93, v93, s22, v19
 v_fma_f32 v94, v94, s22, v19
 v_mfma_f32_16x16x32_bf16 v[160:163], v[32:35], a[232:235], v[160:163]
 v_fma_f32 v95, v95, s22, v19
 v_cvt_pk_bf16_f32 v66, v68, v69
 v_mfma_f32_16x16x32_bf16 v[168:171], v[40:43], a[232:235], v[168:171]
 s_add_u32 m0, s21, 36864
 ds_read_b64_tr_b16 a[232:233], v13 offset:51712
 v_cvt_pk_bf16_f32 v67, v70, v71
 v_mfma_f32_16x16x32_bf16 v[164:167], v[32:35], a[236:239], v[164:167]
 buffer_load_dwordx4 v8, s[8:11], s25 offen nt lds
 ds_read_b64_tr_b16 a[234:235], v13 offset:57856
 v_mfma_f32_16x16x32_bf16 v[172:175], v[40:43], a[236:239], v[172:175]
 s_waitcnt lgkmcnt(3)
 ds_read_b64_tr_b16 a[236:237], v13 offset:51968
 v_cvt_pk_bf16_f32 v74, v76, v77
 v_mfma_f32_16x16x32_bf16 v[192:195], v[32:35], a[224:227], v[192:195]
 s_sub_u32 s25, s25, 896
 ds_read_b64_tr_b16 a[238:239], v13 offset:58112
 v_cvt_pk_bf16_f32 v75, v78, v79
 v_mfma_f32_16x16x32_bf16 v[200:203], v[40:43], a[224:227], v[200:203]
 s_waitcnt lgkmcnt(4)
 v_mfma_f32_16x16x32_bf16 v[196:199], v[32:35], a[228:231], v[196:199]
 v_mfma_f32_16x16x32_bf16 v[204:207], v[40:43], a[228:231], v[204:207]
 v_mfma_f32_16x16x32_bf16 v[208:211], v[48:51], a[224:227], v[208:211]
 buffer_load_dwordx4 v8, s[8:11], s25 offen offset:1024 nt lds
 v_mfma_f32_16x16x32_bf16 v[216:219], v[56:59], a[224:227], v[216:219]
 s_sub_u32 s25, s25, 896
 ds_read_b128 a[224:227], v2 offset:0
 v_mfma_f32_16x16x32_bf16 v[212:215], v[48:51], a[228:231], v[212:215]
 v_mfma_f32_16x16x32_bf16 v[220:223], v[56:59], a[228:231], v[220:223]
 s_waitcnt lgkmcnt(3)
 ds_read_b128 a[228:231], v2 offset:512
 v_mfma_f32_16x16x32_bf16 v[240:243], v[48:51], a[232:235], v[240:243]
 v_mfma_f32_16x16x32_bf16 v[248:251], v[56:59], a[232:235], v[248:251]
 s_waitcnt lgkmcnt(2)
 v_mfma_f32_16x16x32_bf16 v[244:247], v[48:51], a[236:239], v[244:247]
 buffer_load_dwordx4 v8, s[8:11], s25 offen offset:2048 nt lds
 v_mfma_f32_16x16x32_bf16 v[252:255], v[56:59], a[236:239], v[252:255]
 v_mfma_f32_16x16x32_bf16 v[224:227], v[32:35], a[232:235], v[224:227]
 v_mfma_f32_16x16x32_bf16 v[232:235], v[40:43], a[232:235], v[232:235]
 ds_read_b128 a[232:235], v2 offset:1024
 v_mfma_f32_16x16x32_bf16 v[228:231], v[32:35], a[236:239], v[228:231]
 v_mfma_f32_16x16x32_bf16 v[236:239], v[40:43], a[236:239], v[236:239]
 s_branch L_loop
L_tail:
 ds_read_b128 a[236:239], v2 offset:26112
 s_waitcnt lgkmcnt(2)
 v_mfma_f32_16x16x32_bf16 v[88:91], a[224:227], a[12:15], 0
 v_exp_f32 v48, v48
 v_mfma_f32_16x16x32_bf16 v[88:91], a[228:231], a[28:31], v[88:91]
 v_exp_f32 v49, v49
 v_mfma_f32_16x16x32_bf16 v[80:83], a[224:227], a[8:11], 0
 v_exp_f32 v50, v50
 v_mfma_f32_16x16x32_bf16 v[80:83], a[228:231], a[24:27], v[80:83]
 v_exp_f32 v51, v51
 v_mfma_f32_16x16x32_bf16 v[72:75], a[224:227], a[4:7], 0
 buffer_store_dwordx4 a[176:179], v10, s[16:19], s54 offen offset:256 nt
 v_mfma_f32_16x16x32_bf16 v[72:75], a[228:231], a[20:23], v[72:75]
 v_exp_f32 v52, v52
 v_mfma_f32_16x16x32_bf16 v[64:67], a[224:227], a[0:3], 0
 ds_read_b128 a[224:227], v2 offset:26624
 v_cvt_pk_bf16_f32 v48, v48, v49
 v_mfma_f32_16x16x32_bf16 v[64:67], a[228:231], a[16:19], v[64:67]
 s_waitcnt lgkmcnt(1)
 ds_read_b128 a[228:231], v2 offset:27136
 v_cvt_pk_bf16_f32 v49, v50, v51
 v_mfma_f32_16x16x32_bf16 v[64:67], a[232:235], a[32:35], v[64:67]
 v_exp_f32 v53, v53
 v_mfma_f32_16x16x32_bf16 v[64:67], a[236:239], a[48:51], v[64:67]
 v_exp_f32 v54, v54
 v_mfma_f32_16x16x32_bf16 v[72:75], a[232:235], a[36:39], v[72:75]
 v_exp_f32 v55, v55
 v_mfma_f32_16x16x32_bf16 v[72:75], a[236:239], a[52:55], v[72:75]
 v_exp_f32 v56, v56
 v_mfma_f32_16x16x32_bf16 v[80:83], a[232:235], a[40:43], v[80:83]
 v_exp_f32 v57, v57
 v_mfma_f32_16x16x32_bf16 v[80:83], a[236:239], a[56:59], v[80:83]
 v_exp_f32 v58, v58
 v_mfma_f32_16x16x32_bf16 v[88:91], a[232:235], a[44:47], v[88:91]
 ds_read_b128 a[232:235], v2 offset:32768
 v_cvt_pk_bf16_f32 v50, v52, v53
 v_mfma_f32_16x16x32_bf16 v[88:91], a[236:239], a[60:63], v[88:91]
 s_waitcnt lgkmcnt(2)
 ds_read_b128 a[236:239], v2 offset:33280
 v_cvt_pk_bf16_f32 v51, v54, v55
 v_mfma_f32_16x16x32_bf16 v[88:91], a[224:227], a[76:79], v[88:91]
 s_waitcnt lgkmcnt(2)
 v_exp_f32 v59, v59
 v_mfma_f32_16x16x32_bf16 v[88:91], a[228:231], a[92:95], v[88:91]
 v_exp_f32 v60, v60
 v_mfma_f32_16x16x32_bf16 v[80:83], a[224:227], a[72:75], v[80:83]
 v_exp_f32 v61, v61
 v_mfma_f32_16x16x32_bf16 v[80:83], a[228:231], a[88:91], v[80:83]
 v_exp_f32 v62, v62
 v_mfma_f32_16x16x32_bf16 v[72:75], a[224:227], a[68:71], v[72:75]
 v_exp_f32 v63, v63
 v_mfma_f32_16x16x32_bf16 v[72:75], a[228:231], a[84:87], v[72:75]
 v_cvt_pk_bf16_f32 v56, v56, v57
 v_cvt_pk_bf16_f32 v57, v58, v59
 v_mfma_f32_16x16x32_bf16 v[64:67], a[224:227], a[64:67], v[64:67]
 ds_read_b128 a[224:227], v2 offset:31744
 v_cvt_pk_bf16_f32 v58, v60, v61
 v_mfma_f32_16x16x32_bf16 v[64:67], a[228:231], a[80:83], v[64:67]
 s_waitcnt lgkmcnt(2)
 ds_read_b128 a[228:231], v2 offset:32256
 v_cvt_pk_bf16_f32 v59, v62, v63
 v_mfma_f32_16x16x32_bf16 v[68:71], a[232:235], a[64:67], 0
 s_waitcnt lgkmcnt(2)
 v_fma_f32 v80, v80, s22, v18
 v_fma_f32 v81, v81, s22, v18
 v_mfma_f32_16x16x32_bf16 v[68:71], a[236:239], a[80:83], v[68:71]
 v_exp_f32 v80, v80
 v_mfma_f32_16x16x32_bf16 v[76:79], a[232:235], a[68:71], 0
 v_exp_f32 v81, v81
 v_mfma_f32_16x16x32_bf16 v[76:79], a[236:239], a[84:87], v[76:79]
 v_fma_f32 v64, v64, s22, v16
 v_fma_f32 v65, v65, s22, v16
 v_mfma_f32_16x16x32_bf16 v[84:87], a[232:235], a[72:75], 0
 v_exp_f32 v64, v64
 v_mfma_f32_16x16x32_bf16 v[84:87], a[236:239], a[88:91], v[84:87]
 v_exp_f32 v65, v65
 v_mfma_f32_16x16x32_bf16 v[92:95], a[232:235], a[76:79], 0
 buffer_store_dwordx4 a[180:183], v10, s[16:19], s55 offen offset:256 nt
 ds_read_b128 a[232:235], v2 offset:30720
 v_mfma_f32_16x16x32_bf16 v[92:95], a[236:239], a[92:95], v[92:95]
 s_waitcnt lgkmcnt(1)
 ds_read_b128 a[236:239], v2 offset:31232
 v_fma_f32 v66, v66, s22, v16
 v_mfma_f32_16x16x32_bf16 v[92:95], a[224:227], a[44:47], v[92:95]
 v_exp_f32 v66, v66
 v_mfma_f32_16x16x32_bf16 v[92:95], a[228:231], a[60:63], v[92:95]
 v_fma_f32 v67, v67, s22, v16
 v_fma_f32 v72, v72, s22, v17
 v_mfma_f32_16x16x32_bf16 v[84:87], a[224:227], a[40:43], v[84:87]
 buffer_store_dwordx4 a[184:187], v10, s[16:19], s56 offen offset:256 nt
 v_mfma_f32_16x16x32_bf16 v[84:87], a[228:231], a[56:59], v[84:87]
 v_exp_f32 v67, v67
 v_mfma_f32_16x16x32_bf16 v[76:79], a[224:227], a[36:39], v[76:79]
 v_exp_f32 v72, v72
 v_mfma_f32_16x16x32_bf16 v[76:79], a[228:231], a[52:55], v[76:79]
 v_fma_f32 v73, v73, s22, v17
 v_cvt_pk_bf16_f32 v64, v64, v65
 v_mfma_f32_16x16x32_bf16 v[68:71], a[224:227], a[32:35], v[68:71]
 ds_read_b64_tr_b16 a[224:225], v13 offset:24576
 v_fma_f32 v74, v74, s22, v17
 v_mfma_f32_16x16x32_bf16 v[68:71], a[228:231], a[48:51], v[68:71]
 s_waitcnt lgkmcnt(1)
 ds_read_b64_tr_b16 a[226:227], v13 offset:30720
 v_fma_f32 v75, v75, s22, v17
 v_mfma_f32_16x16x32_bf16 v[68:71], a[232:235], a[0:3], v[68:71]
 ds_read_b64_tr_b16 a[228:229], v13 offset:24832
 v_cvt_pk_bf16_f32 v65, v66, v67
 v_mfma_f32_16x16x32_bf16 v[68:71], a[236:239], a[16:19], v[68:71]
 ds_read_b64_tr_b16 a[230:231], v13 offset:30976
 v_fma_f32 v82, v82, s22, v18
 v_mfma_f32_16x16x32_bf16 v[76:79], a[232:235], a[4:7], v[76:79]
 v_exp_f32 v73, v73
 v_mfma_f32_16x16x32_bf16 v[76:79], a[236:239], a[20:23], v[76:79]
 v_exp_f32 v74, v74
 v_mfma_f32_16x16x32_bf16 v[84:87], a[232:235], a[8:11], v[84:87]
 v_exp_f32 v75, v75
 v_mfma_f32_16x16x32_bf16 v[84:87], a[236:239], a[24:27], v[84:87]
 v_exp_f32 v82, v82
 v_mfma_f32_16x16x32_bf16 v[92:95], a[232:235], a[12:15], v[92:95]
 ds_read_b64_tr_b16 a[232:233], v13 offset:25088
 v_fma_f32 v68, v68, s22, v16
 v_mfma_f32_16x16x32_bf16 v[92:95], a[236:239], a[28:31], v[92:95]
 ds_read_b64_tr_b16 a[234:235], v13 offset:31232
 v_fma_f32 v69, v69, s22, v16
 v_mfma_f32_16x16x32_bf16 v[28:31], a[240:243], v[32:35], v[28:31]
 ds_read_b64_tr_b16 a[236:237], v13 offset:25344
 v_fma_f32 v70, v70, s22, v16
 v_mfma_f32_16x16x32_bf16 a[244:247], a[240:243], v[40:43], a[244:247]
 s_waitcnt lgkmcnt(4)
 ds_read_b64_tr_b16 a[238:239], v13 offset:31488
 v_fma_f32 v71, v71, s22, v16
 v_mfma_f32_16x16x32_bf16 v[96:99], v[32:35], a[224:227], v[96:99]
 s_waitcnt vmcnt(20)
 s_barrier
 v_fma_f32 v76, v76, s22, v17
 v_mfma_f32_16x16x32_bf16 v[104:107], v[40:43], a[224:227], v[104:107]
 s_waitcnt lgkmcnt(4)
 v_exp_f32 v68, v68
 v_mfma_f32_16x16x32_bf16 v[100:103], v[32:35], a[228:231], v[100:103]
 v_exp_f32 v69, v69
 v_mfma_f32_16x16x32_bf16 v[108:111], v[40:43], a[228:231], v[108:111]
 v_exp_f32 v70, v70
 v_mfma_f32_16x16x32_bf16 a[192:195], v[48:51], a[224:227], a[192:195]
 v_exp_f32 v71, v71
 v_mfma_f32_16x16x32_bf16 a[200:203], v[56:59], a[224:227], a[200:203]
 ds_read_b64_tr_b16 a[224:225], v3 offset:24576
 v_fma_f32 v77, v77, s22, v17
 v_mfma_f32_16x16x32_bf16 a[196:199], v[48:51], a[228:231], a[196:199]
 ds_read_b64_tr_b16 a[226:227], v3 offset:30720
 v_fma_f32 v78, v78, s22, v17
 v_mfma_f32_16x16x32_bf16 a[204:207], v[56:59], a[228:231], a[204:207]
 ds_read_b64_tr_b16 a[228:229], v3 offset:24832
 v_fma_f32 v79, v79, s22, v17
 v_mfma_f32_16x16x32_bf16 a[248:251], a[240:243], v[48:51], a[248:251]
 ds_read_b64_tr_b16 a[230:231], v3 offset:30976
 v_cvt_pk_bf16_f32 v66, v68, v69
 v_mfma_f32_16x16x32_bf16 a[252:255], a[240:243], v[56:59], a[252:255]
 s_waitcnt lgkmcnt(4)
 v_exp_f32 v76, v76
 v_mfma_f32_16x16x32_bf16 a[208:211], v[48:51], a[232:235], a[208:211]
 s_waitcnt vmcnt(17)
 buffer_store_dwordx4 a[188:191], v10, s[16:19], s57 offen offset:256 nt
 v_mfma_f32_16x16x32_bf16 a[216:219], v[56:59], a[232:235], a[216:219]
 v_exp_f32 v77, v77
 v_mfma_f32_16x16x32_bf16 a[212:215], v[48:51], a[236:239], a[212:215]
 s_add_u32 s16, s16, 25165824
 v_exp_f32 v78, v78
 v_mfma_f32_16x16x32_bf16 a[220:223], v[56:59], a[236:239], a[220:223]
 s_addc_u32 s17, s17, 0
 v_exp_f32 v79, v79
 v_mfma_f32_16x16x32_bf16 v[112:115], v[32:35], a[232:235], v[112:115]
 v_cvt_pk_bf16_f32 v67, v70, v71
 v_cvt_pk_bf16_f32 v72, v72, v73
 v_mfma_f32_16x16x32_bf16 v[120:123], v[40:43], a[232:235], v[120:123]
 ds_read_b64_tr_b16 a[232:233], v3 offset:25088
 v_cvt_pk_bf16_f32 v73, v74, v75
 v_mfma_f32_16x16x32_bf16 v[116:119], v[32:35], a[236:239], v[116:119]
 ds_read_b64_tr_b16 a[234:235], v3 offset:31232
 v_cvt_pk_bf16_f32 v74, v76, v77
 v_mfma_f32_16x16x32_bf16 v[124:127], v[40:43], a[236:239], v[124:127]
 ds_read_b64_tr_b16 a[236:237], v3 offset:25344
 v_cvt_pk_bf16_f32 v75, v78, v79
 v_mfma_f32_16x16x32_bf16 v[28:31], a[240:243], v[64:67], v[28:31]
 ds_read_b64_tr_b16 a[238:239], v3 offset:31488
 v_fma_f32 v83, v83, s22, v18
 v_mfma_f32_16x16x32_bf16 a[244:247], a[240:243], v[72:75], a[244:247]
 s_waitcnt lgkmcnt(4)
 v_exp_f32 v83, v83
 v_mfma_f32_16x16x32_bf16 v[96:99], v[64:67], a[224:227], v[96:99]
 v_fma_f32 v84, v84, s22, v18
 v_fma_f32 v85, v85, s22, v18
 v_mfma_f32_16x16x32_bf16 v[104:107], v[72:75], a[224:227], v[104:107]
 v_fma_f32 v86, v86, s22, v18
 v_fma_f32 v87, v87, s22, v18
 v_mfma_f32_16x16x32_bf16 v[100:103], v[64:67], a[228:231], v[100:103]
 v_exp_f32 v84, v84
 v_exp_f32 v85, v85
 v_exp_f32 v86, v86
 v_exp_f32 v87, v87
 v_fma_f32 v88, v88, s22, v19
 v_fma_f32 v89, v89, s22, v19
 v_cvt_pk_bf16_f32 v80, v80, v81
 v_fma_f32 v90, v90, s22, v19
 v_fma_f32 v91, v91, s22, v19
 v_cvt_pk_bf16_f32 v81, v82, v83
 v_exp_f32 v88, v88
 v_exp_f32 v89, v89
 v_fma_f32 v92, v92, s22, v19
 v_fma_f32 v93, v93, s22, v19
 v_fma_f32 v94, v94, s22, v19
 v_fma_f32 v95, v95, s22, v19
 v_cvt_pk_bf16_f32 v82, v84, v85
 v_cvt_pk_bf16_f32 v83, v86, v87
 v_exp_f32 v90, v90
 v_exp_f32 v91, v91
 v_mfma_f32_16x16x32_bf16 v[108:111], v[72:75], a[228:231], v[108:111]
 v_exp_f32 v92, v92
 v_exp_f32 v93, v93
 v_exp_f32 v94, v94
 v_exp_f32 v95, v95
 v_cvt_pk_bf16_f32 v88, v88, v89
 v_cvt_pk_bf16_f32 v89, v90, v91
 v_cvt_pk_bf16_f32 v90, v92, v93
 v_cvt_pk_bf16_f32 v91, v94, v95
 v_mfma_f32_16x16x32_bf16 a[192:195], v[80:83], a[224:227], a[192:195]
 v_mov_b32 v22, v28
 v_accvgpr_read_b32 v23, a244
 v_mfma_f32_16x16x32_bf16 a[200:203], v[88:91], a[224:227], a[200:203]
 ds_read_b64_tr_b16 a[224:225], v13 offset:25600
 v_add_f32 v0, v22, v23
 v_mfma_f32_16x16x32_bf16 a[196:199], v[80:83], a[228:231], a[196:199]
 ds_read_b64_tr_b16 a[226:227], v13 offset:31744
 v_mfma_f32_16x16x32_bf16 a[204:207], v[88:91], a[228:231], a[204:207]
 v_rcp_f32 v22, v22
 v_mfma_f32_16x16x32_bf16 a[248:251], a[240:243], v[80:83], a[248:251]
 ds_read_b64_tr_b16 a[228:229], v13 offset:25856
 v_mov_b32_dpp v22, v22 row_shl:4 row_mask:0x2 bank_mask:0xf
 v_mfma_f32_16x16x32_bf16 a[252:255], a[240:243], v[88:91], a[252:255]
 s_waitcnt lgkmcnt(3)
 ds_read_b64_tr_b16 a[230:231], v13 offset:32000
 v_mov_b32_dpp v22, v22 row_shl:8 row_mask:0x4 bank_mask:0xf
 v_mfma_f32_16x16x32_bf16 a[208:211], v[80:83], a[232:235], a[208:211]
 v_rcp_f32 v23, v23
 v_mfma_f32_16x16x32_bf16 a[216:219], v[88:91], a[232:235], a[216:219]
 v_mov_b32_dpp v22, v22 row_shl:12 row_mask:0x8 bank_mask:0xf
 v_mov_b32_dpp v23, v23 row_shl:4 row_mask:0x2 bank_mask:0xf
 v_mfma_f32_16x16x32_bf16 a[212:215], v[80:83], a[236:239], a[212:215]
 v_mul_f32_dpp v96, v22, v96 row_newbcast:0 row_mask:0xf bank_mask:0xf
 v_mul_f32_dpp v98, v22, v98 row_newbcast:2 row_mask:0xf bank_mask:0xf
 v_mul_f32_dpp v100, v22, v100 row_newbcast:0 row_mask:0xf bank_mask:0xf
 v_mul_f32_dpp v102, v22, v102 row_newbcast:2 row_mask:0xf bank_mask:0xf
 v_mul_f32_dpp v97, v22, v97 row_newbcast:1 row_mask:0xf bank_mask:0xf
 v_mul_f32_dpp v99, v22, v99 row_newbcast:3 row_mask:0xf bank_mask:0xf
 v_mul_f32_dpp v101, v22, v101 row_newbcast:1 row_mask:0xf bank_mask:0xf
 v_mul_f32_dpp v103, v22, v103 row_newbcast:3 row_mask:0xf bank_mask:0xf
 v_cvt_pk_bf16_f32 v96, v96, v100
 v_cvt_pk_bf16_f32 v98, v98, v102
 v_cvt_pk_bf16_f32 v100, v97, v101
 v_cvt_pk_bf16_f32 v102, v99, v103
 v_mfma_f32_16x16x32_bf16 a[220:223], v[88:91], a[236:239], a[220:223]
 v_mov_b32_dpp v23, v23 row_shl:8 row_mask:0x4 bank_mask:0xf
 v_accvgpr_read_b32 v24, a248
 v_mfma_f32_16x16x32_bf16 v[112:115], v[64:67], a[232:235], v[112:115]
 v_mov_b32_dpp v23, v23 row_shl:12 row_mask:0x8 bank_mask:0xf
 v_add_f32 v0, v0, v24
 v_mfma_f32_16x16x32_bf16 v[120:123], v[72:75], a[232:235], v[120:123]
 ds_read_b64_tr_b16 a[232:233], v13 offset:26112
 v_mul_f32_dpp v104, v23, v104 row_newbcast:0 row_mask:0xf bank_mask:0xf
 v_mfma_f32_16x16x32_bf16 v[116:119], v[64:67], a[236:239], v[116:119]
 ds_read_b64_tr_b16 a[234:235], v13 offset:32256
 v_mul_f32_dpp v106, v23, v106 row_newbcast:2 row_mask:0xf bank_mask:0xf
 v_mfma_f32_16x16x32_bf16 v[124:127], v[72:75], a[236:239], v[124:127]
 s_waitcnt lgkmcnt(2)
 ds_read_b64_tr_b16 a[236:237], v13 offset:26368
 v_mul_f32_dpp v108, v23, v108 row_newbcast:0 row_mask:0xf bank_mask:0xf
 v_mul_f32_dpp v112, v22, v112 row_newbcast:0 row_mask:0xf bank_mask:0xf
 v_mul_f32_dpp v114, v22, v114 row_newbcast:2 row_mask:0xf bank_mask:0xf
 v_mul_f32_dpp v113, v22, v113 row_newbcast:1 row_mask:0xf bank_mask:0xf
 v_mul_f32_dpp v115, v22, v115 row_newbcast:3 row_mask:0xf bank_mask:0xf
 v_mfma_f32_16x16x32_bf16 v[128:131], v[32:35], a[224:227], v[128:131]
 ds_read_b64_tr_b16 a[238:239], v13 offset:32512
 v_mul_f32_dpp v110, v23, v110 row_newbcast:2 row_mask:0xf bank_mask:0xf
 v_mul_f32_dpp v116, v22, v116 row_newbcast:0 row_mask:0xf bank_mask:0xf
 v_mul_f32_dpp v118, v22, v118 row_newbcast:2 row_mask:0xf bank_mask:0xf
 v_cvt_pk_bf16_f32 v97, v112, v116
 v_cvt_pk_bf16_f32 v99, v114, v118
 v_mul_f32_dpp v117, v22, v117 row_newbcast:1 row_mask:0xf bank_mask:0xf
 v_mul_f32_dpp v119, v22, v119 row_newbcast:3 row_mask:0xf bank_mask:0xf
 v_cvt_pk_bf16_f32 v101, v113, v117
 v_cvt_pk_bf16_f32 v103, v115, v119
 v_mul_f32_dpp v105, v23, v105 row_newbcast:1 row_mask:0xf bank_mask:0xf
 v_mul_f32_dpp v107, v23, v107 row_newbcast:3 row_mask:0xf bank_mask:0xf
 v_mul_f32_dpp v109, v23, v109 row_newbcast:1 row_mask:0xf bank_mask:0xf
 v_mul_f32_dpp v111, v23, v111 row_newbcast:3 row_mask:0xf bank_mask:0xf
 v_cvt_pk_bf16_f32 v104, v104, v108
 v_cvt_pk_bf16_f32 v106, v106, v110
 v_cvt_pk_bf16_f32 v108, v105, v109
 v_cvt_pk_bf16_f32 v110, v107, v111
 v_mul_f32_dpp v120, v23, v120 row_newbcast:0 row_mask:0xf bank_mask:0xf
 v_mul_f32_dpp v122, v23, v122 row_newbcast:2 row_mask:0xf bank_mask:0xf
 v_mul_f32_dpp v124, v23, v124 row_newbcast:0 row_mask:0xf bank_mask:0xf
 v_mul_f32_dpp v126, v23, v126 row_newbcast:2 row_mask:0xf bank_mask:0xf
 v_mfma_f32_16x16x32_bf16 v[136:139], v[40:43], a[224:227], v[136:139]
 ds_write_b128 v14, v[96:99] offset:24576
 ds_write_b128 v15, v[100:103] offset:24576
 ds_read_b64_tr_b16 a[96:97], v12 offset:24576
 ds_read_b64_tr_b16 a[98:99], v7 offset:24576
 ds_read_b64_tr_b16 a[100:101], v12 offset:25088
 ds_read_b64_tr_b16 a[102:103], v7 offset:25088
 v_cvt_pk_bf16_f32 v105, v120, v124
 v_cvt_pk_bf16_f32 v107, v122, v126
 v_mfma_f32_16x16x32_bf16 v[132:135], v[32:35], a[228:231], v[132:135]
 ds_write_b128 v14, v[104:107] offset:32768
 v_mul_f32_dpp v121, v23, v121 row_newbcast:1 row_mask:0xf bank_mask:0xf
 v_mul_f32_dpp v123, v23, v123 row_newbcast:3 row_mask:0xf bank_mask:0xf
 v_mul_f32_dpp v125, v23, v125 row_newbcast:1 row_mask:0xf bank_mask:0xf
 v_mul_f32_dpp v127, v23, v127 row_newbcast:3 row_mask:0xf bank_mask:0xf
 v_cvt_pk_bf16_f32 v109, v121, v125
 v_cvt_pk_bf16_f32 v111, v123, v127
 v_mfma_f32_16x16x32_bf16 v[140:143], v[40:43], a[228:231], v[140:143]
 ds_write_b128 v15, v[108:111] offset:32768
 v_rcp_f32 v24, v24
 v_mfma_f32_16x16x32_bf16 v[144:147], v[48:51], a[224:227], v[144:147]
 ds_read_b64_tr_b16 a[104:105], v12 offset:32768
 ds_read_b64_tr_b16 a[106:107], v7 offset:32768
 v_mov_b32_dpp v24, v24 row_shl:4 row_mask:0x2 bank_mask:0xf
 v_mfma_f32_16x16x32_bf16 v[152:155], v[56:59], a[224:227], v[152:155]
 ds_read_b64_tr_b16 a[108:109], v12 offset:33280
 ds_read_b64_tr_b16 a[110:111], v7 offset:33280
 v_mov_b32_dpp v24, v24 row_shl:8 row_mask:0x4 bank_mask:0xf
 v_accvgpr_read_b32 v96, a192
 v_accvgpr_read_b32 v98, a194
 v_mov_b32_dpp v24, v24 row_shl:12 row_mask:0x8 bank_mask:0xf
 v_accvgpr_read_b32 v100, a196
 v_accvgpr_read_b32 v102, a198
 v_accvgpr_read_b32 v97, a193
 v_accvgpr_read_b32 v99, a195
 v_accvgpr_read_b32 v101, a197
 v_accvgpr_read_b32 v103, a199
 v_mfma_f32_16x16x32_bf16 v[148:151], v[48:51], a[228:231], v[148:151]
 s_waitcnt lgkmcnt(5)
 ds_read_b64_tr_b16 a[224:225], v3 offset:25600
 ds_read_b64_tr_b16 a[226:227], v3 offset:31744
 v_accvgpr_read_b32 v112, a208
 v_accvgpr_read_b32 v114, a210
 v_accvgpr_read_b32 v116, a212
 v_accvgpr_read_b32 v118, a214
 v_mul_f32_dpp v96, v24, v96 row_newbcast:0 row_mask:0xf bank_mask:0xf
 v_mul_f32_dpp v98, v24, v98 row_newbcast:2 row_mask:0xf bank_mask:0xf
 v_mul_f32_dpp v100, v24, v100 row_newbcast:0 row_mask:0xf bank_mask:0xf
 v_mul_f32_dpp v102, v24, v102 row_newbcast:2 row_mask:0xf bank_mask:0xf
 v_mul_f32_dpp v97, v24, v97 row_newbcast:1 row_mask:0xf bank_mask:0xf
 v_mul_f32_dpp v99, v24, v99 row_newbcast:3 row_mask:0xf bank_mask:0xf
 v_mul_f32_dpp v101, v24, v101 row_newbcast:1 row_mask:0xf bank_mask:0xf
 v_mul_f32_dpp v103, v24, v103 row_newbcast:3 row_mask:0xf bank_mask:0xf
 v_cvt_pk_bf16_f32 v96, v96, v100
 v_cvt_pk_bf16_f32 v98, v98, v102
 v_cvt_pk_bf16_f32 v100, v97, v101
 v_cvt_pk_bf16_f32 v102, v99, v103
 v_mul_f32_dpp v112, v24, v112 row_newbcast:0 row_mask:0xf bank_mask:0xf
 v_mul_f32_dpp v114, v24, v114 row_newbcast:2 row_mask:0xf bank_mask:0xf
 v_mul_f32_dpp v116, v24, v116 row_newbcast:0 row_mask:0xf bank_mask:0xf
 v_mul_f32_dpp v118, v24, v118 row_newbcast:2 row_mask:0xf bank_mask:0xf
 v_mfma_f32_16x16x32_bf16 v[156:159], v[56:59], a[228:231], v[156:159]
 s_waitcnt lgkmcnt(2)
 buffer_store_dwordx4 a[96:99], v10, s[16:19], s50 offen nt
 v_cvt_pk_bf16_f32 v97, v112, v116
 v_cvt_pk_bf16_f32 v99, v114, v118
 v_accvgpr_read_b32 v113, a209
 v_accvgpr_read_b32 v115, a211
 v_accvgpr_read_b32 v117, a213
 v_accvgpr_read_b32 v119, a215
 v_mfma_f32_16x16x32_bf16 v[176:179], v[48:51], a[232:235], v[176:179]
 ds_write_b128 v14, v[96:99] offset:24576
 buffer_store_dwordx4 a[100:103], v10, s[16:19], s51 offen nt
 ds_read_b64_tr_b16 a[228:229], v3 offset:25856
 ds_read_b64_tr_b16 a[230:231], v3 offset:32000
 v_mul_f32_dpp v113, v24, v113 row_newbcast:1 row_mask:0xf bank_mask:0xf
 v_mul_f32_dpp v115, v24, v115 row_newbcast:3 row_mask:0xf bank_mask:0xf
 v_mul_f32_dpp v117, v24, v117 row_newbcast:1 row_mask:0xf bank_mask:0xf
 v_mul_f32_dpp v119, v24, v119 row_newbcast:3 row_mask:0xf bank_mask:0xf
 v_cvt_pk_bf16_f32 v101, v113, v117
 v_cvt_pk_bf16_f32 v103, v115, v119
 v_accvgpr_read_b32 v25, a252
 v_add_f32 v0, v0, v25
 v_mfma_f32_16x16x32_bf16 v[184:187], v[56:59], a[232:235], v[184:187]
 ds_write_b128 v15, v[100:103] offset:24576
 v_rcp_f32 v25, v25
 v_mfma_f32_16x16x32_bf16 v[180:183], v[48:51], a[236:239], v[180:183]
 ds_read_b64_tr_b16 a[112:113], v12 offset:24576
 ds_read_b64_tr_b16 a[114:115], v7 offset:24576
 v_mov_b32_dpp v25, v25 row_shl:4 row_mask:0x2 bank_mask:0xf
 v_mfma_f32_16x16x32_bf16 v[188:191], v[56:59], a[236:239], v[188:191]
 ds_read_b64_tr_b16 a[116:117], v12 offset:25088
 ds_read_b64_tr_b16 a[118:119], v7 offset:25088
 v_mov_b32_dpp v25, v25 row_shl:8 row_mask:0x4 bank_mask:0xf
 v_accvgpr_read_b32 v104, a200
 v_accvgpr_read_b32 v106, a202
 v_mov_b32_dpp v25, v25 row_shl:12 row_mask:0x8 bank_mask:0xf
 v_accvgpr_read_b32 v108, a204
 v_accvgpr_read_b32 v110, a206
 v_accvgpr_read_b32 v105, a201
 v_accvgpr_read_b32 v107, a203
 v_accvgpr_read_b32 v109, a205
 v_accvgpr_read_b32 v111, a207
 v_mfma_f32_16x16x32_bf16 v[160:163], v[32:35], a[232:235], v[160:163]
 buffer_store_dwordx4 a[104:107], v10, s[16:19], s52 offen nt
 v_accvgpr_read_b32 v120, a216
 v_accvgpr_read_b32 v122, a218
 v_accvgpr_read_b32 v124, a220
 v_accvgpr_read_b32 v126, a222
 v_mul_f32_dpp v104, v25, v104 row_newbcast:0 row_mask:0xf bank_mask:0xf
 v_mul_f32_dpp v106, v25, v106 row_newbcast:2 row_mask:0xf bank_mask:0xf
 v_mul_f32_dpp v108, v25, v108 row_newbcast:0 row_mask:0xf bank_mask:0xf
 v_mul_f32_dpp v110, v25, v110 row_newbcast:2 row_mask:0xf bank_mask:0xf
 v_mul_f32_dpp v105, v25, v105 row_newbcast:1 row_mask:0xf bank_mask:0xf
 v_mul_f32_dpp v107, v25, v107 row_newbcast:3 row_mask:0xf bank_mask:0xf
 v_mul_f32_dpp v109, v25, v109 row_newbcast:1 row_mask:0xf bank_mask:0xf
 v_mul_f32_dpp v111, v25, v111 row_newbcast:3 row_mask:0xf bank_mask:0xf
 v_cvt_pk_bf16_f32 v104, v104, v108
 v_cvt_pk_bf16_f32 v106, v106, v110
 v_cvt_pk_bf16_f32 v108, v105, v109
 v_cvt_pk_bf16_f32 v110, v107, v111
 v_mul_f32_dpp v120, v25, v120 row_newbcast:0 row_mask:0xf bank_mask:0xf
 v_mul_f32_dpp v122, v25, v122 row_newbcast:2 row_mask:0xf bank_mask:0xf
 v_mul_f32_dpp v124, v25, v124 row_newbcast:0 row_mask:0xf bank_mask:0xf
 v_mul_f32_dpp v126, v25, v126 row_newbcast:2 row_mask:0xf bank_mask:0xf
 v_mfma_f32_16x16x32_bf16 v[168:171], v[40:43], a[232:235], v[168:171]
 s_waitcnt lgkmcnt(0)
 buffer_store_dwordx4 a[108:111], v10, s[16:19], s53 offen nt
 v_cvt_pk_bf16_f32 v105, v120, v124
 v_cvt_pk_bf16_f32 v107, v122, v126
 v_accvgpr_read_b32 v121, a217
 v_accvgpr_read_b32 v123, a219
 v_accvgpr_read_b32 v125, a221
 v_accvgpr_read_b32 v127, a223
 v_mfma_f32_16x16x32_bf16 v[164:167], v[32:35], a[236:239], v[164:167]
 ds_write_b128 v14, v[104:107] offset:32768
 ds_read_b64_tr_b16 a[232:233], v3 offset:26112
 ds_read_b64_tr_b16 a[234:235], v3 offset:32256
 v_mul_f32_dpp v121, v25, v121 row_newbcast:1 row_mask:0xf bank_mask:0xf
 v_mul_f32_dpp v123, v25, v123 row_newbcast:3 row_mask:0xf bank_mask:0xf
 v_mul_f32_dpp v125, v25, v125 row_newbcast:1 row_mask:0xf bank_mask:0xf
 v_mul_f32_dpp v127, v25, v127 row_newbcast:3 row_mask:0xf bank_mask:0xf
 v_cvt_pk_bf16_f32 v109, v121, v125
 v_cvt_pk_bf16_f32 v111, v123, v127
 v_mfma_f32_16x16x32_bf16 v[172:175], v[40:43], a[236:239], v[172:175]
 ds_write_b128 v15, v[108:111] offset:32768
 v_mfma_f32_16x16x32_bf16 v[128:131], v[64:67], a[224:227], v[128:131]
 ds_read_b64_tr_b16 a[120:121], v12 offset:32768
 ds_read_b64_tr_b16 a[122:123], v7 offset:32768
 ds_read_b64_tr_b16 a[236:237], v3 offset:26368
 ds_read_b64_tr_b16 a[238:239], v3 offset:32512
 v_mfma_f32_16x16x32_bf16 v[136:139], v[72:75], a[224:227], v[136:139]
 ds_read_b64_tr_b16 a[124:125], v12 offset:33280
 ds_read_b64_tr_b16 a[126:127], v7 offset:33280
 v_mfma_f32_16x16x32_bf16 v[132:135], v[64:67], a[228:231], v[132:135]
 buffer_store_dwordx4 a[112:115], v10, s[16:19], s54 offen nt
 v_mfma_f32_16x16x32_bf16 v[140:143], v[72:75], a[228:231], v[140:143]
 buffer_store_dwordx4 a[116:119], v10, s[16:19], s55 offen nt
 v_mfma_f32_16x16x32_bf16 v[144:147], v[80:83], a[224:227], v[144:147]
 v_mul_f32_dpp v128, v22, v128 row_newbcast:0 row_mask:0xf bank_mask:0xf
 v_mul_f32_dpp v130, v22, v130 row_newbcast:2 row_mask:0xf bank_mask:0xf
 v_mfma_f32_16x16x32_bf16 v[152:155], v[88:91], a[224:227], v[152:155]
 ds_read_b64_tr_b16 a[224:225], v13 offset:26624
 v_mul_f32_dpp v132, v22, v132 row_newbcast:0 row_mask:0xf bank_mask:0xf
 v_mfma_f32_16x16x32_bf16 v[148:151], v[80:83], a[228:231], v[148:151]
 s_waitcnt lgkmcnt(3)
 ds_read_b64_tr_b16 a[226:227], v13 offset:32768
 v_mul_f32_dpp v134, v22, v134 row_newbcast:2 row_mask:0xf bank_mask:0xf
 v_mfma_f32_16x16x32_bf16 v[156:159], v[88:91], a[228:231], v[156:159]
 buffer_store_dwordx4 a[120:123], v10, s[16:19], s56 offen nt
 s_waitcnt lgkmcnt(2)
 v_mfma_f32_16x16x32_bf16 v[176:179], v[80:83], a[232:235], v[176:179]
 ds_read_b64_tr_b16 a[228:229], v13 offset:26880
 ds_read_b64_tr_b16 a[230:231], v13 offset:33024
 v_mfma_f32_16x16x32_bf16 v[184:187], v[88:91], a[232:235], v[184:187]
 buffer_store_dwordx4 a[124:127], v10, s[16:19], s57 offen nt
 v_mfma_f32_16x16x32_bf16 v[180:183], v[80:83], a[236:239], v[180:183]
 v_mul_f32_dpp v129, v22, v129 row_newbcast:1 row_mask:0xf bank_mask:0xf
 v_mul_f32_dpp v131, v22, v131 row_newbcast:3 row_mask:0xf bank_mask:0xf
 v_mul_f32_dpp v133, v22, v133 row_newbcast:1 row_mask:0xf bank_mask:0xf
 v_mul_f32_dpp v135, v22, v135 row_newbcast:3 row_mask:0xf bank_mask:0xf
 v_cvt_pk_bf16_f32 v128, v128, v132
 v_cvt_pk_bf16_f32 v130, v130, v134
 v_cvt_pk_bf16_f32 v132, v129, v133
 v_cvt_pk_bf16_f32 v134, v131, v135
 v_mfma_f32_16x16x32_bf16 v[188:191], v[88:91], a[236:239], v[188:191]
 v_mul_f32_dpp v136, v23, v136 row_newbcast:0 row_mask:0xf bank_mask:0xf
 v_mul_f32_dpp v138, v23, v138 row_newbcast:2 row_mask:0xf bank_mask:0xf
 v_mfma_f32_16x16x32_bf16 v[160:163], v[64:67], a[232:235], v[160:163]
 v_mul_f32_dpp v140, v23, v140 row_newbcast:0 row_mask:0xf bank_mask:0xf
 v_mul_f32_dpp v142, v23, v142 row_newbcast:2 row_mask:0xf bank_mask:0xf
 v_mfma_f32_16x16x32_bf16 v[168:171], v[72:75], a[232:235], v[168:171]
 ds_read_b64_tr_b16 a[232:233], v13 offset:27136
 v_mul_f32_dpp v137, v23, v137 row_newbcast:1 row_mask:0xf bank_mask:0xf
 v_mfma_f32_16x16x32_bf16 v[164:167], v[64:67], a[236:239], v[164:167]
 ds_read_b64_tr_b16 a[234:235], v13 offset:33280
 v_mul_f32_dpp v139, v23, v139 row_newbcast:3 row_mask:0xf bank_mask:0xf
 v_mfma_f32_16x16x32_bf16 v[172:175], v[72:75], a[236:239], v[172:175]
 s_waitcnt lgkmcnt(2)
 ds_read_b64_tr_b16 a[236:237], v13 offset:27392
 v_mul_f32_dpp v141, v23, v141 row_newbcast:1 row_mask:0xf bank_mask:0xf
 v_mul_f32_dpp v160, v22, v160 row_newbcast:0 row_mask:0xf bank_mask:0xf
 v_mul_f32_dpp v162, v22, v162 row_newbcast:2 row_mask:0xf bank_mask:0xf
 v_mul_f32_dpp v161, v22, v161 row_newbcast:1 row_mask:0xf bank_mask:0xf
 v_mul_f32_dpp v163, v22, v163 row_newbcast:3 row_mask:0xf bank_mask:0xf
 v_mfma_f32_16x16x32_bf16 v[192:195], v[32:35], a[224:227], v[192:195]
 ds_read_b64_tr_b16 a[238:239], v13 offset:33536
 v_mul_f32_dpp v143, v23, v143 row_newbcast:3 row_mask:0xf bank_mask:0xf
 v_mul_f32_dpp v164, v22, v164 row_newbcast:0 row_mask:0xf bank_mask:0xf
 v_mul_f32_dpp v166, v22, v166 row_newbcast:2 row_mask:0xf bank_mask:0xf
 v_cvt_pk_bf16_f32 v129, v160, v164
 v_cvt_pk_bf16_f32 v131, v162, v166
 v_mul_f32_dpp v165, v22, v165 row_newbcast:1 row_mask:0xf bank_mask:0xf
 v_mul_f32_dpp v167, v22, v167 row_newbcast:3 row_mask:0xf bank_mask:0xf
 v_cvt_pk_bf16_f32 v133, v161, v165
 v_cvt_pk_bf16_f32 v135, v163, v167
 v_cvt_pk_bf16_f32 v136, v136, v140
 v_cvt_pk_bf16_f32 v138, v138, v142
 v_cvt_pk_bf16_f32 v140, v137, v141
 v_cvt_pk_bf16_f32 v142, v139, v143
 v_mul_f32_dpp v168, v23, v168 row_newbcast:0 row_mask:0xf bank_mask:0xf
 v_mul_f32_dpp v170, v23, v170 row_newbcast:2 row_mask:0xf bank_mask:0xf
 v_mul_f32_dpp v172, v23, v172 row_newbcast:0 row_mask:0xf bank_mask:0xf
 v_mul_f32_dpp v174, v23, v174 row_newbcast:2 row_mask:0xf bank_mask:0xf
 v_mfma_f32_16x16x32_bf16 v[200:203], v[40:43], a[224:227], v[200:203]
 ds_write_b128 v14, v[128:131] offset:24576
 ds_write_b128 v15, v[132:135] offset:24576
 ds_read_b64_tr_b16 a[128:129], v12 offset:24576
 ds_read_b64_tr_b16 a[130:131], v7 offset:24576
 ds_read_b64_tr_b16 a[132:133], v12 offset:25088
 ds_read_b64_tr_b16 a[134:135], v7 offset:25088
 v_cvt_pk_bf16_f32 v137, v168, v172
 v_cvt_pk_bf16_f32 v139, v170, v174
 v_mfma_f32_16x16x32_bf16 v[196:199], v[32:35], a[228:231], v[196:199]
 ds_write_b128 v14, v[136:139] offset:32768
 v_mul_f32_dpp v169, v23, v169 row_newbcast:1 row_mask:0xf bank_mask:0xf
 v_mul_f32_dpp v171, v23, v171 row_newbcast:3 row_mask:0xf bank_mask:0xf
 v_mul_f32_dpp v173, v23, v173 row_newbcast:1 row_mask:0xf bank_mask:0xf
 v_mul_f32_dpp v175, v23, v175 row_newbcast:3 row_mask:0xf bank_mask:0xf
 v_cvt_pk_bf16_f32 v141, v169, v173
 v_cvt_pk_bf16_f32 v143, v171, v175
 v_mfma_f32_16x16x32_bf16 v[204:207], v[40:43], a[228:231], v[204:207]
 ds_write_b128 v15, v[140:143] offset:32768
 v_mfma_f32_16x16x32_bf16 v[208:211], v[48:51], a[224:227], v[208:211]
 ds_read_b64_tr_b16 a[136:137], v12 offset:32768
 ds_read_b64_tr_b16 a[138:139], v7 offset:32768
 v_mfma_f32_16x16x32_bf16 v[216:219], v[56:59], a[224:227], v[216:219]
 ds_read_b64_tr_b16 a[140:141], v12 offset:33280
 ds_read_b64_tr_b16 a[142:143], v7 offset:33280
 v_mfma_f32_16x16x32_bf16 v[212:215], v[48:51], a[228:231], v[212:215]
 s_waitcnt lgkmcnt(6)
 ds_read_b64_tr_b16 a[224:225], v3 offset:26624
 ds_read_b64_tr_b16 a[226:227], v3 offset:32768
 v_mul_f32_dpp v144, v24, v144 row_newbcast:0 row_mask:0xf bank_mask:0xf
 v_mul_f32_dpp v146, v24, v146 row_newbcast:2 row_mask:0xf bank_mask:0xf
 v_mul_f32_dpp v148, v24, v148 row_newbcast:0 row_mask:0xf bank_mask:0xf
 v_mul_f32_dpp v150, v24, v150 row_newbcast:2 row_mask:0xf bank_mask:0xf
 v_mul_f32_dpp v145, v24, v145 row_newbcast:1 row_mask:0xf bank_mask:0xf
 v_mul_f32_dpp v147, v24, v147 row_newbcast:3 row_mask:0xf bank_mask:0xf
 v_mul_f32_dpp v149, v24, v149 row_newbcast:1 row_mask:0xf bank_mask:0xf
 v_mul_f32_dpp v151, v24, v151 row_newbcast:3 row_mask:0xf bank_mask:0xf
 v_cvt_pk_bf16_f32 v144, v144, v148
 v_cvt_pk_bf16_f32 v146, v146, v150
 v_cvt_pk_bf16_f32 v148, v145, v149
 v_cvt_pk_bf16_f32 v150, v147, v151
 v_mul_f32_dpp v176, v24, v176 row_newbcast:0 row_mask:0xf bank_mask:0xf
 v_mul_f32_dpp v178, v24, v178 row_newbcast:2 row_mask:0xf bank_mask:0xf
 v_mul_f32_dpp v180, v24, v180 row_newbcast:0 row_mask:0xf bank_mask:0xf
 v_mul_f32_dpp v182, v24, v182 row_newbcast:2 row_mask:0xf bank_mask:0xf
 v_mfma_f32_16x16x32_bf16 v[220:223], v[56:59], a[228:231], v[220:223]
 buffer_store_dwordx4 a[128:131], v10, s[16:19], s50 offen offset:128 nt
 v_cvt_pk_bf16_f32 v145, v176, v180
 v_cvt_pk_bf16_f32 v147, v178, v182
 v_mfma_f32_16x16x32_bf16 v[240:243], v[48:51], a[232:235], v[240:243]
 s_waitcnt lgkmcnt(2)
 ds_write_b128 v14, v[144:147] offset:24576
 buffer_store_dwordx4 a[132:135], v10, s[16:19], s51 offen offset:128 nt
 ds_read_b64_tr_b16 a[228:229], v3 offset:26880
 ds_read_b64_tr_b16 a[230:231], v3 offset:33024
 v_mul_f32_dpp v177, v24, v177 row_newbcast:1 row_mask:0xf bank_mask:0xf
 v_mul_f32_dpp v179, v24, v179 row_newbcast:3 row_mask:0xf bank_mask:0xf
 v_mul_f32_dpp v181, v24, v181 row_newbcast:1 row_mask:0xf bank_mask:0xf
 v_mul_f32_dpp v183, v24, v183 row_newbcast:3 row_mask:0xf bank_mask:0xf
 v_cvt_pk_bf16_f32 v149, v177, v181
 v_cvt_pk_bf16_f32 v151, v179, v183
 v_mfma_f32_16x16x32_bf16 v[248:251], v[56:59], a[232:235], v[248:251]
 ds_write_b128 v15, v[148:151] offset:24576
 v_mfma_f32_16x16x32_bf16 v[244:247], v[48:51], a[236:239], v[244:247]
 ds_read_b64_tr_b16 a[144:145], v12 offset:24576
 ds_read_b64_tr_b16 a[146:147], v7 offset:24576
 v_mfma_f32_16x16x32_bf16 v[252:255], v[56:59], a[236:239], v[252:255]
 ds_read_b64_tr_b16 a[148:149], v12 offset:25088
 ds_read_b64_tr_b16 a[150:151], v7 offset:25088
 v_mfma_f32_16x16x32_bf16 v[224:227], v[32:35], a[232:235], v[224:227]
 buffer_store_dwordx4 a[136:139], v10, s[16:19], s52 offen offset:128 nt
 v_mul_f32_dpp v152, v25, v152 row_newbcast:0 row_mask:0xf bank_mask:0xf
 v_mul_f32_dpp v154, v25, v154 row_newbcast:2 row_mask:0xf bank_mask:0xf
 v_mul_f32_dpp v156, v25, v156 row_newbcast:0 row_mask:0xf bank_mask:0xf
 v_mul_f32_dpp v158, v25, v158 row_newbcast:2 row_mask:0xf bank_mask:0xf
 v_mul_f32_dpp v153, v25, v153 row_newbcast:1 row_mask:0xf bank_mask:0xf
 v_mul_f32_dpp v155, v25, v155 row_newbcast:3 row_mask:0xf bank_mask:0xf
 v_mul_f32_dpp v157, v25, v157 row_newbcast:1 row_mask:0xf bank_mask:0xf
 v_mul_f32_dpp v159, v25, v159 row_newbcast:3 row_mask:0xf bank_mask:0xf
 v_cvt_pk_bf16_f32 v152, v152, v156
 v_cvt_pk_bf16_f32 v154, v154, v158
 v_cvt_pk_bf16_f32 v156, v153, v157
 v_cvt_pk_bf16_f32 v158, v155, v159
 v_mul_f32_dpp v184, v25, v184 row_newbcast:0 row_mask:0xf bank_mask:0xf
 v_mul_f32_dpp v186, v25, v186 row_newbcast:2 row_mask:0xf bank_mask:0xf
 v_mul_f32_dpp v188, v25, v188 row_newbcast:0 row_mask:0xf bank_mask:0xf
 v_mul_f32_dpp v190, v25, v190 row_newbcast:2 row_mask:0xf bank_mask:0xf
 v_mfma_f32_16x16x32_bf16 v[232:235], v[40:43], a[232:235], v[232:235]
 buffer_store_dwordx4 a[140:143], v10, s[16:19], s53 offen offset:128 nt
 s_waitcnt lgkmcnt(2)
 v_cvt_pk_bf16_f32 v153, v184, v188
 v_cvt_pk_bf16_f32 v155, v186, v190
 v_mfma_f32_16x16x32_bf16 v[228:231], v[32:35], a[236:239], v[228:231]
 s_waitcnt lgkmcnt(0)
 ds_write_b128 v14, v[152:155] offset:32768
 ds_read_b64_tr_b16 a[232:233], v3 offset:27136
 ds_read_b64_tr_b16 a[234:235], v3 offset:33280
 v_mul_f32_dpp v185, v25, v185 row_newbcast:1 row_mask:0xf bank_mask:0xf
 v_mul_f32_dpp v187, v25, v187 row_newbcast:3 row_mask:0xf bank_mask:0xf
 v_mul_f32_dpp v189, v25, v189 row_newbcast:1 row_mask:0xf bank_mask:0xf
 v_mul_f32_dpp v191, v25, v191 row_newbcast:3 row_mask:0xf bank_mask:0xf
 v_cvt_pk_bf16_f32 v157, v185, v189
 v_cvt_pk_bf16_f32 v159, v187, v191
 v_mfma_f32_16x16x32_bf16 v[236:239], v[40:43], a[236:239], v[236:239]
 ds_write_b128 v15, v[156:159] offset:32768
 v_mfma_f32_16x16x32_bf16 v[192:195], v[64:67], a[224:227], v[192:195]
 ds_read_b64_tr_b16 a[152:153], v12 offset:32768
 ds_read_b64_tr_b16 a[154:155], v7 offset:32768
 ds_read_b64_tr_b16 a[236:237], v3 offset:27392
 ds_read_b64_tr_b16 a[238:239], v3 offset:33536
 v_mfma_f32_16x16x32_bf16 v[200:203], v[72:75], a[224:227], v[200:203]
 ds_read_b64_tr_b16 a[156:157], v12 offset:33280
 ds_read_b64_tr_b16 a[158:159], v7 offset:33280
 v_mfma_f32_16x16x32_bf16 v[196:199], v[64:67], a[228:231], v[196:199]
 buffer_store_dwordx4 a[144:147], v10, s[16:19], s54 offen offset:128 nt
 v_mfma_f32_16x16x32_bf16 v[204:207], v[72:75], a[228:231], v[204:207]
 buffer_store_dwordx4 a[148:151], v10, s[16:19], s55 offen offset:128 nt
 v_mfma_f32_16x16x32_bf16 v[208:211], v[80:83], a[224:227], v[208:211]
 v_mul_f32_dpp v192, v22, v192 row_newbcast:0 row_mask:0xf bank_mask:0xf
 v_mul_f32_dpp v194, v22, v194 row_newbcast:2 row_mask:0xf bank_mask:0xf
 v_mfma_f32_16x16x32_bf16 v[216:219], v[88:91], a[224:227], v[216:219]
 s_nop 0
 v_mul_f32_dpp v196, v22, v196 row_newbcast:0 row_mask:0xf bank_mask:0xf
 v_mul_f32_dpp v198, v22, v198 row_newbcast:2 row_mask:0xf bank_mask:0xf
 v_mfma_f32_16x16x32_bf16 v[212:215], v[80:83], a[228:231], v[212:215]
 s_waitcnt lgkmcnt(2)
 buffer_store_dwordx4 a[152:155], v10, s[16:19], s56 offen offset:128 nt
 v_mfma_f32_16x16x32_bf16 v[220:223], v[88:91], a[228:231], v[220:223]
 s_waitcnt lgkmcnt(0)
 buffer_store_dwordx4 a[156:159], v10, s[16:19], s57 offen offset:128 nt
 v_mfma_f32_16x16x32_bf16 v[240:243], v[80:83], a[232:235], v[240:243]
 v_mul_f32_dpp v193, v22, v193 row_newbcast:1 row_mask:0xf bank_mask:0xf
 v_mul_f32_dpp v195, v22, v195 row_newbcast:3 row_mask:0xf bank_mask:0xf
 v_mfma_f32_16x16x32_bf16 v[248:251], v[88:91], a[232:235], v[248:251]
 v_mul_f32_dpp v197, v22, v197 row_newbcast:1 row_mask:0xf bank_mask:0xf
 v_mul_f32_dpp v199, v22, v199 row_newbcast:3 row_mask:0xf bank_mask:0xf
 v_mfma_f32_16x16x32_bf16 v[244:247], v[80:83], a[236:239], v[244:247]
 v_cvt_pk_bf16_f32 v192, v192, v196
 v_cvt_pk_bf16_f32 v194, v194, v198
 v_cvt_pk_bf16_f32 v196, v193, v197
 v_cvt_pk_bf16_f32 v198, v195, v199
 v_mfma_f32_16x16x32_bf16 v[252:255], v[88:91], a[236:239], v[252:255]
 v_cmp_ngt_f32 vcc, s24, v0
 v_mul_f32_dpp v200, v23, v200 row_newbcast:0 row_mask:0xf bank_mask:0xf
 v_mfma_f32_16x16x32_bf16 v[224:227], v[64:67], a[232:235], v[224:227]
 s_cmp_lg_u64 vcc, 0
 v_mul_f32_dpp v202, v23, v202 row_newbcast:2 row_mask:0xf bank_mask:0xf
 v_mul_f32_dpp v204, v23, v204 row_newbcast:0 row_mask:0xf bank_mask:0xf
 v_mfma_f32_16x16x32_bf16 v[232:235], v[72:75], a[232:235], v[232:235]
 s_cselect_b32 s28, s27, 0
 v_mul_f32_dpp v206, v23, v206 row_newbcast:2 row_mask:0xf bank_mask:0xf
 v_mul_f32_dpp v208, v24, v208 row_newbcast:0 row_mask:0xf bank_mask:0xf
 v_mfma_f32_16x16x32_bf16 v[228:231], v[64:67], a[236:239], v[228:231]
 s_or_b32 s26, s26, s28
 v_mul_f32_dpp v210, v24, v210 row_newbcast:2 row_mask:0xf bank_mask:0xf
 v_mul_f32_dpp v212, v24, v212 row_newbcast:0 row_mask:0xf bank_mask:0xf
 v_mul_f32_dpp v214, v24, v214 row_newbcast:2 row_mask:0xf bank_mask:0xf
 v_mul_f32_dpp v216, v25, v216 row_newbcast:0 row_mask:0xf bank_mask:0xf
 v_mul_f32_dpp v218, v25, v218 row_newbcast:2 row_mask:0xf bank_mask:0xf
 v_mul_f32_dpp v220, v25, v220 row_newbcast:0 row_mask:0xf bank_mask:0xf
 v_mul_f32_dpp v224, v22, v224 row_newbcast:0 row_mask:0xf bank_mask:0xf
 v_mul_f32_dpp v226, v22, v226 row_newbcast:2 row_mask:0xf bank_mask:0xf
 v_mul_f32_dpp v225, v22, v225 row_newbcast:1 row_mask:0xf bank_mask:0xf
 v_mul_f32_dpp v227, v22, v227 row_newbcast:3 row_mask:0xf bank_mask:0xf
 v_mul_f32_dpp v222, v25, v222 row_newbcast:2 row_mask:0xf bank_mask:0xf
 v_mfma_f32_16x16x32_bf16 v[236:239], v[72:75], a[236:239], v[236:239]
 s_lshl_b32 s27, s27, 1
 v_mul_f32_dpp v201, v23, v201 row_newbcast:1 row_mask:0xf bank_mask:0xf
 v_mul_f32_dpp v228, v22, v228 row_newbcast:0 row_mask:0xf bank_mask:0xf
 v_mul_f32_dpp v230, v22, v230 row_newbcast:2 row_mask:0xf bank_mask:0xf
 v_cvt_pk_bf16_f32 v193, v224, v228
 v_cvt_pk_bf16_f32 v195, v226, v230
 v_mul_f32_dpp v229, v22, v229 row_newbcast:1 row_mask:0xf bank_mask:0xf
 v_mul_f32_dpp v231, v22, v231 row_newbcast:3 row_mask:0xf bank_mask:0xf
 v_cvt_pk_bf16_f32 v197, v225, v229
 v_cvt_pk_bf16_f32 v199, v227, v231
 v_mul_f32_dpp v203, v23, v203 row_newbcast:3 row_mask:0xf bank_mask:0xf
 v_mul_f32_dpp v205, v23, v205 row_newbcast:1 row_mask:0xf bank_mask:0xf
 v_mul_f32_dpp v207, v23, v207 row_newbcast:3 row_mask:0xf bank_mask:0xf
 v_cvt_pk_bf16_f32 v200, v200, v204
 v_cvt_pk_bf16_f32 v202, v202, v206
 v_mul_f32_dpp v209, v24, v209 row_newbcast:1 row_mask:0xf bank_mask:0xf
 v_mul_f32_dpp v211, v24, v211 row_newbcast:3 row_mask:0xf bank_mask:0xf
 v_mul_f32_dpp v213, v24, v213 row_newbcast:1 row_mask:0xf bank_mask:0xf
 v_mul_f32_dpp v215, v24, v215 row_newbcast:3 row_mask:0xf bank_mask:0xf
 v_cvt_pk_bf16_f32 v208, v208, v212
 v_cvt_pk_bf16_f32 v210, v210, v214
 v_mul_f32_dpp v217, v25, v217 row_newbcast:1 row_mask:0xf bank_mask:0xf
 v_mul_f32_dpp v219, v25, v219 row_newbcast:3 row_mask:0xf bank_mask:0xf
 v_mul_f32_dpp v221, v25, v221 row_newbcast:1 row_mask:0xf bank_mask:0xf
 v_mul_f32_dpp v223, v25, v223 row_newbcast:3 row_mask:0xf bank_mask:0xf
 v_cvt_pk_bf16_f32 v216, v216, v220
 v_cvt_pk_bf16_f32 v218, v218, v222
 v_cvt_pk_bf16_f32 v204, v201, v205
 v_cvt_pk_bf16_f32 v206, v203, v207
 v_mul_f32_dpp v232, v23, v232 row_newbcast:0 row_mask:0xf bank_mask:0xf
 v_mul_f32_dpp v233, v23, v233 row_newbcast:1 row_mask:0xf bank_mask:0xf
 v_mul_f32_dpp v234, v23, v234 row_newbcast:2 row_mask:0xf bank_mask:0xf
 v_mul_f32_dpp v235, v23, v235 row_newbcast:3 row_mask:0xf bank_mask:0xf
 v_mul_f32_dpp v236, v23, v236 row_newbcast:0 row_mask:0xf bank_mask:0xf
 v_mul_f32_dpp v237, v23, v237 row_newbcast:1 row_mask:0xf bank_mask:0xf
 v_mul_f32_dpp v238, v23, v238 row_newbcast:2 row_mask:0xf bank_mask:0xf
 v_mul_f32_dpp v239, v23, v239 row_newbcast:3 row_mask:0xf bank_mask:0xf
 v_cvt_pk_bf16_f32 v212, v209, v213
 v_cvt_pk_bf16_f32 v214, v211, v215
 v_mul_f32_dpp v240, v24, v240 row_newbcast:0 row_mask:0xf bank_mask:0xf
 v_mul_f32_dpp v241, v24, v241 row_newbcast:1 row_mask:0xf bank_mask:0xf
 v_mul_f32_dpp v242, v24, v242 row_newbcast:2 row_mask:0xf bank_mask:0xf
 v_mul_f32_dpp v243, v24, v243 row_newbcast:3 row_mask:0xf bank_mask:0xf
 v_mul_f32_dpp v244, v24, v244 row_newbcast:0 row_mask:0xf bank_mask:0xf
 v_mul_f32_dpp v245, v24, v245 row_newbcast:1 row_mask:0xf bank_mask:0xf
 v_mul_f32_dpp v246, v24, v246 row_newbcast:2 row_mask:0xf bank_mask:0xf
 v_mul_f32_dpp v247, v24, v247 row_newbcast:3 row_mask:0xf bank_mask:0xf
 v_cvt_pk_bf16_f32 v220, v217, v221
 v_cvt_pk_bf16_f32 v222, v219, v223
 v_mul_f32_dpp v248, v25, v248 row_newbcast:0 row_mask:0xf bank_mask:0xf
 v_mul_f32_dpp v249, v25, v249 row_newbcast:1 row_mask:0xf bank_mask:0xf
 v_mul_f32_dpp v250, v25, v250 row_newbcast:2 row_mask:0xf bank_mask:0xf
 v_mul_f32_dpp v251, v25, v251 row_newbcast:3 row_mask:0xf bank_mask:0xf
 v_mul_f32_dpp v252, v25, v252 row_newbcast:0 row_mask:0xf bank_mask:0xf
 v_mul_f32_dpp v253, v25, v253 row_newbcast:1 row_mask:0xf bank_mask:0xf
 v_mul_f32_dpp v254, v25, v254 row_newbcast:2 row_mask:0xf bank_mask:0xf
 v_mul_f32_dpp v255, v25, v255 row_newbcast:3 row_mask:0xf bank_mask:0xf
 v_cvt_pk_bf16_f32 v201, v232, v236
 v_cvt_pk_bf16_f32 v203, v234, v238
 v_cvt_pk_bf16_f32 v205, v233, v237
 v_cvt_pk_bf16_f32 v207, v235, v239
 v_cvt_pk_bf16_f32 v209, v240, v244
 v_cvt_pk_bf16_f32 v211, v242, v246
 v_cvt_pk_bf16_f32 v213, v241, v245
 v_cvt_pk_bf16_f32 v215, v243, v247
 v_cvt_pk_bf16_f32 v217, v248, v252
 v_cvt_pk_bf16_f32 v219, v250, v254
 v_cvt_pk_bf16_f32 v221, v249, v253
 v_cvt_pk_bf16_f32 v223, v251, v255
 ds_write_b128 v14, v[192:195] offset:24576
 ds_write_b128 v15, v[196:199] offset:24576
 ds_read_b64_tr_b16 a[160:161], v12 offset:24576
 ds_read_b64_tr_b16 a[162:163], v7 offset:24576
 ds_read_b64_tr_b16 a[164:165], v12 offset:25088
 ds_read_b64_tr_b16 a[166:167], v7 offset:25088
 ds_write_b128 v14, v[200:203] offset:32768
 ds_write_b128 v15, v[204:207] offset:32768
 ds_read_b64_tr_b16 a[168:169], v12 offset:32768
 ds_read_b64_tr_b16 a[170:171], v7 offset:32768
 ds_read_b64_tr_b16 a[172:173], v12 offset:33280
 ds_read_b64_tr_b16 a[174:175], v7 offset:33280
 ds_write_b128 v14, v[208:211] offset:24576
 ds_write_b128 v15, v[212:215] offset:24576
 ds_read_b64_tr_b16 a[176:177], v12 offset:24576
 ds_read_b64_tr_b16 a[178:179], v7 offset:24576
 ds_read_b64_tr_b16 a[180:181], v12 offset:25088
 ds_read_b64_tr_b16 a[182:183], v7 offset:25088
 ds_write_b128 v14, v[216:219] offset:32768
 s_waitcnt lgkmcnt(12)
 buffer_store_dwordx4 a[160:163], v10, s[16:19], s50 offen offset:256 nt
 buffer_store_dwordx4 a[164:167], v10, s[16:19], s51 offen offset:256 nt
 s_waitcnt lgkmcnt(9)
 buffer_store_dwordx4 a[168:171], v10, s[16:19], s52 offen offset:256 nt
 s_waitcnt lgkmcnt(6)
 buffer_store_dwordx4 a[172:175], v10, s[16:19], s53 offen offset:256 nt
 ds_write_b128 v15, v[220:223] offset:32768
 ds_read_b64_tr_b16 a[184:185], v12 offset:32768
 ds_read_b64_tr_b16 a[186:187], v7 offset:32768
 ds_read_b64_tr_b16 a[188:189], v12 offset:33280
 ds_read_b64_tr_b16 a[190:191], v7 offset:33280
 s_waitcnt lgkmcnt(5)
 buffer_store_dwordx4 a[176:179], v10, s[16:19], s54 offen offset:256 nt
 buffer_store_dwordx4 a[180:183], v10, s[16:19], s55 offen offset:256 nt
 s_waitcnt lgkmcnt(2)
 buffer_store_dwordx4 a[184:187], v10, s[16:19], s56 offen offset:256 nt
 s_waitcnt lgkmcnt(0)
 buffer_store_dwordx4 a[188:191], v10, s[16:19], s57 offen offset:256 nt
 s_cmp_lg_u32 s26, 0
 s_cbranch_scc1 L_fb
L_end:
 s_endpgm
L_codeend:
L_fb:
 s_load_dwordx8 s[36:43], s[0:1], 0
 v_mbcnt_lo_u32_b32 v0, -1, 0
 v_mbcnt_hi_u32_b32 v0, -1, v0
 v_and_b32 v26, 15, v0
 v_lshrrev_b32 v27, 4, v0
 v_mul_u32_u24 v1, 384, v26
 v_lshl_add_u32 v1, v27, 4, v1
 v_add_u32 v2, 6144, v1
 v_mul_u32_u24 v3, 1536, v27
 v_lshrrev_b32 v27, 2, v26
 v_lshl_add_u32 v3, v27, 4, v3
 v_and_b32 v26, 3, v26
 v_lshl_add_u32 v3, v26, 1, v3
 v_add_u32 v4, 6144, v3
 s_waitcnt vmcnt(0) lgkmcnt(0)
L_fb_blk:
 s_bitcmp1_b32 s26, 0
 s_cbranch_scc0 L_fb_next
 s_add_u32 s12, s36, s48
 s_addc_u32 s13, s37, 0
 s_mov_b32 s14, 24576
 s_mov_b32 s15, 0x00020000
 s_add_u32 s4, s38, s47
 s_addc_u32 s5, s39, 0
 s_mov_b32 s6, 196608
 s_mov_b32 s7, 0x00020000
 s_add_u32 s8, s40, s47
 s_addc_u32 s9, s41, 0
 s_mov_b32 s10, 196608
 s_mov_b32 s11, 0x00020000
 s_add_u32 s16, s42, s48
 s_addc_u32 s17, s43, 0
 s_mov_b32 s18, 24576
 s_mov_b32 s19, 0x00020000
 buffer_load_dwordx4 a[0:3], v1, s[12:15], s50 offen
 buffer_load_dwordx4 a[16:19], v1, s[12:15], s50 offen offset:64
 buffer_load_dwordx4 a[32:35], v1, s[12:15], s50 offen offset:128
 buffer_load_dwordx4 a[48:51], v1, s[12:15], s50 offen offset:192
 buffer_load_dwordx4 a[64:67], v1, s[12:15], s50 offen offset:256
 buffer_load_dwordx4 a[80:83], v1, s[12:15], s50 offen offset:320
 buffer_load_dwordx4 a[4:7], v1, s[12:15], s52 offen
 buffer_load_dwordx4 a[20:23], v1, s[12:15], s52 offen offset:64
 buffer_load_dwordx4 a[36:39], v1, s[12:15], s52 offen offset:128
 buffer_load_dwordx4 a[52:55], v1, s[12:15], s52 offen offset:192
 buffer_load_dwordx4 a[68:71], v1, s[12:15], s52 offen offset:256
 buffer_load_dwordx4 a[84:87], v1, s[12:15], s52 offen offset:320
 buffer_load_dwordx4 a[8:11], v1, s[12:15], s54 offen
 buffer_load_dwordx4 a[24:27], v1, s[12:15], s54 offen offset:64
 buffer_load_dwordx4 a[40:43], v1, s[12:15], s54 offen offset:128
 buffer_load_dwordx4 a[56:59], v1, s[12:15], s54 offen offset:192
 buffer_load_dwordx4 a[72:75], v1, s[12:15], s54 offen offset:256
 buffer_load_dwordx4 a[88:91], v1, s[12:15], s54 offen offset:320
 buffer_load_dwordx4 a[12:15], v1, s[12:15], s56 offen
 buffer_load_dwordx4 a[28:31], v1, s[12:15], s56 offen offset:64
 buffer_load_dwordx4 a[44:47], v1, s[12:15], s56 offen offset:128
 buffer_load_dwordx4 a[60:63], v1, s[12:15], s56 offen offset:192
 buffer_load_dwordx4 a[76:79], v1, s[12:15], s56 offen offset:256
 buffer_load_dwordx4 a[92:95], v1, s[12:15], s56 offen offset:320
 v_mov_b32 v16, 0xff800000
 v_mov_b32 v17, 0xff800000
 v_mov_b32 v18, 0xff800000
 v_mov_b32 v19, 0xff800000
 s_mov_b32 s29, 0
L_fb_p1:
 buffer_load_dwordx4 a[96:99], v1, s[4:7], s29 offen
 buffer_load_dwordx4 a[100:103], v1, s[4:7], s29 offen offset:64
 buffer_load_dwordx4 a[104:107], v1, s[4:7], s29 offen offset:128
 buffer_load_dwordx4 a[108:111], v1, s[4:7], s29 offen offset:192
 buffer_load_dwordx4 a[112:115], v1, s[4:7], s29 offen offset:256
 buffer_load_dwordx4 a[116:119], v1, s[4:7], s29 offen offset:320
 buffer_load_dwordx4 a[120:123], v2, s[4:7], s29 offen
 buffer_load_dwordx4 a[124:127], v2, s[4:7], s29 offen offset:64
 buffer_load_dwordx4 a[128:131], v2, s[4:7], s29 offen offset:128
 buffer_load_dwordx4 a[132:135], v2, s[4:7], s29 offen offset:192
 buffer_load_dwordx4 a[136:139], v2, s[4:7], s29 offen offset:256
 buffer_load_dwordx4 a[140:143], v2, s[4:7], s29 offen offset:320
 s_waitcnt vmcnt(0) lgkmcnt(0)
 v_mfma_f32_16x16x32_bf16 v[32:35], a[96:99], a[0:3], 0
 v_mfma_f32_16x16x32_bf16 v[40:43], a[96:99], a[4:7], 0
 v_mfma_f32_16x16x32_bf16 v[48:51], a[96:99], a[8:11], 0
 v_mfma_f32_16x16x32_bf16 v[56:59], a[96:99], a[12:15], 0
 v_mfma_f32_16x16x32_bf16 v[36:39], a[120:123], a[0:3], 0
 v_mfma_f32_16x16x32_bf16 v[44:47], a[120:123], a[4:7], 0
 v_mfma_f32_16x16x32_bf16 v[52:55], a[120:123], a[8:11], 0
 v_mfma_f32_16x16x32_bf16 v[60:63], a[120:123], a[12:15], 0
 v_mfma_f32_16x16x32_bf16 v[32:35], a[100:103], a[16:19], v[32:35]
 v_mfma_f32_16x16x32_bf16 v[40:43], a[100:103], a[20:23], v[40:43]
 v_mfma_f32_16x16x32_bf16 v[48:51], a[100:103], a[24:27], v[48:51]
 v_mfma_f32_16x16x32_bf16 v[56:59], a[100:103], a[28:31], v[56:59]
 v_mfma_f32_16x16x32_bf16 v[36:39], a[124:127], a[16:19], v[36:39]
 v_mfma_f32_16x16x32_bf16 v[44:47], a[124:127], a[20:23], v[44:47]
 v_mfma_f32_16x16x32_bf16 v[52:55], a[124:127], a[24:27], v[52:55]
 v_mfma_f32_16x16x32_bf16 v[60:63], a[124:127], a[28:31], v[60:63]
 v_mfma_f32_16x16x32_bf16 v[32:35], a[104:107], a[32:35], v[32:35]
 v_mfma_f32_16x16x32_bf16 v[40:43], a[104:107], a[36:39], v[40:43]
 v_mfma_f32_16x16x32_bf16 v[48:51], a[104:107], a[40:43], v[48:51]
 v_mfma_f32_16x16x32_bf16 v[56:59], a[104:107], a[44:47], v[56:59]
 v_mfma_f32_16x16x32_bf16 v[36:39], a[128:131], a[32:35], v[36:39]
 v_mfma_f32_16x16x32_bf16 v[44:47], a[128:131], a[36:39], v[44:47]
 v_mfma_f32_16x16x32_bf16 v[52:55], a[128:131], a[40:43], v[52:55]
 v_mfma_f32_16x16x32_bf16 v[60:63], a[128:131], a[44:47], v[60:63]
 v_mfma_f32_16x16x32_bf16 v[32:35], a[108:111], a[48:51], v[32:35]
 v_mfma_f32_16x16x32_bf16 v[40:43], a[108:111], a[52:55], v[40:43]
 v_mfma_f32_16x16x32_bf16 v[48:51], a[108:111], a[56:59], v[48:51]
 v_mfma_f32_16x16x32_bf16 v[56:59], a[108:111], a[60:63], v[56:59]
 v_mfma_f32_16x16x32_bf16 v[36:39], a[132:135], a[48:51], v[36:39]
 v_mfma_f32_16x16x32_bf16 v[44:47], a[132:135], a[52:55], v[44:47]
 v_mfma_f32_16x16x32_bf16 v[52:55], a[132:135], a[56:59], v[52:55]
 v_mfma_f32_16x16x32_bf16 v[60:63], a[132:135], a[60:63], v[60:63]
 v_mfma_f32_16x16x32_bf16 v[32:35], a[112:115], a[64:67], v[32:35]
 v_mfma_f32_16x16x32_bf16 v[40:43], a[112:115], a[68:71], v[40:43]
 v_mfma_f32_16x16x32_bf16 v[48:51], a[112:115], a[72:75], v[48:51]
 v_mfma_f32_16x16x32_bf16 v[56:59], a[112:115], a[76:79], v[56:59]
 v_mfma_f32_16x16x32_bf16 v[36:39], a[136:139], a[64:67], v[36:39]
 v_mfma_f32_16x16x32_bf16 v[44:47], a[136:139], a[68:71], v[44:47]
 v_mfma_f32_16x16x32_bf16 v[52:55], a[136:139], a[72:75], v[52:55]
 v_mfma_f32_16x16x32_bf16 v[60:63], a[136:139], a[76:79], v[60:63]
 v_mfma_f32_16x16x32_bf16 v[32:35], a[116:119], a[80:83], v[32:35]
 v_mfma_f32_16x16x32_bf16 v[40:43], a[116:119], a[84:87], v[40:43]
 v_mfma_f32_16x16x32_bf16 v[48:51], a[116:119], a[88:91], v[48:51]
 v_mfma_f32_16x16x32_bf16 v[56:59], a[116:119], a[92:95], v[56:59]
 v_mfma_f32_16x16x32_bf16 v[36:39], a[140:143], a[80:83], v[36:39]
 v_mfma_f32_16x16x32_bf16 v[44:47], a[140:143], a[84:87], v[44:47]
 v_mfma_f32_16x16x32_bf16 v[52:55], a[140:143], a[88:91], v[52:55]
 v_mfma_f32_16x16x32_bf16 v[60:63], a[140:143], a[92:95], v[60:63]
 s_nop 0
 v_max3_f32 v16, v16, v32, v33
 v_max3_f32 v16, v16, v34, v35
 s_nop 1
 v_max3_f32 v16, v16, v36, v37
 s_nop 0
 v_max3_f32 v16, v16, v38, v39
 v_max3_f32 v17, v17, v40, v41
 v_max3_f32 v17, v17, v42, v43
 v_max3_f32 v17, v17, v44, v45
 v_max3_f32 v17, v17, v46, v47
 v_max3_f32 v18, v18, v48, v49
 v_max3_f32 v18, v18, v50, v51
 v_max3_f32 v18, v18, v52, v53
 v_max3_f32 v18, v18, v54, v55
 v_max3_f32 v19, v19, v56, v57
 v_max3_f32 v19, v19, v58, v59
 v_max3_f32 v19, v19, v60, v61
 v_max3_f32 v19, v19, v62, v63
 s_add_u32 s29, s29, 12288
 s_cmp_lt_u32 s29, 196608
 s_cbranch_scc1 L_fb_p1
 v_mov_b32 v26, v16
 s_nop 1
 v_permlane16_swap_b32 v16, v26
 v_max_f32 v16, v16, v26
 v_mov_b32 v26, v16
 s_nop 1
 v_permlane32_swap_b32 v16, v26
 v_max_f32 v16, v16, v26
 v_mul_f32 v16, s23, v16
 v_mov_b32 v26, v17
 s_nop 1
 v_permlane16_swap_b32 v17, v26
 v_max_f32 v17, v17, v26
 v_mov_b32 v26, v17
 s_nop 1
 v_permlane32_swap_b32 v17, v26
 v_max_f32 v17, v17, v26
 v_mul_f32 v17, s23, v17
 v_mov_b32 v26, v18
 s_nop 1
 v_permlane16_swap_b32 v18, v26
 v_max_f32 v18, v18, v26
 v_mov_b32 v26, v18
 s_nop 1
 v_permlane32_swap_b32 v18, v26
 v_max_f32 v18, v18, v26
 v_mul_f32 v18, s23, v18
 v_mov_b32 v26, v19
 s_nop 1
 v_permlane16_swap_b32 v19, v26
 v_max_f32 v19, v19, v26
 v_mov_b32 v26, v19
 s_nop 1
 v_permlane32_swap_b32 v19, v26
 v_max_f32 v19, v19, v26
 v_mul_f32 v19, s23, v19
 v_mov_b32 v28, 0
 v_mov_b32 v29, 0
 v_mov_b32 v30, 0
 v_mov_b32 v31, 0
 v_accvgpr_write_b32 a244, 0
 v_accvgpr_write_b32 a245, 0
 v_accvgpr_write_b32 a246, 0
 v_accvgpr_write_b32 a247, 0
 v_accvgpr_write_b32 a248, 0
 v_accvgpr_write_b32 a249, 0
 v_accvgpr_write_b32 a250, 0
 v_accvgpr_write_b32 a251, 0
 v_accvgpr_write_b32 a252, 0
 v_accvgpr_write_b32 a253, 0
 v_accvgpr_write_b32 a254, 0
 v_accvgpr_write_b32 a255, 0
 v_mov_b32 v96, 0
 v_mov_b32 v97, 0
 v_mov_b32 v98, 0
 v_mov_b32 v99, 0
 v_mov_b32 v100, 0
 v_mov_b32 v101, 0
 v_mov_b32 v102, 0
 v_mov_b32 v103, 0
 v_mov_b32 v104, 0
 v_mov_b32 v105, 0
 v_mov_b32 v106, 0
 v_mov_b32 v107, 0
 v_mov_b32 v108, 0
 v_mov_b32 v109, 0
 v_mov_b32 v110, 0
 v_mov_b32 v111, 0
 v_accvgpr_write_b32 a192, 0
 v_accvgpr_write_b32 a193, 0
 v_accvgpr_write_b32 a194, 0
 v_accvgpr_write_b32 a195, 0
 v_accvgpr_write_b32 a196, 0
 v_accvgpr_write_b32 a197, 0
 v_accvgpr_write_b32 a198, 0
 v_accvgpr_write_b32 a199, 0
 v_accvgpr_write_b32 a200, 0
 v_accvgpr_write_b32 a201, 0
 v_accvgpr_write_b32 a202, 0
 v_accvgpr_write_b32 a203, 0
 v_accvgpr_write_b32 a204, 0
 v_accvgpr_write_b32 a205, 0
 v_accvgpr_write_b32 a206, 0
 v_accvgpr_write_b32 a207, 0
 v_mov_b32 v112, 0
 v_mov_b32 v113, 0
 v_mov_b32 v114, 0
 v_mov_b32 v115, 0
 v_mov_b32 v116, 0
 v_mov_b32 v117, 0
 v_mov_b32 v118, 0
 v_mov_b32 v119, 0
 v_mov_b32 v120, 0
 v_mov_b32 v121, 0
 v_mov_b32 v122, 0
 v_mov_b32 v123, 0
 v_mov_b32 v124, 0
 v_mov_b32 v125, 0
 v_mov_b32 v126, 0
 v_mov_b32 v127, 0
 v_accvgpr_write_b32 a208, 0
 v_accvgpr_write_b32 a209, 0
 v_accvgpr_write_b32 a210, 0
 v_accvgpr_write_b32 a211, 0
 v_accvgpr_write_b32 a212, 0
 v_accvgpr_write_b32 a213, 0
 v_accvgpr_write_b32 a214, 0
 v_accvgpr_write_b32 a215, 0
 v_accvgpr_write_b32 a216, 0
 v_accvgpr_write_b32 a217, 0
 v_accvgpr_write_b32 a218, 0
 v_accvgpr_write_b32 a219, 0
 v_accvgpr_write_b32 a220, 0
 v_accvgpr_write_b32 a221, 0
 v_accvgpr_write_b32 a222, 0
 v_accvgpr_write_b32 a223, 0
 v_mov_b32 v128, 0
 v_mov_b32 v129, 0
 v_mov_b32 v130, 0
 v_mov_b32 v131, 0
 v_mov_b32 v132, 0
 v_mov_b32 v133, 0
 v_mov_b32 v134, 0
 v_mov_b32 v135, 0
 v_mov_b32 v136, 0
 v_mov_b32 v137, 0
 v_mov_b32 v138, 0
 v_mov_b32 v139, 0
 v_mov_b32 v140, 0
 v_mov_b32 v141, 0
 v_mov_b32 v142, 0
 v_mov_b32 v143, 0
 v_mov_b32 v144, 0
 v_mov_b32 v145, 0
 v_mov_b32 v146, 0
 v_mov_b32 v147, 0
 v_mov_b32 v148, 0
 v_mov_b32 v149, 0
 v_mov_b32 v150, 0
 v_mov_b32 v151, 0
 v_mov_b32 v152, 0
 v_mov_b32 v153, 0
 v_mov_b32 v154, 0
 v_mov_b32 v155, 0
 v_mov_b32 v156, 0
 v_mov_b32 v157, 0
 v_mov_b32 v158, 0
 v_mov_b32 v159, 0
 v_mov_b32 v160, 0
 v_mov_b32 v161, 0
 v_mov_b32 v162, 0
 v_mov_b32 v163, 0
 v_mov_b32 v164, 0
 v_mov_b32 v165, 0
 v_mov_b32 v166, 0
 v_mov_b32 v167, 0
 v_mov_b32 v168, 0
 v_mov_b32 v169, 0
 v_mov_b32 v170, 0
 v_mov_b32 v171, 0
 v_mov_b32 v172, 0
 v_mov_b32 v173, 0
 v_mov_b32 v174, 0
 v_mov_b32 v175, 0
 v_mov_b32 v176, 0
 v_mov_b32 v177, 0
 v_mov_b32 v178, 0
 v_mov_b32 v179, 0
 v_mov_b32 v180, 0
 v_mov_b32 v181, 0
 v_mov_b32 v182, 0
 v_mov_b32 v183, 0
 v_mov_b32 v184, 0
 v_mov_b32 v185, 0
 v_mov_b32 v186, 0
 v_mov_b32 v187, 0
 v_mov_b32 v188, 0
 v_mov_b32 v189, 0
 v_mov_b32 v190, 0
 v_mov_b32 v191, 0
 v_mov_b32 v192, 0
 v_mov_b32 v193, 0
 v_mov_b32 v194, 0
 v_mov_b32 v195, 0
 v_mov_b32 v196, 0
 v_mov_b32 v197, 0
 v_mov_b32 v198, 0
 v_mov_b32 v199, 0
 v_mov_b32 v200, 0
 v_mov_b32 v201, 0
 v_mov_b32 v202, 0
 v_mov_b32 v203, 0
 v_mov_b32 v204, 0
 v_mov_b32 v205, 0
 v_mov_b32 v206, 0
 v_mov_b32 v207, 0
 v_mov_b32 v208, 0
 v_mov_b32 v209, 0
 v_mov_b32 v210, 0
 v_mov_b32 v211, 0
 v_mov_b32 v212, 0
 v_mov_b32 v213, 0
 v_mov_b32 v214, 0
 v_mov_b32 v215, 0
 v_mov_b32 v216, 0
 v_mov_b32 v217, 0
 v_mov_b32 v218, 0
 v_mov_b32 v219, 0
 v_mov_b32 v220, 0
 v_mov_b32 v221, 0
 v_mov_b32 v222, 0
 v_mov_b32 v223, 0
 v_mov_b32 v224, 0
 v_mov_b32 v225, 0
 v_mov_b32 v226, 0
 v_mov_b32 v227, 0
 v_mov_b32 v228, 0
 v_mov_b32 v229, 0
 v_mov_b32 v230, 0
 v_mov_b32 v231, 0
 v_mov_b32 v232, 0
 v_mov_b32 v233, 0
 v_mov_b32 v234, 0
 v_mov_b32 v235, 0
 v_mov_b32 v236, 0
 v_mov_b32 v237, 0
 v_mov_b32 v238, 0
 v_mov_b32 v239, 0
 v_mov_b32 v240, 0
 v_mov_b32 v241, 0
 v_mov_b32 v242, 0
 v_mov_b32 v243, 0
 v_mov_b32 v244, 0
 v_mov_b32 v245, 0
 v_mov_b32 v246, 0
 v_mov_b32 v247, 0
 v_mov_b32 v248, 0
 v_mov_b32 v249, 0
 v_mov_b32 v250, 0
 v_mov_b32 v251, 0
 v_mov_b32 v252, 0
 v_mov_b32 v253, 0
 v_mov_b32 v254, 0
 v_mov_b32 v255, 0
 s_mov_b32 s29, 0
L_fb_p2:
 buffer_load_dwordx4 a[96:99], v1, s[4:7], s29 offen
 buffer_load_dwordx4 a[100:103], v1, s[4:7], s29 offen offset:64
 buffer_load_dwordx4 a[104:107], v1, s[4:7], s29 offen offset:128
 buffer_load_dwordx4 a[108:111], v1, s[4:7], s29 offen offset:192
 buffer_load_dwordx4 a[112:115], v1, s[4:7], s29 offen offset:256
 buffer_load_dwordx4 a[116:119], v1, s[4:7], s29 offen offset:320
 buffer_load_dwordx4 a[120:123], v2, s[4:7], s29 offen
 buffer_load_dwordx4 a[124:127], v2, s[4:7], s29 offen offset:64
 buffer_load_dwordx4 a[128:131], v2, s[4:7], s29 offen offset:128
 buffer_load_dwordx4 a[132:135], v2, s[4:7], s29 offen offset:192
 buffer_load_dwordx4 a[136:139], v2, s[4:7], s29 offen offset:256
 buffer_load_dwordx4 a[140:143], v2, s[4:7], s29 offen offset:320
 s_waitcnt vmcnt(0) lgkmcnt(0)
 v_mfma_f32_16x16x32_bf16 v[32:35], a[96:99], a[0:3], 0
 v_mfma_f32_16x16x32_bf16 v[40:43], a[96:99], a[4:7], 0
 v_mfma_f32_16x16x32_bf16 v[48:51], a[96:99], a[8:11], 0
 v_mfma_f32_16x16x32_bf16 v[56:59], a[96:99], a[12:15], 0
 v_mfma_f32_16x16x32_bf16 v[36:39], a[120:123], a[0:3], 0
 v_mfma_f32_16x16x32_bf16 v[44:47], a[120:123], a[4:7], 0
 v_mfma_f32_16x16x32_bf16 v[52:55], a[120:123], a[8:11], 0
 v_mfma_f32_16x16x32_bf16 v[60:63], a[120:123], a[12:15], 0
 v_mfma_f32_16x16x32_bf16 v[32:35], a[100:103], a[16:19], v[32:35]
 v_mfma_f32_16x16x32_bf16 v[40:43], a[100:103], a[20:23], v[40:43]
 v_mfma_f32_16x16x32_bf16 v[48:51], a[100:103], a[24:27], v[48:51]
 v_mfma_f32_16x16x32_bf16 v[56:59], a[100:103], a[28:31], v[56:59]
 v_mfma_f32_16x16x32_bf16 v[36:39], a[124:127], a[16:19], v[36:39]
 v_mfma_f32_16x16x32_bf16 v[44:47], a[124:127], a[20:23], v[44:47]
 v_mfma_f32_16x16x32_bf16 v[52:55], a[124:127], a[24:27], v[52:55]
 v_mfma_f32_16x16x32_bf16 v[60:63], a[124:127], a[28:31], v[60:63]
 v_mfma_f32_16x16x32_bf16 v[32:35], a[104:107], a[32:35], v[32:35]
 v_mfma_f32_16x16x32_bf16 v[40:43], a[104:107], a[36:39], v[40:43]
 v_mfma_f32_16x16x32_bf16 v[48:51], a[104:107], a[40:43], v[48:51]
 v_mfma_f32_16x16x32_bf16 v[56:59], a[104:107], a[44:47], v[56:59]
 v_mfma_f32_16x16x32_bf16 v[36:39], a[128:131], a[32:35], v[36:39]
 v_mfma_f32_16x16x32_bf16 v[44:47], a[128:131], a[36:39], v[44:47]
 v_mfma_f32_16x16x32_bf16 v[52:55], a[128:131], a[40:43], v[52:55]
 v_mfma_f32_16x16x32_bf16 v[60:63], a[128:131], a[44:47], v[60:63]
 v_mfma_f32_16x16x32_bf16 v[32:35], a[108:111], a[48:51], v[32:35]
 v_mfma_f32_16x16x32_bf16 v[40:43], a[108:111], a[52:55], v[40:43]
 v_mfma_f32_16x16x32_bf16 v[48:51], a[108:111], a[56:59], v[48:51]
 v_mfma_f32_16x16x32_bf16 v[56:59], a[108:111], a[60:63], v[56:59]
 v_mfma_f32_16x16x32_bf16 v[36:39], a[132:135], a[48:51], v[36:39]
 v_mfma_f32_16x16x32_bf16 v[44:47], a[132:135], a[52:55], v[44:47]
 v_mfma_f32_16x16x32_bf16 v[52:55], a[132:135], a[56:59], v[52:55]
 v_mfma_f32_16x16x32_bf16 v[60:63], a[132:135], a[60:63], v[60:63]
 v_mfma_f32_16x16x32_bf16 v[32:35], a[112:115], a[64:67], v[32:35]
 v_mfma_f32_16x16x32_bf16 v[40:43], a[112:115], a[68:71], v[40:43]
 v_mfma_f32_16x16x32_bf16 v[48:51], a[112:115], a[72:75], v[48:51]
 v_mfma_f32_16x16x32_bf16 v[56:59], a[112:115], a[76:79], v[56:59]
 v_mfma_f32_16x16x32_bf16 v[36:39], a[136:139], a[64:67], v[36:39]
 v_mfma_f32_16x16x32_bf16 v[44:47], a[136:139], a[68:71], v[44:47]
 v_mfma_f32_16x16x32_bf16 v[52:55], a[136:139], a[72:75], v[52:55]
 v_mfma_f32_16x16x32_bf16 v[60:63], a[136:139], a[76:79], v[60:63]
 v_mfma_f32_16x16x32_bf16 v[32:35], a[116:119], a[80:83], v[32:35]
 v_mfma_f32_16x16x32_bf16 v[40:43], a[116:119], a[84:87], v[40:43]
 v_mfma_f32_16x16x32_bf16 v[48:51], a[116:119], a[88:91], v[48:51]
 v_mfma_f32_16x16x32_bf16 v[56:59], a[116:119], a[92:95], v[56:59]
 v_mfma_f32_16x16x32_bf16 v[36:39], a[140:143], a[80:83], v[36:39]
 v_mfma_f32_16x16x32_bf16 v[44:47], a[140:143], a[84:87], v[44:47]
 v_mfma_f32_16x16x32_bf16 v[52:55], a[140:143], a[88:91], v[52:55]
 v_mfma_f32_16x16x32_bf16 v[60:63], a[140:143], a[92:95], v[60:63]
 s_nop 0
 v_fma_f32 v32, v32, s22, v16
 v_fma_f32 v33, v33, s22, v16
 v_fma_f32 v34, v34, s22, v16
 v_fma_f32 v35, v35, s22, v16
 s_nop 0
 v_fma_f32 v36, v36, s22, v16
 v_fma_f32 v37, v37, s22, v16
 v_fma_f32 v38, v38, s22, v16
 v_fma_f32 v39, v39, s22, v16
 v_fma_f32 v40, v40, s22, v17
 v_fma_f32 v41, v41, s22, v17
 v_fma_f32 v42, v42, s22, v17
 v_fma_f32 v43, v43, s22, v17
 v_fma_f32 v44, v44, s22, v17
 v_fma_f32 v45, v45, s22, v17
 v_fma_f32 v46, v46, s22, v17
 v_fma_f32 v47, v47, s22, v17
 v_fma_f32 v48, v48, s22, v18
 v_fma_f32 v49, v49, s22, v18
 v_fma_f32 v50, v50, s22, v18
 v_fma_f32 v51, v51, s22, v18
 v_fma_f32 v52, v52, s22, v18
 v_fma_f32 v53, v53, s22, v18
 v_fma_f32 v54, v54, s22, v18
 v_fma_f32 v55, v55, s22, v18
 v_fma_f32 v56, v56, s22, v19
 v_fma_f32 v57, v57, s22, v19
 v_fma_f32 v58, v58, s22, v19
 v_fma_f32 v59, v59, s22, v19
 v_fma_f32 v60, v60, s22, v19
 v_fma_f32 v61, v61, s22, v19
 v_fma_f32 v62, v62, s22, v19
 v_fma_f32 v63, v63, s22, v19
 v_exp_f32 v32, v32
 v_exp_f32 v33, v33
 v_exp_f32 v34, v34
 v_exp_f32 v35, v35
 v_exp_f32 v36, v36
 v_exp_f32 v37, v37
 v_exp_f32 v38, v38
 v_exp_f32 v39, v39
 v_cvt_pk_bf16_f32 v32, v32, v33
 v_cvt_pk_bf16_f32 v33, v34, v35
 v_cvt_pk_bf16_f32 v34, v36, v37
 v_cvt_pk_bf16_f32 v35, v38, v39
 v_exp_f32 v40, v40
 v_exp_f32 v41, v41
 v_exp_f32 v42, v42
 v_exp_f32 v43, v43
 v_exp_f32 v44, v44
 v_exp_f32 v45, v45
 v_exp_f32 v46, v46
 v_exp_f32 v47, v47
 v_cvt_pk_bf16_f32 v40, v40, v41
 v_cvt_pk_bf16_f32 v41, v42, v43
 v_cvt_pk_bf16_f32 v42, v44, v45
 v_cvt_pk_bf16_f32 v43, v46, v47
 v_exp_f32 v48, v48
 v_exp_f32 v49, v49
 v_exp_f32 v50, v50
 v_exp_f32 v51, v51
 v_exp_f32 v52, v52
 v_exp_f32 v53, v53
 v_exp_f32 v54, v54
 v_exp_f32 v55, v55
 v_cvt_pk_bf16_f32 v48, v48, v49
 v_cvt_pk_bf16_f32 v49, v50, v51
 v_cvt_pk_bf16_f32 v50, v52, v53
 v_cvt_pk_bf16_f32 v51, v54, v55
 v_exp_f32 v56, v56
 v_exp_f32 v57, v57
 v_exp_f32 v58, v58
 v_exp_f32 v59, v59
 v_exp_f32 v60, v60
 v_exp_f32 v61, v61
 v_exp_f32 v62, v62
 v_exp_f32 v63, v63
 v_cvt_pk_bf16_f32 v56, v56, v57
 v_cvt_pk_bf16_f32 v57, v58, v59
 v_cvt_pk_bf16_f32 v58, v60, v61
 v_cvt_pk_bf16_f32 v59, v62, v63
 v_mfma_f32_16x16x32_bf16 v[28:31], a[240:243], v[32:35], v[28:31]
 v_mfma_f32_16x16x32_bf16 a[244:247], a[240:243], v[40:43], a[244:247]
 v_mfma_f32_16x16x32_bf16 a[248:251], a[240:243], v[48:51], a[248:251]
 v_mfma_f32_16x16x32_bf16 a[252:255], a[240:243], v[56:59], a[252:255]
 buffer_load_ushort v64, v3, s[8:11], s29 offen offset:0
 buffer_load_ushort v68, v3, s[8:11], s29 offen offset:384
 buffer_load_ushort v65, v3, s[8:11], s29 offen offset:768
 buffer_load_ushort v69, v3, s[8:11], s29 offen offset:1152
 buffer_load_ushort v66, v4, s[8:11], s29 offen offset:0
 buffer_load_ushort v70, v4, s[8:11], s29 offen offset:384
 buffer_load_ushort v67, v4, s[8:11], s29 offen offset:768
 buffer_load_ushort v71, v4, s[8:11], s29 offen offset:1152
 buffer_load_ushort v72, v3, s[8:11], s29 offen offset:8
 buffer_load_ushort v76, v3, s[8:11], s29 offen offset:392
 buffer_load_ushort v73, v3, s[8:11], s29 offen offset:776
 buffer_load_ushort v77, v3, s[8:11], s29 offen offset:1160
 buffer_load_ushort v74, v4, s[8:11], s29 offen offset:8
 buffer_load_ushort v78, v4, s[8:11], s29 offen offset:392
 buffer_load_ushort v75, v4, s[8:11], s29 offen offset:776
 buffer_load_ushort v79, v4, s[8:11], s29 offen offset:1160
 buffer_load_ushort v80, v3, s[8:11], s29 offen offset:64
 buffer_load_ushort v84, v3, s[8:11], s29 offen offset:448
 buffer_load_ushort v81, v3, s[8:11], s29 offen offset:832
 buffer_load_ushort v85, v3, s[8:11], s29 offen offset:1216
 buffer_load_ushort v82, v4, s[8:11], s29 offen offset:64
 buffer_load_ushort v86, v4, s[8:11], s29 offen offset:448
 buffer_load_ushort v83, v4, s[8:11], s29 offen offset:832
 buffer_load_ushort v87, v4, s[8:11], s29 offen offset:1216
 buffer_load_ushort v88, v3, s[8:11], s29 offen offset:72
 buffer_load_ushort v92, v3, s[8:11], s29 offen offset:456
 buffer_load_ushort v89, v3, s[8:11], s29 offen offset:840
 buffer_load_ushort v93, v3, s[8:11], s29 offen offset:1224
 buffer_load_ushort v90, v4, s[8:11], s29 offen offset:72
 buffer_load_ushort v94, v4, s[8:11], s29 offen offset:456
 buffer_load_ushort v91, v4, s[8:11], s29 offen offset:840
 buffer_load_ushort v95, v4, s[8:11], s29 offen offset:1224
 s_waitcnt vmcnt(0) lgkmcnt(0)
 v_lshl_or_b32 v64, v68, 16, v64
 v_lshl_or_b32 v65, v69, 16, v65
 v_lshl_or_b32 v66, v70, 16, v66
 v_lshl_or_b32 v67, v71, 16, v67
 v_lshl_or_b32 v72, v76, 16, v72
 v_lshl_or_b32 v73, v77, 16, v73
 v_lshl_or_b32 v74, v78, 16, v74
 v_lshl_or_b32 v75, v79, 16, v75
 v_lshl_or_b32 v80, v84, 16, v80
 v_lshl_or_b32 v81, v85, 16, v81
 v_lshl_or_b32 v82, v86, 16, v82
 v_lshl_or_b32 v83, v87, 16, v83
 v_lshl_or_b32 v88, v92, 16, v88
 v_lshl_or_b32 v89, v93, 16, v89
 v_lshl_or_b32 v90, v94, 16, v90
 v_lshl_or_b32 v91, v95, 16, v91
 v_mfma_f32_16x16x32_bf16 v[96:99], v[64:67], v[32:35], v[96:99]
 v_mfma_f32_16x16x32_bf16 v[104:107], v[64:67], v[40:43], v[104:107]
 v_mfma_f32_16x16x32_bf16 a[192:195], v[64:67], v[48:51], a[192:195]
 v_mfma_f32_16x16x32_bf16 a[200:203], v[64:67], v[56:59], a[200:203]
 v_mfma_f32_16x16x32_bf16 v[100:103], v[72:75], v[32:35], v[100:103]
 v_mfma_f32_16x16x32_bf16 v[108:111], v[72:75], v[40:43], v[108:111]
 v_mfma_f32_16x16x32_bf16 a[196:199], v[72:75], v[48:51], a[196:199]
 v_mfma_f32_16x16x32_bf16 a[204:207], v[72:75], v[56:59], a[204:207]
 v_mfma_f32_16x16x32_bf16 v[112:115], v[80:83], v[32:35], v[112:115]
 v_mfma_f32_16x16x32_bf16 v[120:123], v[80:83], v[40:43], v[120:123]
 v_mfma_f32_16x16x32_bf16 a[208:211], v[80:83], v[48:51], a[208:211]
 v_mfma_f32_16x16x32_bf16 a[216:219], v[80:83], v[56:59], a[216:219]
 v_mfma_f32_16x16x32_bf16 v[116:119], v[88:91], v[32:35], v[116:119]
 v_mfma_f32_16x16x32_bf16 v[124:127], v[88:91], v[40:43], v[124:127]
 v_mfma_f32_16x16x32_bf16 a[212:215], v[88:91], v[48:51], a[212:215]
 v_mfma_f32_16x16x32_bf16 a[220:223], v[88:91], v[56:59], a[220:223]
 buffer_load_ushort v64, v3, s[8:11], s29 offen offset:128
 buffer_load_ushort v68, v3, s[8:11], s29 offen offset:512
 buffer_load_ushort v65, v3, s[8:11], s29 offen offset:896
 buffer_load_ushort v69, v3, s[8:11], s29 offen offset:1280
 buffer_load_ushort v66, v4, s[8:11], s29 offen offset:128
 buffer_load_ushort v70, v4, s[8:11], s29 offen offset:512
 buffer_load_ushort v67, v4, s[8:11], s29 offen offset:896
 buffer_load_ushort v71, v4, s[8:11], s29 offen offset:1280
 buffer_load_ushort v72, v3, s[8:11], s29 offen offset:136
 buffer_load_ushort v76, v3, s[8:11], s29 offen offset:520
 buffer_load_ushort v73, v3, s[8:11], s29 offen offset:904
 buffer_load_ushort v77, v3, s[8:11], s29 offen offset:1288
 buffer_load_ushort v74, v4, s[8:11], s29 offen offset:136
 buffer_load_ushort v78, v4, s[8:11], s29 offen offset:520
 buffer_load_ushort v75, v4, s[8:11], s29 offen offset:904
 buffer_load_ushort v79, v4, s[8:11], s29 offen offset:1288
 buffer_load_ushort v80, v3, s[8:11], s29 offen offset:192
 buffer_load_ushort v84, v3, s[8:11], s29 offen offset:576
 buffer_load_ushort v81, v3, s[8:11], s29 offen offset:960
 buffer_load_ushort v85, v3, s[8:11], s29 offen offset:1344
 buffer_load_ushort v82, v4, s[8:11], s29 offen offset:192
 buffer_load_ushort v86, v4, s[8:11], s29 offen offset:576
 buffer_load_ushort v83, v4, s[8:11], s29 offen offset:960
 buffer_load_ushort v87, v4, s[8:11], s29 offen offset:1344
 buffer_load_ushort v88, v3, s[8:11], s29 offen offset:200
 buffer_load_ushort v92, v3, s[8:11], s29 offen offset:584
 buffer_load_ushort v89, v3, s[8:11], s29 offen offset:968
 buffer_load_ushort v93, v3, s[8:11], s29 offen offset:1352
 buffer_load_ushort v90, v4, s[8:11], s29 offen offset:200
 buffer_load_ushort v94, v4, s[8:11], s29 offen offset:584
 buffer_load_ushort v91, v4, s[8:11], s29 offen offset:968
 buffer_load_ushort v95, v4, s[8:11], s29 offen offset:1352
 s_waitcnt vmcnt(0) lgkmcnt(0)
 v_lshl_or_b32 v64, v68, 16, v64
 v_lshl_or_b32 v65, v69, 16, v65
 v_lshl_or_b32 v66, v70, 16, v66
 v_lshl_or_b32 v67, v71, 16, v67
 v_lshl_or_b32 v72, v76, 16, v72
 v_lshl_or_b32 v73, v77, 16, v73
 v_lshl_or_b32 v74, v78, 16, v74
 v_lshl_or_b32 v75, v79, 16, v75
 v_lshl_or_b32 v80, v84, 16, v80
 v_lshl_or_b32 v81, v85, 16, v81
 v_lshl_or_b32 v82, v86, 16, v82
 v_lshl_or_b32 v83, v87, 16, v83
 v_lshl_or_b32 v88, v92, 16, v88
 v_lshl_or_b32 v89, v93, 16, v89
 v_lshl_or_b32 v90, v94, 16, v90
 v_lshl_or_b32 v91, v95, 16, v91
 v_mfma_f32_16x16x32_bf16 v[128:131], v[64:67], v[32:35], v[128:131]
 v_mfma_f32_16x16x32_bf16 v[136:139], v[64:67], v[40:43], v[136:139]
 v_mfma_f32_16x16x32_bf16 v[144:147], v[64:67], v[48:51], v[144:147]
 v_mfma_f32_16x16x32_bf16 v[152:155], v[64:67], v[56:59], v[152:155]
 v_mfma_f32_16x16x32_bf16 v[132:135], v[72:75], v[32:35], v[132:135]
 v_mfma_f32_16x16x32_bf16 v[140:143], v[72:75], v[40:43], v[140:143]
 v_mfma_f32_16x16x32_bf16 v[148:151], v[72:75], v[48:51], v[148:151]
 v_mfma_f32_16x16x32_bf16 v[156:159], v[72:75], v[56:59], v[156:159]
 v_mfma_f32_16x16x32_bf16 v[160:163], v[80:83], v[32:35], v[160:163]
 v_mfma_f32_16x16x32_bf16 v[168:171], v[80:83], v[40:43], v[168:171]
 v_mfma_f32_16x16x32_bf16 v[176:179], v[80:83], v[48:51], v[176:179]
 v_mfma_f32_16x16x32_bf16 v[184:187], v[80:83], v[56:59], v[184:187]
 v_mfma_f32_16x16x32_bf16 v[164:167], v[88:91], v[32:35], v[164:167]
 v_mfma_f32_16x16x32_bf16 v[172:175], v[88:91], v[40:43], v[172:175]
 v_mfma_f32_16x16x32_bf16 v[180:183], v[88:91], v[48:51], v[180:183]
 v_mfma_f32_16x16x32_bf16 v[188:191], v[88:91], v[56:59], v[188:191]
 buffer_load_ushort v64, v3, s[8:11], s29 offen offset:256
 buffer_load_ushort v68, v3, s[8:11], s29 offen offset:640
 buffer_load_ushort v65, v3, s[8:11], s29 offen offset:1024
 buffer_load_ushort v69, v3, s[8:11], s29 offen offset:1408
 buffer_load_ushort v66, v4, s[8:11], s29 offen offset:256
 buffer_load_ushort v70, v4, s[8:11], s29 offen offset:640
 buffer_load_ushort v67, v4, s[8:11], s29 offen offset:1024
 buffer_load_ushort v71, v4, s[8:11], s29 offen offset:1408
 buffer_load_ushort v72, v3, s[8:11], s29 offen offset:264
 buffer_load_ushort v76, v3, s[8:11], s29 offen offset:648
 buffer_load_ushort v73, v3, s[8:11], s29 offen offset:1032
 buffer_load_ushort v77, v3, s[8:11], s29 offen offset:1416
 buffer_load_ushort v74, v4, s[8:11], s29 offen offset:264
 buffer_load_ushort v78, v4, s[8:11], s29 offen offset:648
 buffer_load_ushort v75, v4, s[8:11], s29 offen offset:1032
 buffer_load_ushort v79, v4, s[8:11], s29 offen offset:1416
 buffer_load_ushort v80, v3, s[8:11], s29 offen offset:320
 buffer_load_ushort v84, v3, s[8:11], s29 offen offset:704
 buffer_load_ushort v81, v3, s[8:11], s29 offen offset:1088
 buffer_load_ushort v85, v3, s[8:11], s29 offen offset:1472
 buffer_load_ushort v82, v4, s[8:11], s29 offen offset:320
 buffer_load_ushort v86, v4, s[8:11], s29 offen offset:704
 buffer_load_ushort v83, v4, s[8:11], s29 offen offset:1088
 buffer_load_ushort v87, v4, s[8:11], s29 offen offset:1472
 buffer_load_ushort v88, v3, s[8:11], s29 offen offset:328
 buffer_load_ushort v92, v3, s[8:11], s29 offen offset:712
 buffer_load_ushort v89, v3, s[8:11], s29 offen offset:1096
 buffer_load_ushort v93, v3, s[8:11], s29 offen offset:1480
 buffer_load_ushort v90, v4, s[8:11], s29 offen offset:328
 buffer_load_ushort v94, v4, s[8:11], s29 offen offset:712
 buffer_load_ushort v91, v4, s[8:11], s29 offen offset:1096
 buffer_load_ushort v95, v4, s[8:11], s29 offen offset:1480
 s_waitcnt vmcnt(0) lgkmcnt(0)
 v_lshl_or_b32 v64, v68, 16, v64
 v_lshl_or_b32 v65, v69, 16, v65
 v_lshl_or_b32 v66, v70, 16, v66
 v_lshl_or_b32 v67, v71, 16, v67
 v_lshl_or_b32 v72, v76, 16, v72
 v_lshl_or_b32 v73, v77, 16, v73
 v_lshl_or_b32 v74, v78, 16, v74
 v_lshl_or_b32 v75, v79, 16, v75
 v_lshl_or_b32 v80, v84, 16, v80
 v_lshl_or_b32 v81, v85, 16, v81
 v_lshl_or_b32 v82, v86, 16, v82
 v_lshl_or_b32 v83, v87, 16, v83
 v_lshl_or_b32 v88, v92, 16, v88
 v_lshl_or_b32 v89, v93, 16, v89
 v_lshl_or_b32 v90, v94, 16, v90
 v_lshl_or_b32 v91, v95, 16, v91
 v_mfma_f32_16x16x32_bf16 v[192:195], v[64:67], v[32:35], v[192:195]
 v_mfma_f32_16x16x32_bf16 v[200:203], v[64:67], v[40:43], v[200:203]
 v_mfma_f32_16x16x32_bf16 v[208:211], v[64:67], v[48:51], v[208:211]
 v_mfma_f32_16x16x32_bf16 v[216:219], v[64:67], v[56:59], v[216:219]
 v_mfma_f32_16x16x32_bf16 v[196:199], v[72:75], v[32:35], v[196:199]
 v_mfma_f32_16x16x32_bf16 v[204:207], v[72:75], v[40:43], v[204:207]
 v_mfma_f32_16x16x32_bf16 v[212:215], v[72:75], v[48:51], v[212:215]
 v_mfma_f32_16x16x32_bf16 v[220:223], v[72:75], v[56:59], v[220:223]
 v_mfma_f32_16x16x32_bf16 v[224:227], v[80:83], v[32:35], v[224:227]
 v_mfma_f32_16x16x32_bf16 v[232:235], v[80:83], v[40:43], v[232:235]
 v_mfma_f32_16x16x32_bf16 v[240:243], v[80:83], v[48:51], v[240:243]
 v_mfma_f32_16x16x32_bf16 v[248:251], v[80:83], v[56:59], v[248:251]
 v_mfma_f32_16x16x32_bf16 v[228:231], v[88:91], v[32:35], v[228:231]
 v_mfma_f32_16x16x32_bf16 v[236:239], v[88:91], v[40:43], v[236:239]
 v_mfma_f32_16x16x32_bf16 v[244:247], v[88:91], v[48:51], v[244:247]
 v_mfma_f32_16x16x32_bf16 v[252:255], v[88:91], v[56:59], v[252:255]
 s_add_u32 s29, s29, 12288
 s_cmp_lt_u32 s29, 196608
 s_cbranch_scc1 L_fb_p2
 v_mov_b32 v22, v28
 v_accvgpr_read_b32 v23, a244
 v_accvgpr_read_b32 v24, a248
 v_accvgpr_read_b32 v25, a252
 v_rcp_f32 v22, v22
 v_rcp_f32 v23, v23
 v_rcp_f32 v24, v24
 v_rcp_f32 v25, v25
 v_mul_f32 v32, v96, v22
 v_mul_f32 v33, v97, v22
 v_mul_f32 v34, v98, v22
 v_mul_f32 v35, v99, v22
 v_mul_f32 v36, v100, v22
 v_mul_f32 v37, v101, v22
 v_mul_f32 v38, v102, v22
 v_mul_f32 v39, v103, v22
 v_cvt_pk_bf16_f32 v32, v32, v33
 v_cvt_pk_bf16_f32 v33, v34, v35
 v_cvt_pk_bf16_f32 v34, v36, v37
 v_cvt_pk_bf16_f32 v35, v38, v39
 buffer_store_dwordx4 v[32:35], v1, s[16:19], s50 offen
 v_mul_f32 v64, v112, v22
 v_mul_f32 v65, v113, v22
 v_mul_f32 v66, v114, v22
 v_mul_f32 v67, v115, v22
 v_mul_f32 v68, v116, v22
 v_mul_f32 v69, v117, v22
 v_mul_f32 v70, v118, v22
 v_mul_f32 v71, v119, v22
 v_cvt_pk_bf16_f32 v64, v64, v65
 v_cvt_pk_bf16_f32 v65, v66, v67
 v_cvt_pk_bf16_f32 v66, v68, v69
 v_cvt_pk_bf16_f32 v67, v70, v71
 buffer_store_dwordx4 v[64:67], v1, s[16:19], s50 offen offset:64
 v_mul_f32 v32, v128, v22
 v_mul_f32 v33, v129, v22
 v_mul_f32 v34, v130, v22
 v_mul_f32 v35, v131, v22
 v_mul_f32 v36, v132, v22
 v_mul_f32 v37, v133, v22
 v_mul_f32 v38, v134, v22
 v_mul_f32 v39, v135, v22
 v_cvt_pk_bf16_f32 v32, v32, v33
 v_cvt_pk_bf16_f32 v33, v34, v35
 v_cvt_pk_bf16_f32 v34, v36, v37
 v_cvt_pk_bf16_f32 v35, v38, v39
 buffer_store_dwordx4 v[32:35], v1, s[16:19], s50 offen offset:128
 v_mul_f32 v64, v160, v22
 v_mul_f32 v65, v161, v22
 v_mul_f32 v66, v162, v22
 v_mul_f32 v67, v163, v22
 v_mul_f32 v68, v164, v22
 v_mul_f32 v69, v165, v22
 v_mul_f32 v70, v166, v22
 v_mul_f32 v71, v167, v22
 v_cvt_pk_bf16_f32 v64, v64, v65
 v_cvt_pk_bf16_f32 v65, v66, v67
 v_cvt_pk_bf16_f32 v66, v68, v69
 v_cvt_pk_bf16_f32 v67, v70, v71
 buffer_store_dwordx4 v[64:67], v1, s[16:19], s50 offen offset:192
 v_mul_f32 v32, v192, v22
 v_mul_f32 v33, v193, v22
 v_mul_f32 v34, v194, v22
 v_mul_f32 v35, v195, v22
 v_mul_f32 v36, v196, v22
 v_mul_f32 v37, v197, v22
 v_mul_f32 v38, v198, v22
 v_mul_f32 v39, v199, v22
 v_cvt_pk_bf16_f32 v32, v32, v33
 v_cvt_pk_bf16_f32 v33, v34, v35
 v_cvt_pk_bf16_f32 v34, v36, v37
 v_cvt_pk_bf16_f32 v35, v38, v39
 buffer_store_dwordx4 v[32:35], v1, s[16:19], s50 offen offset:256
 v_mul_f32 v64, v224, v22
 v_mul_f32 v65, v225, v22
 v_mul_f32 v66, v226, v22
 v_mul_f32 v67, v227, v22
 v_mul_f32 v68, v228, v22
 v_mul_f32 v69, v229, v22
 v_mul_f32 v70, v230, v22
 v_mul_f32 v71, v231, v22
 v_cvt_pk_bf16_f32 v64, v64, v65
 v_cvt_pk_bf16_f32 v65, v66, v67
 v_cvt_pk_bf16_f32 v66, v68, v69
 v_cvt_pk_bf16_f32 v67, v70, v71
 buffer_store_dwordx4 v[64:67], v1, s[16:19], s50 offen offset:320
 v_mul_f32 v40, v104, v23
 v_mul_f32 v41, v105, v23
 v_mul_f32 v42, v106, v23
 v_mul_f32 v43, v107, v23
 v_mul_f32 v44, v108, v23
 v_mul_f32 v45, v109, v23
 v_mul_f32 v46, v110, v23
 v_mul_f32 v47, v111, v23
 v_cvt_pk_bf16_f32 v40, v40, v41
 v_cvt_pk_bf16_f32 v41, v42, v43
 v_cvt_pk_bf16_f32 v42, v44, v45
 v_cvt_pk_bf16_f32 v43, v46, v47
 buffer_store_dwordx4 v[40:43], v1, s[16:19], s52 offen
 v_mul_f32 v72, v120, v23
 v_mul_f32 v73, v121, v23
 v_mul_f32 v74, v122, v23
 v_mul_f32 v75, v123, v23
 v_mul_f32 v76, v124, v23
 v_mul_f32 v77, v125, v23
 v_mul_f32 v78, v126, v23
 v_mul_f32 v79, v127, v23
 v_cvt_pk_bf16_f32 v72, v72, v73
 v_cvt_pk_bf16_f32 v73, v74, v75
 v_cvt_pk_bf16_f32 v74, v76, v77
 v_cvt_pk_bf16_f32 v75, v78, v79
 buffer_store_dwordx4 v[72:75], v1, s[16:19], s52 offen offset:64
 v_mul_f32 v40, v136, v23
 v_mul_f32 v41, v137, v23
 v_mul_f32 v42, v138, v23
 v_mul_f32 v43, v139, v23
 v_mul_f32 v44, v140, v23
 v_mul_f32 v45, v141, v23
 v_mul_f32 v46, v142, v23
 v_mul_f32 v47, v143, v23
 v_cvt_pk_bf16_f32 v40, v40, v41
 v_cvt_pk_bf16_f32 v41, v42, v43
 v_cvt_pk_bf16_f32 v42, v44, v45
 v_cvt_pk_bf16_f32 v43, v46, v47
 buffer_store_dwordx4 v[40:43], v1, s[16:19], s52 offen offset:128
 v_mul_f32 v72, v168, v23
 v_mul_f32 v73, v169, v23
 v_mul_f32 v74, v170, v23
 v_mul_f32 v75, v171, v23
 v_mul_f32 v76, v172, v23
 v_mul_f32 v77, v173, v23
 v_mul_f32 v78, v174, v23
 v_mul_f32 v79, v175, v23
 v_cvt_pk_bf16_f32 v72, v72, v73
 v_cvt_pk_bf16_f32 v73, v74, v75
 v_cvt_pk_bf16_f32 v74, v76, v77
 v_cvt_pk_bf16_f32 v75, v78, v79
 buffer_store_dwordx4 v[72:75], v1, s[16:19], s52 offen offset:192
 v_mul_f32 v40, v200, v23
 v_mul_f32 v41, v201, v23
 v_mul_f32 v42, v202, v23
 v_mul_f32 v43, v203, v23
 v_mul_f32 v44, v204, v23
 v_mul_f32 v45, v205, v23
 v_mul_f32 v46, v206, v23
 v_mul_f32 v47, v207, v23
 v_cvt_pk_bf16_f32 v40, v40, v41
 v_cvt_pk_bf16_f32 v41, v42, v43
 v_cvt_pk_bf16_f32 v42, v44, v45
 v_cvt_pk_bf16_f32 v43, v46, v47
 buffer_store_dwordx4 v[40:43], v1, s[16:19], s52 offen offset:256
 v_mul_f32 v72, v232, v23
 v_mul_f32 v73, v233, v23
 v_mul_f32 v74, v234, v23
 v_mul_f32 v75, v235, v23
 v_mul_f32 v76, v236, v23
 v_mul_f32 v77, v237, v23
 v_mul_f32 v78, v238, v23
 v_mul_f32 v79, v239, v23
 v_cvt_pk_bf16_f32 v72, v72, v73
 v_cvt_pk_bf16_f32 v73, v74, v75
 v_cvt_pk_bf16_f32 v74, v76, v77
 v_cvt_pk_bf16_f32 v75, v78, v79
 buffer_store_dwordx4 v[72:75], v1, s[16:19], s52 offen offset:320
 v_accvgpr_read_b32 v48, a192
 v_mul_f32 v48, v48, v24
 v_accvgpr_read_b32 v49, a193
 v_mul_f32 v49, v49, v24
 v_accvgpr_read_b32 v50, a194
 v_mul_f32 v50, v50, v24
 v_accvgpr_read_b32 v51, a195
 v_mul_f32 v51, v51, v24
 v_accvgpr_read_b32 v52, a196
 v_mul_f32 v52, v52, v24
 v_accvgpr_read_b32 v53, a197
 v_mul_f32 v53, v53, v24
 v_accvgpr_read_b32 v54, a198
 v_mul_f32 v54, v54, v24
 v_accvgpr_read_b32 v55, a199
 v_mul_f32 v55, v55, v24
 v_cvt_pk_bf16_f32 v48, v48, v49
 v_cvt_pk_bf16_f32 v49, v50, v51
 v_cvt_pk_bf16_f32 v50, v52, v53
 v_cvt_pk_bf16_f32 v51, v54, v55
 buffer_store_dwordx4 v[48:51], v1, s[16:19], s54 offen
 v_accvgpr_read_b32 v80, a208
 v_mul_f32 v80, v80, v24
 v_accvgpr_read_b32 v81, a209
 v_mul_f32 v81, v81, v24
 v_accvgpr_read_b32 v82, a210
 v_mul_f32 v82, v82, v24
 v_accvgpr_read_b32 v83, a211
 v_mul_f32 v83, v83, v24
 v_accvgpr_read_b32 v84, a212
 v_mul_f32 v84, v84, v24
 v_accvgpr_read_b32 v85, a213
 v_mul_f32 v85, v85, v24
 v_accvgpr_read_b32 v86, a214
 v_mul_f32 v86, v86, v24
 v_accvgpr_read_b32 v87, a215
 v_mul_f32 v87, v87, v24
 v_cvt_pk_bf16_f32 v80, v80, v81
 v_cvt_pk_bf16_f32 v81, v82, v83
 v_cvt_pk_bf16_f32 v82, v84, v85
 v_cvt_pk_bf16_f32 v83, v86, v87
 buffer_store_dwordx4 v[80:83], v1, s[16:19], s54 offen offset:64
 v_mul_f32 v48, v144, v24
 v_mul_f32 v49, v145, v24
 v_mul_f32 v50, v146, v24
 v_mul_f32 v51, v147, v24
 v_mul_f32 v52, v148, v24
 v_mul_f32 v53, v149, v24
 v_mul_f32 v54, v150, v24
 v_mul_f32 v55, v151, v24
 v_cvt_pk_bf16_f32 v48, v48, v49
 v_cvt_pk_bf16_f32 v49, v50, v51
 v_cvt_pk_bf16_f32 v50, v52, v53
 v_cvt_pk_bf16_f32 v51, v54, v55
 buffer_store_dwordx4 v[48:51], v1, s[16:19], s54 offen offset:128
 v_mul_f32 v80, v176, v24
 v_mul_f32 v81, v177, v24
 v_mul_f32 v82, v178, v24
 v_mul_f32 v83, v179, v24
 v_mul_f32 v84, v180, v24
 v_mul_f32 v85, v181, v24
 v_mul_f32 v86, v182, v24
 v_mul_f32 v87, v183, v24
 v_cvt_pk_bf16_f32 v80, v80, v81
 v_cvt_pk_bf16_f32 v81, v82, v83
 v_cvt_pk_bf16_f32 v82, v84, v85
 v_cvt_pk_bf16_f32 v83, v86, v87
 buffer_store_dwordx4 v[80:83], v1, s[16:19], s54 offen offset:192
 v_mul_f32 v48, v208, v24
 v_mul_f32 v49, v209, v24
 v_mul_f32 v50, v210, v24
 v_mul_f32 v51, v211, v24
 v_mul_f32 v52, v212, v24
 v_mul_f32 v53, v213, v24
 v_mul_f32 v54, v214, v24
 v_mul_f32 v55, v215, v24
 v_cvt_pk_bf16_f32 v48, v48, v49
 v_cvt_pk_bf16_f32 v49, v50, v51
 v_cvt_pk_bf16_f32 v50, v52, v53
 v_cvt_pk_bf16_f32 v51, v54, v55
 buffer_store_dwordx4 v[48:51], v1, s[16:19], s54 offen offset:256
 v_mul_f32 v80, v240, v24
 v_mul_f32 v81, v241, v24
 v_mul_f32 v82, v242, v24
 v_mul_f32 v83, v243, v24
 v_mul_f32 v84, v244, v24
 v_mul_f32 v85, v245, v24
 v_mul_f32 v86, v246, v24
 v_mul_f32 v87, v247, v24
 v_cvt_pk_bf16_f32 v80, v80, v81
 v_cvt_pk_bf16_f32 v81, v82, v83
 v_cvt_pk_bf16_f32 v82, v84, v85
 v_cvt_pk_bf16_f32 v83, v86, v87
 buffer_store_dwordx4 v[80:83], v1, s[16:19], s54 offen offset:320
 v_accvgpr_read_b32 v56, a200
 v_mul_f32 v56, v56, v25
 v_accvgpr_read_b32 v57, a201
 v_mul_f32 v57, v57, v25
 v_accvgpr_read_b32 v58, a202
 v_mul_f32 v58, v58, v25
 v_accvgpr_read_b32 v59, a203
 v_mul_f32 v59, v59, v25
 v_accvgpr_read_b32 v60, a204
 v_mul_f32 v60, v60, v25
 v_accvgpr_read_b32 v61, a205
 v_mul_f32 v61, v61, v25
 v_accvgpr_read_b32 v62, a206
 v_mul_f32 v62, v62, v25
 v_accvgpr_read_b32 v63, a207
 v_mul_f32 v63, v63, v25
 v_cvt_pk_bf16_f32 v56, v56, v57
 v_cvt_pk_bf16_f32 v57, v58, v59
 v_cvt_pk_bf16_f32 v58, v60, v61
 v_cvt_pk_bf16_f32 v59, v62, v63
 buffer_store_dwordx4 v[56:59], v1, s[16:19], s56 offen
 v_accvgpr_read_b32 v88, a216
 v_mul_f32 v88, v88, v25
 v_accvgpr_read_b32 v89, a217
 v_mul_f32 v89, v89, v25
 v_accvgpr_read_b32 v90, a218
 v_mul_f32 v90, v90, v25
 v_accvgpr_read_b32 v91, a219
 v_mul_f32 v91, v91, v25
 v_accvgpr_read_b32 v92, a220
 v_mul_f32 v92, v92, v25
 v_accvgpr_read_b32 v93, a221
 v_mul_f32 v93, v93, v25
 v_accvgpr_read_b32 v94, a222
 v_mul_f32 v94, v94, v25
 v_accvgpr_read_b32 v95, a223
 v_mul_f32 v95, v95, v25
 v_cvt_pk_bf16_f32 v88, v88, v89
 v_cvt_pk_bf16_f32 v89, v90, v91
 v_cvt_pk_bf16_f32 v90, v92, v93
 v_cvt_pk_bf16_f32 v91, v94, v95
 buffer_store_dwordx4 v[88:91], v1, s[16:19], s56 offen offset:64
 v_mul_f32 v56, v152, v25
 v_mul_f32 v57, v153, v25
 v_mul_f32 v58, v154, v25
 v_mul_f32 v59, v155, v25
 v_mul_f32 v60, v156, v25
 v_mul_f32 v61, v157, v25
 v_mul_f32 v62, v158, v25
 v_mul_f32 v63, v159, v25
 v_cvt_pk_bf16_f32 v56, v56, v57
 v_cvt_pk_bf16_f32 v57, v58, v59
 v_cvt_pk_bf16_f32 v58, v60, v61
 v_cvt_pk_bf16_f32 v59, v62, v63
 buffer_store_dwordx4 v[56:59], v1, s[16:19], s56 offen offset:128
 v_mul_f32 v88, v184, v25
 v_mul_f32 v89, v185, v25
 v_mul_f32 v90, v186, v25
 v_mul_f32 v91, v187, v25
 v_mul_f32 v92, v188, v25
 v_mul_f32 v93, v189, v25
 v_mul_f32 v94, v190, v25
 v_mul_f32 v95, v191, v25
 v_cvt_pk_bf16_f32 v88, v88, v89
 v_cvt_pk_bf16_f32 v89, v90, v91
 v_cvt_pk_bf16_f32 v90, v92, v93
 v_cvt_pk_bf16_f32 v91, v94, v95
 buffer_store_dwordx4 v[88:91], v1, s[16:19], s56 offen offset:192
 v_mul_f32 v56, v216, v25
 v_mul_f32 v57, v217, v25
 v_mul_f32 v58, v218, v25
 v_mul_f32 v59, v219, v25
 v_mul_f32 v60, v220, v25
 v_mul_f32 v61, v221, v25
 v_mul_f32 v62, v222, v25
 v_mul_f32 v63, v223, v25
 v_cvt_pk_bf16_f32 v56, v56, v57
 v_cvt_pk_bf16_f32 v57, v58, v59
 v_cvt_pk_bf16_f32 v58, v60, v61
 v_cvt_pk_bf16_f32 v59, v62, v63
 buffer_store_dwordx4 v[56:59], v1, s[16:19], s56 offen offset:256
 v_mul_f32 v88, v248, v25
 v_mul_f32 v89, v249, v25
 v_mul_f32 v90, v250, v25
 v_mul_f32 v91, v251, v25
 v_mul_f32 v92, v252, v25
 v_mul_f32 v93, v253, v25
 v_mul_f32 v94, v254, v25
 v_mul_f32 v95, v255, v25
 v_cvt_pk_bf16_f32 v88, v88, v89
 v_cvt_pk_bf16_f32 v89, v90, v91
 v_cvt_pk_bf16_f32 v90, v92, v93
 v_cvt_pk_bf16_f32 v91, v94, v95
 buffer_store_dwordx4 v[88:91], v1, s[16:19], s56 offen offset:320
 s_waitcnt vmcnt(0) lgkmcnt(0)
L_fb_next:
 s_lshr_b32 s26, s26, 1
 s_add_u32 s47, s47, 25165824
 s_add_u32 s48, s48, 25165824
 s_cmp_lg_u32 s26, 0
 s_cbranch_scc1 L_fb_blk
 s_endpgm
.section .rodata,"a"
.p2align 6
.amdhsa_kernel standalone__mha_softmax__near_ridge_kernel
  .amdhsa_next_free_vgpr 512
  .amdhsa_next_free_sgpr 102
  .amdhsa_accum_offset 256
  .amdhsa_group_segment_fixed_size 0
  .amdhsa_kernarg_size 48
  .amdhsa_user_sgpr_count 2
  .amdhsa_user_sgpr_kernarg_segment_ptr 1
  .amdhsa_system_sgpr_workgroup_id_x 1
.end_amdhsa_kernel
```
